```python
import torch

def _softmax(x, axis=-1):
    return torch.softmax(x, dim=axis)
def _gelu(x):
    return torch.nn.functional.gelu(x, approximate="tanh")
def _silu(x):
    return torch.nn.functional.silu(x)
def _sigmoid(x):
    return torch.sigmoid(x)
def _layernorm(x, axis=-1, eps=1e-5):
    m = x.mean(dim=axis, keepdim=True)
    v = x.var(dim=axis, keepdim=True, unbiased=False)
    return (x - m) / torch.sqrt(v + eps)
def _scatter_add(tgt, idx, src, axis=0):
    return tgt.clone().index_add_(axis, idx, src)
def _segment_sum(src, seg, n):
    out = torch.zeros((n,) + src.shape[1:], dtype=src.dtype)
    return out.index_add_(0, seg, src)
def _pad(x, pw):
    flat = tuple(v for pair in reversed(pw) for v in pair)
    return torch.nn.functional.pad(x, flat)

kernel_name = 'concat_heads__mha_block_cached__mha_block_cached__near_ridge'

def setup_inputs():

    _w = (lambda a: (lambda t: t.to(torch.bfloat16) if t.is_floating_point() else t)(torch.as_tensor(a)))
    def _A_setup():
        B, Sq, D = 8, 144, 576
        H, Sk, Dh = 32, 512, 128
        return {
            "x": _w((lambda *s: torch.randn(*s, dtype=torch.bfloat16) * 0.8)(B, Sq, D)),
            "k_cache": _w((lambda *s: torch.randn(*s, dtype=torch.bfloat16) * 0.8)(B, H, Sk, Dh)),
            "v_cache": _w((lambda *s: torch.randn(*s, dtype=torch.bfloat16) * 0.05)(B, H, Sk, Dh)),
            "wq": _w((lambda *s: torch.randn(*s, dtype=torch.bfloat16) * 0.8)(D, H * Dh) * (D ** -0.5)),
            "wo": _w((lambda *s: torch.randn(*s, dtype=torch.bfloat16) * 0.05)(H * Dh, D) * ((H * Dh) ** -0.5)),
        }
    _A_in = _A_setup()

    def _B_setup():
        B, Sq, D = 8, 144, 576
        H, Sk, Dh = 32, 512, 128
        return {
            "x": _w((lambda *s: torch.randn(*s, dtype=torch.bfloat16) * 0.8)(B, Sq, D)),
            "k_cache": _w((lambda *s: torch.randn(*s, dtype=torch.bfloat16) * 0.8)(B, H, Sk, Dh)),
            "v_cache": _w((lambda *s: torch.randn(*s, dtype=torch.bfloat16) * 0.05)(B, H, Sk, Dh)),
            "wq": _w((lambda *s: torch.randn(*s, dtype=torch.bfloat16) * 0.8)(D, H * Dh) * (D ** -0.5)),
            "wo": _w((lambda *s: torch.randn(*s, dtype=torch.bfloat16) * 0.05)(H * Dh, D) * ((H * Dh) ** -0.5)),
        }
    _B_in = _B_setup()

    return {
        "A_x": _A_in["x"],
        "A_k_cache": _A_in["k_cache"],
        "A_v_cache": _A_in["v_cache"],
        "A_wq": _A_in["wq"],
        "A_wo": _A_in["wo"],
        "B_x": _B_in["x"],
        "B_k_cache": _B_in["k_cache"],
        "B_v_cache": _B_in["v_cache"],
        "B_wq": _B_in["wq"],
        "B_wo": _B_in["wo"],
    }

def reference(A_x, A_k_cache, A_v_cache, A_wq, A_wo, B_x, B_k_cache, B_v_cache, B_wq, B_wo):
    def _A_ref(x, k_cache, v_cache, wq, wo):
        B, Sq, D = x.shape
        H, Dh = 32, 128
        q = (lambda x, *d: x.permute(*d))((x @ wq).reshape(B, Sq, H, Dh), 0, 2, 1, 3)
        scores = torch.einsum("bhqd,bhkd->bhqk", q, k_cache) * (Dh ** -0.5)
        p = _softmax(scores, axis=-1)
        o = torch.einsum("bhqk,bhkd->bhqd", p, v_cache)
        return (lambda x, *d: x.permute(*d))(o, 0, 2, 1, 3).reshape(B, Sq, H * Dh) @ wo

    def _B_ref(x, k_cache, v_cache, wq, wo):
        B, Sq, D = x.shape
        H, Dh = 32, 128
        q = (lambda x, *d: x.permute(*d))((x @ wq).reshape(B, Sq, H, Dh), 0, 2, 1, 3)
        scores = torch.einsum("bhqd,bhkd->bhqk", q, k_cache) * (Dh ** -0.5)
        p = _softmax(scores, axis=-1)
        o = torch.einsum("bhqk,bhkd->bhqd", p, v_cache)
        return (lambda x, *d: x.permute(*d))(o, 0, 2, 1, 3).reshape(B, Sq, H * Dh) @ wo

    a = _A_ref(A_x, A_k_cache, A_v_cache, A_wq, A_wo)
    b = _B_ref(B_x, B_k_cache, B_v_cache, B_wq, B_wo)
    return torch.concatenate([a, b], axis=-1)
```

```asm
; @launch grid=(256,1,1) block=(256,1,1) lds=163840
.amdgcn_target "amdgcn-amd-amdhsa--gfx950"
.text
.globl concat_heads__mha_block_cached__mha_block_cached__near_ridge_kernel
.p2align 8
.type concat_heads__mha_block_cached__mha_block_cached__near_ridge_kernel,@function
concat_heads__mha_block_cached__mha_block_cached__near_ridge_kernel:
  s_cmp_ge_u32 s2, 256
  s_cbranch_scc1 L_end
  s_load_dwordx8 s[52:59], s[0:1], 0
  s_load_dwordx8 s[60:67], s[0:1], 40
  s_load_dwordx2 s[82:83], s[0:1], 96
  s_load_dwordx2 s[94:95], s[0:1], 32
  s_load_dwordx2 s[96:97], s[0:1], 72
  s_load_dwordx2 s[98:99], s[0:1], 88
  v_lshrrev_b32 v1, 6, v0
  v_and_b32 v2, 63, v0
  v_readfirstlane_b32 s28, v1
  s_and_b32 s3, s2, 7
  s_lshr_b32 s4, s2, 3
  s_lshr_b32 s5, s4, 2
  s_and_b32 s4, s4, 3
  s_and_b32 s6, s3, 3
  s_lshl_b32 s6, s6, 3
  s_lshl_b32 s7, s4, 1
  s_add_u32 s6, s6, s7
  s_lshr_b32 s29, s28, 1
  s_add_u32 s7, s6, s29
  s_lshl_b32 s44, s29, 15
  s_lshr_b32 s30, s2, 2
  s_and_b32 s30, s30, 14
  s_add_u32 s30, s30, s29
  s_lshl_b32 s30, s30, 1
  v_lshrrev_b32 v3, 4, v2
  v_and_b32 v4, 15, v2
  v_lshlrev_b32 v5, 1, v3
  v_xor_b32 v5, v5, v4
  v_lshlrev_b32 v5, 4, v5
  v_lshl_add_u32 v56, v3, 8, v5
  v_xor_b32 v57, 128, v56
  v_lshl_add_u32 v54, v3, 13, v5
  s_lshl_b32 s38, s7, 8
  v_add_u32 v54, s38, v54
  v_xor_b32 v55, 128, v54
  v_add_u32 v55, 64512, v55
  s_lshl_b32 s38, s29, 2
  v_add_u32 v5, s38, v3
  v_and_b32 v6, 7, v2
  v_xor_b32 v5, v5, v6
  v_lshlrev_b32 v5, 4, v5
  v_lshrrev_b32 v6, 3, v2
  s_lshl_b32 s38, s29, 3
  v_add_u32 v6, s38, v6
  s_movk_i32 s38, 1152
  v_mad_u32_u24 v53, v6, s38, v5
  s_waitcnt lgkmcnt(0)
  s_cmp_ge_u32 s3, 4
  s_cselect_b32 s52, s60, s52
  s_cselect_b32 s53, s61, s53
  s_cselect_b32 s54, s62, s54
  s_cselect_b32 s55, s63, s55
  s_cselect_b32 s56, s64, s56
  s_cselect_b32 s57, s65, s57
  s_cselect_b32 s58, s66, s58
  s_cselect_b32 s59, s67, s59
  s_cselect_b32 s94, s96, s94
  s_cselect_b32 s95, s97, s95
  s_mul_i32 s38, s5, 165888
  s_add_u32 s8, s52, s38
  s_addc_u32 s9, s53, 0
  s_mov_b32 s10, 165888
  s_mov_b32 s11, 0x20000
  s_mov_b32 s12, s58
  s_mov_b32 s13, s59
  s_mov_b32 s14, 4718592
  s_mov_b32 s15, 0x20000
  s_and_b32 s76, s28, 1
  s_mul_i32 s47, s29, 24576
  s_add_u32 s47, s47, 102400
  s_mul_i32 s75, s76, 92160
  s_mul_i32 s74, s76, 10240
  s_lshl_b32 s38, s29, 10
  s_add_u32 s74, s74, s38
  s_add_u32 s74, s74, 65536
  s_lshl_b32 s77, s76, 12
  s_add_u32 s77, s77, s47
  s_lshl_b32 s78, s76, 17
  s_mov_b32 s60, s54
  s_mov_b32 s61, s55
  s_lshr_b32 s52, s4, 1
  s_mul_i32 s52, s52, 4
  s_andn2_b32 s38, s5, 1
  s_add_u32 s52, s52, s38
  s_sub_u32 s38, s52, 9
  s_cselect_b32 s52, s52, s38
  s_lshl_b32 s32, s52, 19
  s_add_u32 s32, s32, s78
  s_add_u32 s54, s78, 4718592
  s_add_u32 s34, s52, 0
  s_sub_u32 s35, s34, 9
  s_cselect_b32 s34, s34, s35
  s_lshl_b32 s34, s34, 7
  s_add_u32 s35, s74, 0
  s_add_u32 s34, s75, s34
  s_mov_b32 m0, s35
  s_nop 0
  buffer_load_dwordx4 v53, s[8:11], s34 offen offset:0  lds
  s_add_u32 s34, s34, 16384
  s_nop 0
  buffer_load_dwordx4 v53, s[8:11], s34 offen offset:2048  lds
  s_add_u32 s34, s34, 20480
  s_add_u32 m0, m0, 4096
  s_nop 0
  buffer_load_dwordx4 v53, s[8:11], s34 offen offset:0  lds
  s_add_u32 s34, s34, 16384
  s_nop 0
  buffer_load_dwordx4 v53, s[8:11], s34 offen offset:2048  lds
  s_add_u32 s34, s34, 20480
  s_add_u32 m0, m0, 4096
  s_nop 0
  s_cmp_eq_u32 s76, 1
  s_cbranch_scc1 L_x0
  buffer_load_dwordx4 v53, s[8:11], s34 offen offset:0  lds
  s_nop 0
L_x0:
  s_add_u32 s33, s77, 0
  s_add_u32 s72, s32, 30720
  s_mov_b32 m0, s33
  s_nop 0
  buffer_load_dwordx4 v54, s[12:15], s32 offen offset:0  lds
  buffer_load_dwordx4 v55, s[12:15], s32 offen offset:1024  lds
  buffer_load_dwordx4 v54, s[12:15], s72 offen offset:2048  lds
  buffer_load_dwordx4 v55, s[12:15], s72 offen offset:3072  lds
  s_add_u32 s32, s32, 262144
  s_cmp_ge_u32 s32, s54
  s_cselect_b32 s32, s78, s32
  s_add_u32 s33, s77, 8192
  s_add_u32 s72, s32, 30720
  s_mov_b32 m0, s33
  s_nop 0
  buffer_load_dwordx4 v54, s[12:15], s32 offen offset:0  lds
  buffer_load_dwordx4 v55, s[12:15], s32 offen offset:1024  lds
  buffer_load_dwordx4 v54, s[12:15], s72 offen offset:2048  lds
  buffer_load_dwordx4 v55, s[12:15], s72 offen offset:3072  lds
  s_add_u32 s32, s32, 262144
  s_cmp_ge_u32 s32, s54
  s_cselect_b32 s32, s78, s32
  s_mul_i32 s53, s4, 0
  s_add_u32 s53, s53, 1
  s_lshl_b32 s38, s5, 5
  s_add_u32 s38, s38, s7
  s_lshl_b32 s39, s38, 17
  s_add_u32 s16, s60, s39
  s_addc_u32 s17, s61, 0
  s_mov_b32 s18, 131072
  s_mov_b32 s19, 0x20000
  s_add_u32 s20, s56, s39
  s_addc_u32 s21, s57, 0
  s_mov_b32 s22, 131072
  s_mov_b32 s23, 0x20000
  s_mov_b32 s24, s82
  s_mov_b32 s25, s83
  s_mov_b32 s26, 18874368
  s_mov_b32 s27, 0x20000
  s_lshr_b32 s39, s3, 2
  s_lshl_b32 s39, s39, 8
  s_add_u32 s38, s38, s39
  s_mul_i32 s50, s38, 36864
  s_mov_b32 s56, s94
  s_mov_b32 s57, s95
  s_mov_b32 s58, 4718592
  s_mov_b32 s59, 0x20000
  s_and_b32 s55, s3, 3
  s_lshl_b32 s55, s55, 5
  s_lshr_b32 s38, s2, 3
  s_add_u32 s55, s55, s38
  s_lshl_b32 s55, s55, 1
  s_add_u32 s55, s55, s29
  s_mul_i32 s55, s55, 18432
  s_cmp_eq_u32 s76, 1
  s_cselect_b32 s68, s20, s16
  s_cselect_b32 s69, s21, s17
  s_mov_b32 s70, 131072
  s_mov_b32 s71, 0x20000
  s_lshl_b32 s39, s76, 13
  s_add_u32 s39, s39, s44
  s_mov_b32 s6, s98
  s_mov_b32 s7, s99
  v_lshlrev_b32 v51, 7, v2
  s_mov_b32 s40, -2
  s_cmp_eq_u32 s28, 0
  s_cbranch_scc0 L_nc
  s_getpc_b64 s[80:81]
L_pc:
  s_sub_u32 s80, s80, L_pc-concat_heads__mha_block_cached__mha_block_cached__near_ridge_kernel
  s_subb_u32 s81, s81, 0
  s_lshr_b32 s38, s2, 3
  s_and_b32 s38, s38, 15
  s_lshl_b32 s38, s38, 13
  v_add_u32 v8, s38, v51
  s_mov_b32 s38, L_codeend-concat_heads__mha_block_cached__mha_block_cached__near_ridge_kernel-4
  v_min_u32 v8, s38, v8
  global_load_dword v50, v8, s[80:81]
  v_mov_b32 v8, 163836
  v_mov_b32 v9, 0
  ds_write_b32 v8, v9
  s_cmp_lt_u32 s2, 8
  s_cbranch_scc0 L_nc
  s_memrealtime s[80:81]
  v_mov_b32 v11, 0
  s_waitcnt lgkmcnt(0)
  s_or_b32 s80, s80, 1
  v_mov_b32 v10, s80
  s_mov_b64 exec, 1
  global_atomic_cmpswap v9, v[10:11], s[6:7] sc1
  s_mov_b64 exec, -1
L_nc:
  v_and_b32 v5, 7, v4
  v_lshlrev_b32 v5, 1, v5
  v_xor_b32 v5, v5, v3
  v_lshlrev_b32 v5, 4, v5
  v_lshl_add_u32 v5, v4, 8, v5
  v_add_u32 v60, s44, v5
  v_xor_b32 v61, 64, v60
  v_xor_b32 v62, 128, v60
  v_xor_b32 v63, 192, v60
  v_bfe_u32 v5, v2, 2, 2
  v_and_b32 v6, 1, v3
  v_lshl_add_u32 v5, v6, 2, v5
  v_lshrrev_b32 v6, 1, v3
  v_lshl_add_u32 v6, v6, 4, v5
  v_lshlrev_b32 v5, 1, v5
  v_bfe_u32 v7, v2, 1, 1
  v_xor_b32 v5, v5, v7
  v_lshlrev_b32 v5, 4, v5
  v_and_b32 v7, 1, v2
  v_lshl_add_u32 v5, v7, 3, v5
  v_lshl_add_u32 v5, v6, 8, v5
  v_add_u32 v64, s47, v5
  s_mov_b32 s47, s77
  v_xor_b32 v65, 32, v64
  v_xor_b32 v66, 64, v64
  v_xor_b32 v67, 96, v64
  v_xor_b32 v68, 128, v64
  v_xor_b32 v69, 160, v64
  v_xor_b32 v70, 192, v64
  v_xor_b32 v71, 224, v64
  v_lshrrev_b32 v5, 1, v4
  v_xor_b32 v5, v5, v3
  v_lshlrev_b32 v5, 4, v5
  v_lshl_add_u32 v5, v4, 7, v5
  s_mul_i32 s79, s76, 8192
  s_add_u32 s79, s79, 65536
  v_add_u32 v58, s79, v5
  v_xor_b32 v59, 64, v58
  s_mul_i32 s79, s76, 5120
  v_lshl_add_u32 v52, v2, 4, s79
  s_mul_i32 s79, s29, 73728
  v_add_u32 v49, s79, v52
  s_mov_b32 s49, 0x3e0293ee
  s_mov_b32 s46, 0
  s_mov_b32 s48, 8192
  s_mov_b32 s51, -16384
  s_mov_b32 s36, 8192
  s_mov_b32 s37, 18432
  s_movk_i32 s79, 3641
  s_mul_i32 s80, s76, 864
  v_add_u32 v5, 0, v2
  v_mul_u32_u24 v6, s79, v5
  v_lshrrev_b32 v6, 16, v6
  v_lshlrev_b32 v5, 4, v5
  v_mad_u32_u24 v5, v6, s80, v5
  v_subrev_u32 v32, 0, v5
  v_add_u32 v5, 64, v2
  v_mul_u32_u24 v6, s79, v5
  v_lshrrev_b32 v6, 16, v6
  v_lshlrev_b32 v5, 4, v5
  v_mad_u32_u24 v5, v6, s80, v5
  v_subrev_u32 v33, 1024, v5
  v_add_u32 v5, 128, v2
  v_mul_u32_u24 v6, s79, v5
  v_lshrrev_b32 v6, 16, v6
  v_lshlrev_b32 v5, 4, v5
  v_mad_u32_u24 v5, v6, s80, v5
  v_subrev_u32 v34, 2048, v5
  v_add_u32 v5, 192, v2
  v_mul_u32_u24 v6, s79, v5
  v_lshrrev_b32 v6, 16, v6
  v_lshlrev_b32 v5, 4, v5
  v_mad_u32_u24 v5, v6, s80, v5
  v_subrev_u32 v35, 3072, v5
  v_add_u32 v5, 256, v2
  v_mul_u32_u24 v6, s79, v5
  v_lshrrev_b32 v6, 16, v6
  v_lshlrev_b32 v5, 4, v5
  v_mad_u32_u24 v5, v6, s80, v5
  v_subrev_u32 v36, 0, v5
  v_add_u32 v5, 320, v2
  v_mul_u32_u24 v6, s79, v5
  v_lshrrev_b32 v6, 16, v6
  v_lshlrev_b32 v5, 4, v5
  v_mad_u32_u24 v5, v6, s80, v5
  v_subrev_u32 v37, 1024, v5
  v_add_u32 v5, 384, v2
  v_mul_u32_u24 v6, s79, v5
  v_lshrrev_b32 v6, 16, v6
  v_lshlrev_b32 v5, 4, v5
  v_mad_u32_u24 v5, v6, s80, v5
  v_subrev_u32 v38, 2048, v5
  v_add_u32 v5, 448, v2
  v_mul_u32_u24 v6, s79, v5
  v_lshrrev_b32 v6, 16, v6
  v_lshlrev_b32 v5, 4, v5
  v_mad_u32_u24 v5, v6, s80, v5
  v_subrev_u32 v39, 3072, v5
  v_add_u32 v5, 512, v2
  v_mul_u32_u24 v6, s79, v5
  v_lshrrev_b32 v6, 16, v6
  v_lshlrev_b32 v5, 4, v5
  v_mad_u32_u24 v5, v6, s80, v5
  v_subrev_u32 v40, 0, v5
  v_lshrrev_b32 v5, 2, v2
  v_and_b32 v6, 3, v2
  v_lshlrev_b32 v6, 3, v6
  s_movk_i32 s79, 288
  v_mad_u32_u24 v5, v5, s79, v6
  v_add_u32 v46, 18688, v5
  s_lshl_b32 s79, s28, 6
  s_add_u32 s79, s79, 18432
  v_add_u32 v45, s79, v5
  v_lshlrev_b32 v5, 4, v2
  s_lshl_b32 s79, s28, 11
  v_add_u32 v41, s79, v5
  s_cmp_eq_u32 s28, 0
  s_cselect_b32 s79, 3072, 0
  v_add_u32 v42, s79, v5
  s_cmp_lt_u32 s28, 2
  s_movk_i32 s79, 2048
  s_cselect_b32 s79, 5120, s79
  v_add_u32 v43, s79, v5
  s_cmp_lt_u32 s28, 3
  s_movk_i32 s79, 4096
  s_cselect_b32 s79, 7168, s79
  v_add_u32 v44, s79, v5
  v_lshrrev_b32 v5, 2, v2
  v_and_b32 v6, 7, v5
  v_lshlrev_b32 v6, 1, v6
  v_bfe_u32 v7, v2, 1, 1
  v_xor_b32 v6, v6, v7
  v_lshlrev_b32 v6, 4, v6
  v_and_b32 v7, 1, v2
  v_lshl_add_u32 v6, v7, 3, v6
  v_lshl_add_u32 v6, v5, 8, v6
  s_add_u32 s80, s44, 8192
  v_add_u32 v8, s80, v6
  v_xor_b32 v9, 32, v8
  v_xor_b32 v10, 64, v8
  v_xor_b32 v11, 96, v8
  v_xor_b32 v12, 128, v8
  v_xor_b32 v13, 160, v8
  v_xor_b32 v14, 192, v8
  v_xor_b32 v15, 224, v8
  v_pk_mov_b32 v[96:97], 0, 0
  v_pk_mov_b32 v[98:99], 0, 0
  v_pk_mov_b32 v[100:101], 0, 0
  v_pk_mov_b32 v[102:103], 0, 0
  v_pk_mov_b32 v[104:105], 0, 0
  v_pk_mov_b32 v[106:107], 0, 0
  v_pk_mov_b32 v[108:109], 0, 0
  v_pk_mov_b32 v[110:111], 0, 0
  v_pk_mov_b32 v[112:113], 0, 0
  v_pk_mov_b32 v[114:115], 0, 0
  v_pk_mov_b32 v[116:117], 0, 0
  v_pk_mov_b32 v[118:119], 0, 0
  v_pk_mov_b32 v[120:121], 0, 0
  v_pk_mov_b32 v[122:123], 0, 0
  v_pk_mov_b32 v[124:125], 0, 0
  v_pk_mov_b32 v[126:127], 0, 0
  v_pk_mov_b32 v[128:129], 0, 0
  v_pk_mov_b32 v[130:131], 0, 0
  v_pk_mov_b32 v[132:133], 0, 0
  v_pk_mov_b32 v[134:135], 0, 0
  v_pk_mov_b32 v[136:137], 0, 0
  v_pk_mov_b32 v[138:139], 0, 0
  v_pk_mov_b32 v[140:141], 0, 0
  v_pk_mov_b32 v[142:143], 0, 0
  v_pk_mov_b32 v[144:145], 0, 0
  v_pk_mov_b32 v[146:147], 0, 0
  v_pk_mov_b32 v[148:149], 0, 0
  v_pk_mov_b32 v[150:151], 0, 0
  v_pk_mov_b32 v[152:153], 0, 0
  v_pk_mov_b32 v[154:155], 0, 0
  v_pk_mov_b32 v[156:157], 0, 0
  v_pk_mov_b32 v[158:159], 0, 0
  v_pk_mov_b32 v[160:161], 0, 0
  v_pk_mov_b32 v[162:163], 0, 0
  v_pk_mov_b32 v[164:165], 0, 0
  v_pk_mov_b32 v[166:167], 0, 0
  v_pk_mov_b32 v[168:169], 0, 0
  v_pk_mov_b32 v[170:171], 0, 0
  v_pk_mov_b32 v[172:173], 0, 0
  v_pk_mov_b32 v[174:175], 0, 0
  v_pk_mov_b32 v[176:177], 0, 0
  v_pk_mov_b32 v[178:179], 0, 0
  v_pk_mov_b32 v[180:181], 0, 0
  v_pk_mov_b32 v[182:183], 0, 0
  v_pk_mov_b32 v[184:185], 0, 0
  v_pk_mov_b32 v[186:187], 0, 0
  v_pk_mov_b32 v[188:189], 0, 0
  v_pk_mov_b32 v[190:191], 0, 0
  v_pk_mov_b32 v[192:193], 0, 0
  v_pk_mov_b32 v[194:195], 0, 0
  v_pk_mov_b32 v[196:197], 0, 0
  v_pk_mov_b32 v[198:199], 0, 0
  v_pk_mov_b32 v[200:201], 0, 0
  v_pk_mov_b32 v[202:203], 0, 0
  v_pk_mov_b32 v[204:205], 0, 0
  v_pk_mov_b32 v[206:207], 0, 0
  v_pk_mov_b32 v[208:209], 0, 0
  v_pk_mov_b32 v[210:211], 0, 0
  v_pk_mov_b32 v[212:213], 0, 0
  v_pk_mov_b32 v[214:215], 0, 0
  v_pk_mov_b32 v[216:217], 0, 0
  v_pk_mov_b32 v[218:219], 0, 0
  v_pk_mov_b32 v[220:221], 0, 0
  v_pk_mov_b32 v[222:223], 0, 0
  v_pk_mov_b32 v[224:225], 0, 0
  v_pk_mov_b32 v[226:227], 0, 0
  v_pk_mov_b32 v[228:229], 0, 0
  v_pk_mov_b32 v[230:231], 0, 0
  v_pk_mov_b32 v[232:233], 0, 0
  v_pk_mov_b32 v[234:235], 0, 0
  v_pk_mov_b32 v[236:237], 0, 0
  v_pk_mov_b32 v[238:239], 0, 0
  v_pk_mov_b32 v[240:241], 0, 0
  v_pk_mov_b32 v[242:243], 0, 0
  v_pk_mov_b32 v[244:245], 0, 0
  v_pk_mov_b32 v[246:247], 0, 0
  v_pk_mov_b32 v[248:249], 0, 0
  v_pk_mov_b32 v[250:251], 0, 0
  v_pk_mov_b32 v[252:253], 0, 0
  v_pk_mov_b32 v[254:255], 0, 0
  s_bitcmp1_b32 s28, 0
  s_cbranch_scc1 L_small
  s_waitcnt vmcnt(4)
  s_waitcnt lgkmcnt(0)
  s_barrier
  ds_read_b128 a[208:211], v58 offset:0
  ds_read_b128 a[212:215], v58 offset:2048
  ds_read_b128 a[216:219], v58 offset:4096
  ds_read_b128 a[220:223], v58 offset:6144
  ds_read_b128 a[224:227], v58 offset:8192
  ds_read_b64_tr_b16 a[0:1], v64
  ds_read_b64_tr_b16 a[2:3], v64 offset:2048
  ds_read_b64_tr_b16 a[4:5], v65
  ds_read_b64_tr_b16 a[6:7], v65 offset:2048
  ds_read_b64_tr_b16 a[8:9], v66
  ds_read_b64_tr_b16 a[10:11], v66 offset:2048
  ds_read_b64_tr_b16 a[12:13], v67
  ds_read_b64_tr_b16 a[14:15], v67 offset:2048
  ds_read_b64_tr_b16 a[16:17], v68
  ds_read_b64_tr_b16 a[18:19], v68 offset:2048
  ds_read_b64_tr_b16 a[20:21], v69
  ds_read_b64_tr_b16 a[22:23], v69 offset:2048
  ds_read_b64_tr_b16 a[24:25], v70
  ds_read_b64_tr_b16 a[26:27], v70 offset:2048
  ds_read_b64_tr_b16 a[28:29], v71
  ds_read_b64_tr_b16 a[30:31], v71 offset:2048
  s_ashr_i32 s41, s40, 1
  s_sub_u32 s41, s41, s53
  s_mul_i32 s41, s41, 2
  s_lshr_b32 s38, s41, 1
  s_add_u32 s43, s38, s30
  s_and_b32 s43, s43, 31
  s_lshl_b32 s43, s43, 12
  s_and_b32 s38, s41, 1
  s_lshl_b32 s38, s38, 11
  s_add_u32 s43, s43, s38
  s_bfe_u32 s42, s41, 0x10002
  s_lshl_b32 s42, s42, 14
  s_and_b32 s38, s41, 3
  s_lshl_b32 s38, s38, 11
  s_add_u32 s42, s42, s38
  s_add_u32 s42, s42, s39
  s_cmp_ge_u32 s41, 16
  s_cselect_b32 s42, 196608, s42
  s_cselect_b32 s43, 1073741824, s43
  s_mov_b32 m0, s42
  s_nop 0
  buffer_load_dwordx4 v56, s[68:71], s43 offen offset:0 nt lds
  buffer_load_dwordx4 v57, s[68:71], s43 offen offset:1024 nt lds
  buffer_load_dwordx4 v56, s[68:71], s43 offen offset:2048 nt lds
  buffer_load_dwordx4 v57, s[68:71], s43 offen offset:3072 nt lds
  s_add_u32 s34, s52, 1
  s_sub_u32 s35, s34, 9
  s_cselect_b32 s34, s34, s35
  s_lshl_b32 s34, s34, 7
  s_add_u32 s35, s74, 18432
  s_add_u32 s34, s75, s34
  s_mov_b32 m0, s35
  s_nop 0
  buffer_load_dwordx4 v53, s[8:11], s34 offen offset:0  lds
  s_add_u32 s34, s34, 16384
  s_nop 0
  buffer_load_dwordx4 v53, s[8:11], s34 offen offset:2048  lds
  s_add_u32 s34, s34, 20480
  s_add_u32 m0, m0, 4096
  s_nop 0
  buffer_load_dwordx4 v53, s[8:11], s34 offen offset:0  lds
  s_add_u32 s34, s34, 16384
  s_nop 0
  buffer_load_dwordx4 v53, s[8:11], s34 offen offset:2048  lds
  s_add_u32 s34, s34, 20480
  s_add_u32 m0, m0, 4096
  s_nop 0
  buffer_load_dwordx4 v53, s[8:11], s34 offen offset:0  lds
  s_nop 0
  s_add_u32 s33, s77, 16384
  s_mov_b32 s63, s32
  s_add_u32 s64, s32, 30720
  s_mov_b32 m0, s33
  s_nop 0
  buffer_load_dwordx4 v54, s[12:15], s63 offen offset:0  lds
  buffer_load_dwordx4 v55, s[12:15], s63 offen offset:1024  lds
  buffer_load_dwordx4 v54, s[12:15], s64 offen offset:2048  lds
  buffer_load_dwordx4 v55, s[12:15], s64 offen offset:3072  lds
  s_add_u32 s32, s32, 262144
  s_cmp_ge_u32 s32, s54
  s_cselect_b32 s32, s78, s32
  s_mov_b32 s40, 0
  s_ashr_i32 s41, s40, 1
  s_sub_u32 s41, s41, s53
  s_mul_i32 s41, s41, 2
  s_lshr_b32 s38, s41, 1
  s_add_u32 s43, s38, s30
  s_and_b32 s43, s43, 31
  s_lshl_b32 s43, s43, 12
  s_and_b32 s38, s41, 1
  s_lshl_b32 s38, s38, 11
  s_add_u32 s43, s43, s38
  s_bfe_u32 s42, s41, 0x10002
  s_lshl_b32 s42, s42, 14
  s_and_b32 s38, s41, 3
  s_lshl_b32 s38, s38, 11
  s_add_u32 s42, s42, s38
  s_add_u32 s42, s42, s39
  s_cmp_ge_u32 s41, 16
  s_cselect_b32 s42, 196608, s42
  s_cselect_b32 s43, 1073741824, s43
  s_mov_b32 s33, s77
  s_add_u32 s72, s32, 30720
  v_add_u32 v64, s36, v64
  v_add_u32 v65, s36, v65
  v_add_u32 v66, s36, v66
  v_add_u32 v67, s36, v67
  v_add_u32 v68, s36, v68
  v_add_u32 v69, s36, v69
  v_add_u32 v70, s36, v70
  v_add_u32 v71, s36, v71
L_qb:
  s_waitcnt lgkmcnt(0)
  s_waitcnt vmcnt(13)
  s_barrier
  v_mfma_f32_16x16x32_bf16 v[96:99], a[0:3], a[208:211], v[96:99]
  s_mov_b32 m0, s33
  ds_read_b128 a[228:231], v59 offset:0
  s_add_u32 s40, s40, 1
  v_mfma_f32_16x16x32_bf16 v[128:131], a[0:3], a[212:215], v[128:131]
  buffer_load_dwordx4 v54, s[12:15], s32 offen offset:0  lds
  v_mfma_f32_16x16x32_bf16 v[160:163], a[0:3], a[216:219], v[160:163]
  s_add_u32 s38, s40, 3
  ds_read_b128 a[232:235], v59 offset:2048
  s_lshr_b32 s38, s38, 1
  v_mfma_f32_16x16x32_bf16 v[192:195], a[0:3], a[220:223], v[192:195]
  buffer_load_dwordx4 v55, s[12:15], s32 offen offset:1024  lds
  v_mfma_f32_16x16x32_bf16 v[224:227], a[0:3], a[224:227], v[224:227]
  s_add_u32 s34, s38, s52
  ds_read_b128 a[236:239], v59 offset:4096
  s_sub_u32 s35, s34, 9
  v_mfma_f32_16x16x32_bf16 v[100:103], a[4:7], a[208:211], v[100:103]
  buffer_load_dwordx4 v54, s[12:15], s72 offen offset:2048  lds
  v_mfma_f32_16x16x32_bf16 v[132:135], a[4:7], a[212:215], v[132:135]
  s_cmp_lt_u32 s34, 9
  ds_read_b128 a[240:243], v59 offset:6144
  v_add_u32 v58, s37, v58
  v_mfma_f32_16x16x32_bf16 v[164:167], a[4:7], a[216:219], v[164:167]
  buffer_load_dwordx4 v55, s[12:15], s72 offen offset:3072  lds
  v_mfma_f32_16x16x32_bf16 v[196:199], a[4:7], a[220:223], v[196:199]
  s_mov_b32 m0, s42
  ds_read_b128 a[244:247], v59 offset:8192
  v_add_u32 v59, s37, v59
  v_mfma_f32_16x16x32_bf16 v[228:231], a[4:7], a[224:227], v[228:231]
  buffer_load_dwordx4 v56, s[68:71], s43 offen offset:0 nt lds
  v_mfma_f32_16x16x32_bf16 v[104:107], a[8:11], a[208:211], v[104:107]
  s_cselect_b32 s34, s34, s35
  ds_read_b64_tr_b16 a[32:33], v64
  s_lshl_b32 s34, s34, 7
  v_mfma_f32_16x16x32_bf16 v[136:139], a[8:11], a[212:215], v[136:139]
  buffer_load_dwordx4 v57, s[68:71], s43 offen offset:1024 nt lds
  v_mfma_f32_16x16x32_bf16 v[168:171], a[8:11], a[216:219], v[168:171]
  s_add_u32 s34, s34, s75
  ds_read_b64_tr_b16 a[34:35], v64 offset:2048
  v_add_u32 v64, s36, v64
  v_mfma_f32_16x16x32_bf16 v[200:203], a[8:11], a[220:223], v[200:203]
  buffer_load_dwordx4 v56, s[68:71], s43 offen offset:2048 nt lds
  v_mfma_f32_16x16x32_bf16 v[232:235], a[8:11], a[224:227], v[232:235]
  s_and_b32 s38, s38, 1
  ds_read_b64_tr_b16 a[36:37], v65
  s_mul_i32 s38, s38, 18432
  v_mfma_f32_16x16x32_bf16 v[108:111], a[12:15], a[208:211], v[108:111]
  buffer_load_dwordx4 v57, s[68:71], s43 offen offset:3072 nt lds
  v_mfma_f32_16x16x32_bf16 v[140:143], a[12:15], a[212:215], v[140:143]
  s_add_u32 s35, s74, s38
  ds_read_b64_tr_b16 a[38:39], v65 offset:2048
  v_add_u32 v65, s36, v65
  v_mfma_f32_16x16x32_bf16 v[172:175], a[12:15], a[216:219], v[172:175]
  s_cmp_ge_u32 s40, 15
  ds_read_b64_tr_b16 a[40:41], v66
  s_cselect_b32 s35, 196608, s35
  v_mfma_f32_16x16x32_bf16 v[204:207], a[12:15], a[220:223], v[204:207]
  s_cselect_b32 s34, 1073741824, s34
  ds_read_b64_tr_b16 a[42:43], v66 offset:2048
  v_add_u32 v66, s36, v66
  v_mfma_f32_16x16x32_bf16 v[236:239], a[12:15], a[224:227], v[236:239]
  s_add_u32 s46, s46, 8192
  ds_read_b64_tr_b16 a[44:45], v67
  s_cmp_eq_u32 s46, 24576
  v_mfma_f32_16x16x32_bf16 v[112:115], a[16:19], a[208:211], v[112:115]
  s_cselect_b32 s46, 0, s46
  ds_read_b64_tr_b16 a[46:47], v67 offset:2048
  v_add_u32 v67, s36, v67
  v_mfma_f32_16x16x32_bf16 v[144:147], a[16:19], a[212:215], v[144:147]
  s_cmp_eq_u32 s46, 8192
  ds_read_b64_tr_b16 a[48:49], v68
  s_cselect_b32 s62, s51, s48
  v_mfma_f32_16x16x32_bf16 v[176:179], a[16:19], a[216:219], v[176:179]
  s_add_u32 s63, s32, 262144
  ds_read_b64_tr_b16 a[50:51], v68 offset:2048
  v_add_u32 v68, s36, v68
  v_mfma_f32_16x16x32_bf16 v[208:211], a[16:19], a[220:223], v[208:211]
  s_cmp_ge_u32 s63, s54
  ds_read_b64_tr_b16 a[52:53], v69
  s_cselect_b32 s63, s78, s63
  v_mfma_f32_16x16x32_bf16 v[116:119], a[20:23], a[208:211], v[116:119]
  s_add_u32 s65, s46, s47
  ds_read_b64_tr_b16 a[54:55], v69 offset:2048
  v_add_u32 v69, s36, v69
  v_mfma_f32_16x16x32_bf16 v[148:151], a[20:23], a[212:215], v[148:151]
  s_cmp_ge_u32 s40, 15
  ds_read_b64_tr_b16 a[56:57], v70
  s_cselect_b32 s65, 196608, s65
  v_mfma_f32_16x16x32_bf16 v[180:183], a[20:23], a[216:219], v[180:183]
  s_cselect_b32 s63, 1073741824, s63
  ds_read_b64_tr_b16 a[58:59], v70 offset:2048
  v_add_u32 v70, s36, v70
  v_mfma_f32_16x16x32_bf16 v[212:215], a[20:23], a[220:223], v[212:215]
  s_add_u32 s64, s63, 30720
  ds_read_b64_tr_b16 a[60:61], v71
  s_mov_b32 s33, s65
  v_mfma_f32_16x16x32_bf16 v[120:123], a[24:27], a[208:211], v[120:123]
  s_sub_u32 s37, 0, s37
  ds_read_b64_tr_b16 a[62:63], v71 offset:2048
  v_add_u32 v71, s36, v71
  v_mfma_f32_16x16x32_bf16 v[152:155], a[24:27], a[212:215], v[152:155]
  v_mfma_f32_16x16x32_bf16 v[184:187], a[24:27], a[216:219], v[184:187]
  v_mfma_f32_16x16x32_bf16 v[216:219], a[24:27], a[220:223], v[216:219]
  v_mfma_f32_16x16x32_bf16 v[124:127], a[28:31], a[208:211], v[124:127]
  v_mfma_f32_16x16x32_bf16 v[156:159], a[28:31], a[212:215], v[156:159]
  v_mfma_f32_16x16x32_bf16 v[188:191], a[28:31], a[216:219], v[188:191]
  v_mfma_f32_16x16x32_bf16 v[220:223], a[28:31], a[220:223], v[220:223]
  s_waitcnt lgkmcnt(0)
  s_waitcnt vmcnt(8)
  s_barrier
  v_mfma_f32_16x16x32_bf16 v[96:99], a[32:35], a[228:231], v[96:99]
  s_mov_b32 m0, s35
  ds_read_b128 a[208:211], v58 offset:0
  v_mfma_f32_16x16x32_bf16 v[128:131], a[32:35], a[232:235], v[128:131]
  buffer_load_dwordx4 v53, s[8:11], s34 offen offset:0  lds
  v_mfma_f32_16x16x32_bf16 v[160:163], a[32:35], a[236:239], v[160:163]
  s_add_u32 s34, s34, 16384
  ds_read_b128 a[212:215], v58 offset:2048
  v_mfma_f32_16x16x32_bf16 v[192:195], a[32:35], a[240:243], v[192:195]
  buffer_load_dwordx4 v53, s[8:11], s34 offen offset:2048  lds
  v_mfma_f32_16x16x32_bf16 v[224:227], a[32:35], a[244:247], v[224:227]
  s_add_u32 s34, s34, 20480
  ds_read_b128 a[216:219], v58 offset:4096
  s_add_u32 m0, m0, 4096
  v_mfma_f32_16x16x32_bf16 v[100:103], a[36:39], a[228:231], v[100:103]
  buffer_load_dwordx4 v53, s[8:11], s34 offen offset:0  lds
  v_mfma_f32_16x16x32_bf16 v[132:135], a[36:39], a[232:235], v[132:135]
  s_add_u32 s34, s34, 16384
  ds_read_b128 a[220:223], v58 offset:6144
  v_mfma_f32_16x16x32_bf16 v[164:167], a[36:39], a[236:239], v[164:167]
  buffer_load_dwordx4 v53, s[8:11], s34 offen offset:2048  lds
  v_mfma_f32_16x16x32_bf16 v[196:199], a[36:39], a[240:243], v[196:199]
  s_add_u32 s34, s34, 20480
  ds_read_b128 a[224:227], v58 offset:8192
  s_add_u32 m0, m0, 4096
  v_mfma_f32_16x16x32_bf16 v[228:231], a[36:39], a[244:247], v[228:231]
  buffer_load_dwordx4 v53, s[8:11], s34 offen offset:0  lds
  v_mfma_f32_16x16x32_bf16 v[104:107], a[40:43], a[228:231], v[104:107]
  s_mov_b32 m0, s33
  ds_read_b64_tr_b16 a[0:1], v64
  s_add_u32 s40, s40, 1
  v_mfma_f32_16x16x32_bf16 v[136:139], a[40:43], a[232:235], v[136:139]
  s_ashr_i32 s41, s40, 1
  ds_read_b64_tr_b16 a[2:3], v64 offset:2048
  v_add_u32 v64, s62, v64
  v_mfma_f32_16x16x32_bf16 v[168:171], a[40:43], a[236:239], v[168:171]
  s_sub_u32 s41, s41, s53
  ds_read_b64_tr_b16 a[4:5], v65
  s_mul_i32 s41, s41, 2
  v_mfma_f32_16x16x32_bf16 v[200:203], a[40:43], a[240:243], v[200:203]
  buffer_load_dwordx4 v54, s[12:15], s63 offen offset:0  lds
  v_mfma_f32_16x16x32_bf16 v[232:235], a[40:43], a[244:247], v[232:235]
  s_lshr_b32 s38, s41, 1
  ds_read_b64_tr_b16 a[6:7], v65 offset:2048
  v_add_u32 v65, s62, v65
  v_mfma_f32_16x16x32_bf16 v[108:111], a[44:47], a[228:231], v[108:111]
  s_add_u32 s43, s38, s30
  ds_read_b64_tr_b16 a[8:9], v66
  s_and_b32 s43, s43, 31
  v_mfma_f32_16x16x32_bf16 v[140:143], a[44:47], a[232:235], v[140:143]
  s_lshl_b32 s43, s43, 12
  ds_read_b64_tr_b16 a[10:11], v66 offset:2048
  v_add_u32 v66, s62, v66
  v_mfma_f32_16x16x32_bf16 v[172:175], a[44:47], a[236:239], v[172:175]
  buffer_load_dwordx4 v55, s[12:15], s63 offen offset:1024  lds
  v_mfma_f32_16x16x32_bf16 v[204:207], a[44:47], a[240:243], v[204:207]
  s_and_b32 s38, s41, 1
  ds_read_b64_tr_b16 a[12:13], v67
  s_lshl_b32 s38, s38, 11
  v_mfma_f32_16x16x32_bf16 v[236:239], a[44:47], a[244:247], v[236:239]
  s_add_u32 s43, s43, s38
  ds_read_b64_tr_b16 a[14:15], v67 offset:2048
  v_add_u32 v67, s62, v67
  v_mfma_f32_16x16x32_bf16 v[112:115], a[48:51], a[228:231], v[112:115]
  s_bfe_u32 s42, s41, 0x10002
  ds_read_b64_tr_b16 a[16:17], v68
  s_lshl_b32 s42, s42, 14
  v_mfma_f32_16x16x32_bf16 v[144:147], a[48:51], a[232:235], v[144:147]
  s_and_b32 s38, s41, 3
  ds_read_b64_tr_b16 a[18:19], v68 offset:2048
  v_add_u32 v68, s62, v68
  v_mfma_f32_16x16x32_bf16 v[176:179], a[48:51], a[236:239], v[176:179]
  buffer_load_dwordx4 v54, s[12:15], s64 offen offset:2048  lds
  v_mfma_f32_16x16x32_bf16 v[208:211], a[48:51], a[240:243], v[208:211]
  s_lshl_b32 s38, s38, 11
  ds_read_b64_tr_b16 a[20:21], v69
  s_add_u32 s42, s42, s38
  v_mfma_f32_16x16x32_bf16 v[116:119], a[52:55], a[228:231], v[116:119]
  s_add_u32 s42, s42, s39
  ds_read_b64_tr_b16 a[22:23], v69 offset:2048
  v_add_u32 v69, s62, v69
  v_mfma_f32_16x16x32_bf16 v[148:151], a[52:55], a[232:235], v[148:151]
  s_cmp_ge_u32 s41, 16
  ds_read_b64_tr_b16 a[24:25], v70
  s_cselect_b32 s42, 196608, s42
  v_mfma_f32_16x16x32_bf16 v[180:183], a[52:55], a[236:239], v[180:183]
  s_cselect_b32 s43, 1073741824, s43
  ds_read_b64_tr_b16 a[26:27], v70 offset:2048
  v_add_u32 v70, s62, v70
  v_mfma_f32_16x16x32_bf16 v[212:215], a[52:55], a[240:243], v[212:215]
  buffer_load_dwordx4 v55, s[12:15], s64 offen offset:3072  lds
  v_mfma_f32_16x16x32_bf16 v[120:123], a[56:59], a[228:231], v[120:123]
  s_add_u32 s46, s46, 8192
  ds_read_b64_tr_b16 a[28:29], v71
  s_cmp_eq_u32 s46, 24576
  v_mfma_f32_16x16x32_bf16 v[152:155], a[56:59], a[232:235], v[152:155]
  s_cselect_b32 s46, 0, s46
  ds_read_b64_tr_b16 a[30:31], v71 offset:2048
  v_add_u32 v71, s62, v71
  v_mfma_f32_16x16x32_bf16 v[184:187], a[56:59], a[236:239], v[184:187]
  s_cmp_eq_u32 s46, 8192
  s_cselect_b32 s36, s51, s48
  s_add_u32 s32, s63, 262144
  v_mfma_f32_16x16x32_bf16 v[216:219], a[56:59], a[240:243], v[216:219]
  s_cmp_ge_u32 s32, s54
  s_cselect_b32 s32, s78, s32
  s_add_u32 s65, s46, s47
  v_mfma_f32_16x16x32_bf16 v[124:127], a[60:63], a[228:231], v[124:127]
  s_cmp_ge_u32 s40, 15
  s_cselect_b32 s65, 196608, s65
  s_cselect_b32 s32, 1073741824, s32
  v_mfma_f32_16x16x32_bf16 v[156:159], a[60:63], a[232:235], v[156:159]
  s_add_u32 s72, s32, 30720
  s_mov_b32 s33, s65
  v_mfma_f32_16x16x32_bf16 v[188:191], a[60:63], a[236:239], v[188:191]
  v_mfma_f32_16x16x32_bf16 v[220:223], a[60:63], a[240:243], v[220:223]
  s_cmp_eq_u32 s40, 18
  s_cbranch_scc1 L_qeb
  s_cmp_eq_u32 s40, 6
  s_cbranch_scc0 L_qb
  s_waitcnt lgkmcnt(0)
  s_waitcnt vmcnt(13)
  s_barrier
  v_mfma_f32_16x16x32_bf16 v[96:99], a[0:3], a[208:211], v[96:99]
  s_mov_b32 m0, s33
  ds_read_b128 a[228:231], v59 offset:0
  s_add_u32 s40, s40, 1
  v_mfma_f32_16x16x32_bf16 v[128:131], a[0:3], a[212:215], v[128:131]
  buffer_load_dwordx4 v54, s[12:15], s32 offen offset:0  lds
  v_mfma_f32_16x16x32_bf16 v[160:163], a[0:3], a[216:219], v[160:163]
  s_add_u32 s38, s40, 3
  ds_read_b128 a[232:235], v59 offset:2048
  s_lshr_b32 s38, s38, 1
  v_mfma_f32_16x16x32_bf16 v[192:195], a[0:3], a[220:223], v[192:195]
  buffer_load_dwordx4 v55, s[12:15], s32 offen offset:1024  lds
  v_mfma_f32_16x16x32_bf16 v[224:227], a[0:3], a[224:227], v[224:227]
  s_add_u32 s34, s38, s52
  ds_read_b128 a[236:239], v59 offset:4096
  s_sub_u32 s35, s34, 9
  v_mfma_f32_16x16x32_bf16 v[100:103], a[4:7], a[208:211], v[100:103]
  buffer_load_dwordx4 v54, s[12:15], s72 offen offset:2048  lds
  v_mfma_f32_16x16x32_bf16 v[132:135], a[4:7], a[212:215], v[132:135]
  s_cmp_lt_u32 s34, 9
  ds_read_b128 a[240:243], v59 offset:6144
  v_add_u32 v58, s37, v58
  v_mfma_f32_16x16x32_bf16 v[164:167], a[4:7], a[216:219], v[164:167]
  buffer_load_dwordx4 v55, s[12:15], s72 offen offset:3072  lds
  v_mfma_f32_16x16x32_bf16 v[196:199], a[4:7], a[220:223], v[196:199]
  s_mov_b32 m0, s42
  ds_read_b128 a[244:247], v59 offset:8192
  v_add_u32 v59, s37, v59
  v_mfma_f32_16x16x32_bf16 v[228:231], a[4:7], a[224:227], v[228:231]
  buffer_load_dwordx4 v56, s[68:71], s43 offen offset:0 nt lds
  v_mfma_f32_16x16x32_bf16 v[104:107], a[8:11], a[208:211], v[104:107]
  s_cselect_b32 s34, s34, s35
  ds_read_b64_tr_b16 a[32:33], v64
  s_lshl_b32 s34, s34, 7
  v_mfma_f32_16x16x32_bf16 v[136:139], a[8:11], a[212:215], v[136:139]
  buffer_load_dwordx4 v57, s[68:71], s43 offen offset:1024 nt lds
  v_mfma_f32_16x16x32_bf16 v[168:171], a[8:11], a[216:219], v[168:171]
  s_add_u32 s34, s34, s75
  ds_read_b64_tr_b16 a[34:35], v64 offset:2048
  v_add_u32 v64, s36, v64
  v_mfma_f32_16x16x32_bf16 v[200:203], a[8:11], a[220:223], v[200:203]
  buffer_load_dwordx4 v56, s[68:71], s43 offen offset:2048 nt lds
  v_mfma_f32_16x16x32_bf16 v[232:235], a[8:11], a[224:227], v[232:235]
  s_and_b32 s38, s38, 1
  ds_read_b64_tr_b16 a[36:37], v65
  s_mul_i32 s38, s38, 18432
  v_mfma_f32_16x16x32_bf16 v[108:111], a[12:15], a[208:211], v[108:111]
  buffer_load_dwordx4 v57, s[68:71], s43 offen offset:3072 nt lds
  v_mfma_f32_16x16x32_bf16 v[140:143], a[12:15], a[212:215], v[140:143]
  s_add_u32 s35, s74, s38
  ds_read_b64_tr_b16 a[38:39], v65 offset:2048
  v_add_u32 v65, s36, v65
  v_mfma_f32_16x16x32_bf16 v[172:175], a[12:15], a[216:219], v[172:175]
  s_cmp_ge_u32 s40, 15
  ds_read_b64_tr_b16 a[40:41], v66
  s_cselect_b32 s35, 196608, s35
  v_mfma_f32_16x16x32_bf16 v[204:207], a[12:15], a[220:223], v[204:207]
  s_cselect_b32 s34, 1073741824, s34
  ds_read_b64_tr_b16 a[42:43], v66 offset:2048
  v_add_u32 v66, s36, v66
  v_mfma_f32_16x16x32_bf16 v[236:239], a[12:15], a[224:227], v[236:239]
  s_add_u32 s46, s46, 8192
  ds_read_b64_tr_b16 a[44:45], v67
  s_cmp_eq_u32 s46, 24576
  v_mfma_f32_16x16x32_bf16 v[112:115], a[16:19], a[208:211], v[112:115]
  s_cselect_b32 s46, 0, s46
  ds_read_b64_tr_b16 a[46:47], v67 offset:2048
  v_add_u32 v67, s36, v67
  v_mfma_f32_16x16x32_bf16 v[144:147], a[16:19], a[212:215], v[144:147]
  s_cmp_eq_u32 s46, 8192
  ds_read_b64_tr_b16 a[48:49], v68
  s_cselect_b32 s62, s51, s48
  v_mfma_f32_16x16x32_bf16 v[176:179], a[16:19], a[216:219], v[176:179]
  s_add_u32 s63, s32, 262144
  ds_read_b64_tr_b16 a[50:51], v68 offset:2048
  v_add_u32 v68, s36, v68
  v_mfma_f32_16x16x32_bf16 v[208:211], a[16:19], a[220:223], v[208:211]
  s_cmp_ge_u32 s63, s54
  ds_read_b64_tr_b16 a[52:53], v69
  s_cselect_b32 s63, s78, s63
  v_mfma_f32_16x16x32_bf16 v[116:119], a[20:23], a[208:211], v[116:119]
  s_add_u32 s65, s46, s47
  ds_read_b64_tr_b16 a[54:55], v69 offset:2048
  v_add_u32 v69, s36, v69
  v_mfma_f32_16x16x32_bf16 v[148:151], a[20:23], a[212:215], v[148:151]
  s_cmp_ge_u32 s40, 15
  ds_read_b64_tr_b16 a[56:57], v70
  s_cselect_b32 s65, 196608, s65
  v_mfma_f32_16x16x32_bf16 v[180:183], a[20:23], a[216:219], v[180:183]
  s_cselect_b32 s63, 1073741824, s63
  ds_read_b64_tr_b16 a[58:59], v70 offset:2048
  v_add_u32 v70, s36, v70
  v_mfma_f32_16x16x32_bf16 v[212:215], a[20:23], a[220:223], v[212:215]
  s_add_u32 s64, s63, 30720
  ds_read_b64_tr_b16 a[60:61], v71
  s_mov_b32 s33, s65
  v_mfma_f32_16x16x32_bf16 v[120:123], a[24:27], a[208:211], v[120:123]
  s_sub_u32 s37, 0, s37
  ds_read_b64_tr_b16 a[62:63], v71 offset:2048
  v_add_u32 v71, s36, v71
  v_mfma_f32_16x16x32_bf16 v[152:155], a[24:27], a[212:215], v[152:155]
  v_mfma_f32_16x16x32_bf16 v[184:187], a[24:27], a[216:219], v[184:187]
  v_mfma_f32_16x16x32_bf16 v[216:219], a[24:27], a[220:223], v[216:219]
  v_mfma_f32_16x16x32_bf16 v[124:127], a[28:31], a[208:211], v[124:127]
  v_mfma_f32_16x16x32_bf16 v[156:159], a[28:31], a[212:215], v[156:159]
  v_mfma_f32_16x16x32_bf16 v[188:191], a[28:31], a[216:219], v[188:191]
  v_mfma_f32_16x16x32_bf16 v[220:223], a[28:31], a[220:223], v[220:223]
  s_waitcnt lgkmcnt(0)
  s_waitcnt vmcnt(8)
  s_barrier
  v_mfma_f32_16x16x32_bf16 v[96:99], a[32:35], a[228:231], v[96:99]
  s_mov_b32 m0, s35
  ds_read_b128 a[208:211], v58 offset:0
  ds_read_b128 a[212:215], v58 offset:2048
  v_mfma_f32_16x16x32_bf16 v[128:131], a[32:35], a[232:235], v[128:131]
  buffer_load_dwordx4 v53, s[8:11], s34 offen offset:0  lds
  v_mfma_f32_16x16x32_bf16 v[160:163], a[32:35], a[236:239], v[160:163]
  s_add_u32 s34, s34, 16384
  ds_read_b128 a[216:219], v58 offset:4096
  ds_read_b128 a[220:223], v58 offset:6144
  v_mfma_f32_16x16x32_bf16 v[192:195], a[32:35], a[240:243], v[192:195]
  buffer_load_dwordx4 v53, s[8:11], s34 offen offset:2048  lds
  v_mfma_f32_16x16x32_bf16 v[224:227], a[32:35], a[244:247], v[224:227]
  s_add_u32 s34, s34, 20480
  ds_read_b128 a[224:227], v58 offset:8192
  s_add_u32 m0, m0, 4096
  v_mfma_f32_16x16x32_bf16 v[100:103], a[36:39], a[228:231], v[100:103]
  buffer_load_dwordx4 v53, s[8:11], s34 offen offset:0  lds
  ds_read_b64_tr_b16 a[0:1], v64
  v_mfma_f32_16x16x32_bf16 v[132:135], a[36:39], a[232:235], v[132:135]
  s_add_u32 s34, s34, 16384
  ds_read_b64_tr_b16 a[2:3], v64 offset:2048
  ds_read_b64_tr_b16 a[4:5], v65
  v_mfma_f32_16x16x32_bf16 v[164:167], a[36:39], a[236:239], v[164:167]
  buffer_load_dwordx4 v53, s[8:11], s34 offen offset:2048  lds
  v_mfma_f32_16x16x32_bf16 v[196:199], a[36:39], a[240:243], v[196:199]
  s_add_u32 s34, s34, 20480
  ds_read_b64_tr_b16 a[6:7], v65 offset:2048
  s_add_u32 m0, m0, 4096
  v_mfma_f32_16x16x32_bf16 v[228:231], a[36:39], a[244:247], v[228:231]
  buffer_load_dwordx4 v53, s[8:11], s34 offen offset:0  lds
  ds_read_b64_tr_b16 a[8:9], v66
  v_mfma_f32_16x16x32_bf16 v[104:107], a[40:43], a[228:231], v[104:107]
  s_mov_b32 m0, s33
  ds_read_b64_tr_b16 a[10:11], v66 offset:2048
  ds_read_b64_tr_b16 a[12:13], v67
  v_mfma_f32_16x16x32_bf16 v[136:139], a[40:43], a[232:235], v[136:139]
  s_nop 0
  ds_read_b64_tr_b16 a[14:15], v67 offset:2048
  ds_read_b64_tr_b16 a[16:17], v68
  v_mfma_f32_16x16x32_bf16 v[168:171], a[40:43], a[236:239], v[168:171]
  s_nop 0
  ds_read_b64_tr_b16 a[18:19], v68 offset:2048
  ds_read_b64_tr_b16 a[20:21], v69
  v_mfma_f32_16x16x32_bf16 v[200:203], a[40:43], a[240:243], v[200:203]
  buffer_load_dwordx4 v54, s[12:15], s63 offen offset:0  lds
  v_mfma_f32_16x16x32_bf16 v[232:235], a[40:43], a[244:247], v[232:235]
  s_nop 0
  ds_read_b64_tr_b16 a[22:23], v69 offset:2048
  ds_read_b64_tr_b16 a[24:25], v70
  v_mfma_f32_16x16x32_bf16 v[108:111], a[44:47], a[228:231], v[108:111]
  s_nop 0
  ds_read_b64_tr_b16 a[26:27], v70 offset:2048
  ds_read_b64_tr_b16 a[28:29], v71
  v_mfma_f32_16x16x32_bf16 v[140:143], a[44:47], a[232:235], v[140:143]
  s_nop 0
  ds_read_b64_tr_b16 a[30:31], v71 offset:2048
  ds_read_b128 a[80:83], v60 offset:0
  v_mfma_f32_16x16x32_bf16 v[172:175], a[44:47], a[236:239], v[172:175]
  buffer_load_dwordx4 v55, s[12:15], s63 offen offset:1024  lds
  v_mfma_f32_16x16x32_bf16 v[204:207], a[44:47], a[240:243], v[204:207]
  s_nop 0
  ds_read_b128 a[84:87], v61 offset:0
  ds_read_b128 a[88:91], v62 offset:0
  v_mfma_f32_16x16x32_bf16 v[236:239], a[44:47], a[244:247], v[236:239]
  s_add_u32 s40, s40, 1
  ds_read_b128 a[92:95], v63 offset:0
  v_add_u32 v64, s62, v64
  v_mfma_f32_16x16x32_bf16 v[112:115], a[48:51], a[228:231], v[112:115]
  s_ashr_i32 s41, s40, 1
  ds_read_b128 a[96:99], v60 offset:4096
  v_add_u32 v65, s62, v65
  v_mfma_f32_16x16x32_bf16 v[144:147], a[48:51], a[232:235], v[144:147]
  s_sub_u32 s41, s41, s53
  ds_read_b128 a[100:103], v61 offset:4096
  v_add_u32 v66, s62, v66
  v_mfma_f32_16x16x32_bf16 v[176:179], a[48:51], a[236:239], v[176:179]
  buffer_load_dwordx4 v54, s[12:15], s64 offen offset:2048  lds
  v_mfma_f32_16x16x32_bf16 v[208:211], a[48:51], a[240:243], v[208:211]
  s_mul_i32 s41, s41, 2
  ds_read_b128 a[104:107], v62 offset:4096
  v_add_u32 v67, s62, v67
  v_mfma_f32_16x16x32_bf16 v[116:119], a[52:55], a[228:231], v[116:119]
  s_lshr_b32 s38, s41, 1
  ds_read_b128 a[108:111], v63 offset:4096
  v_add_u32 v68, s62, v68
  v_mfma_f32_16x16x32_bf16 v[148:151], a[52:55], a[232:235], v[148:151]
  s_add_u32 s43, s38, s30
  ds_read_b64_tr_b16 a[144:145], v8 offset:0
  v_add_u32 v69, s62, v69
  v_mfma_f32_16x16x32_bf16 v[180:183], a[52:55], a[236:239], v[180:183]
  s_and_b32 s43, s43, 31
  ds_read_b64_tr_b16 a[146:147], v8 offset:4096
  v_add_u32 v70, s62, v70
  v_mfma_f32_16x16x32_bf16 v[212:215], a[52:55], a[240:243], v[212:215]
  buffer_load_dwordx4 v55, s[12:15], s64 offen offset:3072  lds
  v_mfma_f32_16x16x32_bf16 v[120:123], a[56:59], a[228:231], v[120:123]
  s_lshl_b32 s43, s43, 12
  ds_read_b64_tr_b16 a[148:149], v9 offset:0
  v_add_u32 v71, s62, v71
  v_mfma_f32_16x16x32_bf16 v[152:155], a[56:59], a[232:235], v[152:155]
  s_and_b32 s38, s41, 1
  ds_read_b64_tr_b16 a[150:151], v9 offset:4096
  s_lshl_b32 s38, s38, 11
  v_mfma_f32_16x16x32_bf16 v[184:187], a[56:59], a[236:239], v[184:187]
  s_add_u32 s43, s43, s38
  s_bfe_u32 s42, s41, 0x10002
  s_lshl_b32 s42, s42, 14
  v_mfma_f32_16x16x32_bf16 v[216:219], a[56:59], a[240:243], v[216:219]
  s_and_b32 s38, s41, 3
  s_lshl_b32 s38, s38, 11
  s_add_u32 s42, s42, s38
  v_mfma_f32_16x16x32_bf16 v[124:127], a[60:63], a[228:231], v[124:127]
  s_add_u32 s42, s42, s39
  s_cmp_ge_u32 s41, 16
  s_cselect_b32 s42, 196608, s42
  v_mfma_f32_16x16x32_bf16 v[156:159], a[60:63], a[232:235], v[156:159]
  s_cselect_b32 s43, 1073741824, s43
  s_add_u32 s46, s46, 8192
  s_cmp_eq_u32 s46, 24576
  v_mfma_f32_16x16x32_bf16 v[188:191], a[60:63], a[236:239], v[188:191]
  s_cselect_b32 s46, 0, s46
  s_cmp_eq_u32 s46, 8192
  s_cselect_b32 s36, s51, s48
  v_mfma_f32_16x16x32_bf16 v[220:223], a[60:63], a[240:243], v[220:223]
  s_add_u32 s32, s63, 262144
  s_cmp_ge_u32 s32, s54
  s_cselect_b32 s32, s78, s32
  s_add_u32 s65, s46, s47
  s_cmp_ge_u32 s40, 15
  s_cselect_b32 s65, 196608, s65
  s_cselect_b32 s32, 1073741824, s32
  s_add_u32 s72, s32, 30720
  s_mov_b32 s33, s65
  s_waitcnt lgkmcnt(0)
  s_waitcnt vmcnt(13)
  s_barrier
  v_mfma_f32_16x16x32_bf16 v[96:99], a[0:3], a[208:211], v[96:99]
  s_mov_b32 m0, s33
  ds_read_b128 a[228:231], v59 offset:0
  ds_read_b128 a[232:235], v59 offset:2048
  v_mfma_f32_16x16x32_bf16 v[128:131], a[0:3], a[212:215], v[128:131]
  buffer_load_dwordx4 v54, s[12:15], s32 offen offset:0  lds
  v_mfma_f32_16x16x32_bf16 v[160:163], a[0:3], a[216:219], v[160:163]
  s_nop 0
  ds_read_b128 a[236:239], v59 offset:4096
  ds_read_b128 a[240:243], v59 offset:6144
  v_mfma_f32_16x16x32_bf16 v[192:195], a[0:3], a[220:223], v[192:195]
  buffer_load_dwordx4 v55, s[12:15], s32 offen offset:1024  lds
  v_mfma_f32_16x16x32_bf16 v[224:227], a[0:3], a[224:227], v[224:227]
  s_nop 0
  ds_read_b128 a[244:247], v59 offset:8192
  ds_read_b64_tr_b16 a[32:33], v64
  v_mfma_f32_16x16x32_bf16 v[100:103], a[4:7], a[208:211], v[100:103]
  buffer_load_dwordx4 v54, s[12:15], s72 offen offset:2048  lds
  v_mfma_f32_16x16x32_bf16 v[132:135], a[4:7], a[212:215], v[132:135]
  s_nop 0
  ds_read_b64_tr_b16 a[34:35], v64 offset:2048
  ds_read_b64_tr_b16 a[36:37], v65
  v_mfma_f32_16x16x32_bf16 v[164:167], a[4:7], a[216:219], v[164:167]
  buffer_load_dwordx4 v55, s[12:15], s72 offen offset:3072  lds
  v_mfma_f32_16x16x32_bf16 v[196:199], a[4:7], a[220:223], v[196:199]
  s_mov_b32 m0, s42
  ds_read_b64_tr_b16 a[38:39], v65 offset:2048
  ds_read_b64_tr_b16 a[40:41], v66
  v_mfma_f32_16x16x32_bf16 v[228:231], a[4:7], a[224:227], v[228:231]
  buffer_load_dwordx4 v56, s[68:71], s43 offen offset:0 nt lds
  v_mfma_f32_16x16x32_bf16 v[104:107], a[8:11], a[208:211], v[104:107]
  s_nop 0
  ds_read_b64_tr_b16 a[42:43], v66 offset:2048
  ds_read_b64_tr_b16 a[44:45], v67
  v_mfma_f32_16x16x32_bf16 v[136:139], a[8:11], a[212:215], v[136:139]
  buffer_load_dwordx4 v57, s[68:71], s43 offen offset:1024 nt lds
  v_mfma_f32_16x16x32_bf16 v[168:171], a[8:11], a[216:219], v[168:171]
  s_nop 0
  ds_read_b64_tr_b16 a[46:47], v67 offset:2048
  ds_read_b64_tr_b16 a[48:49], v68
  v_mfma_f32_16x16x32_bf16 v[200:203], a[8:11], a[220:223], v[200:203]
  buffer_load_dwordx4 v56, s[68:71], s43 offen offset:2048 nt lds
  v_mfma_f32_16x16x32_bf16 v[232:235], a[8:11], a[224:227], v[232:235]
  s_nop 0
  ds_read_b64_tr_b16 a[50:51], v68 offset:2048
  ds_read_b64_tr_b16 a[52:53], v69
  v_mfma_f32_16x16x32_bf16 v[108:111], a[12:15], a[208:211], v[108:111]
  buffer_load_dwordx4 v57, s[68:71], s43 offen offset:3072 nt lds
  v_mfma_f32_16x16x32_bf16 v[140:143], a[12:15], a[212:215], v[140:143]
  s_nop 0
  ds_read_b64_tr_b16 a[54:55], v69 offset:2048
  ds_read_b64_tr_b16 a[56:57], v70
  v_mfma_f32_16x16x32_bf16 v[172:175], a[12:15], a[216:219], v[172:175]
  s_nop 0
  ds_read_b64_tr_b16 a[58:59], v70 offset:2048
  ds_read_b64_tr_b16 a[60:61], v71
  v_mfma_f32_16x16x32_bf16 v[204:207], a[12:15], a[220:223], v[204:207]
  s_nop 0
  ds_read_b64_tr_b16 a[62:63], v71 offset:2048
  ds_read_b64_tr_b16 a[152:153], v10 offset:0
  v_mfma_f32_16x16x32_bf16 v[236:239], a[12:15], a[224:227], v[236:239]
  s_add_u32 s40, s40, 1
  ds_read_b64_tr_b16 a[154:155], v10 offset:4096
  v_add_u32 v58, s37, v58
  v_mfma_f32_16x16x32_bf16 v[112:115], a[16:19], a[208:211], v[112:115]
  s_add_u32 s38, s40, 3
  ds_read_b64_tr_b16 a[156:157], v11 offset:0
  v_add_u32 v59, s37, v59
  v_mfma_f32_16x16x32_bf16 v[144:147], a[16:19], a[212:215], v[144:147]
  s_lshr_b32 s38, s38, 1
  ds_read_b64_tr_b16 a[158:159], v11 offset:4096
  v_add_u32 v64, s36, v64
  v_mfma_f32_16x16x32_bf16 v[176:179], a[16:19], a[216:219], v[176:179]
  s_add_u32 s34, s38, s52
  ds_read_b64_tr_b16 a[160:161], v12 offset:0
  v_add_u32 v65, s36, v65
  v_mfma_f32_16x16x32_bf16 v[208:211], a[16:19], a[220:223], v[208:211]
  s_sub_u32 s35, s34, 9
  ds_read_b64_tr_b16 a[162:163], v12 offset:4096
  v_add_u32 v66, s36, v66
  v_mfma_f32_16x16x32_bf16 v[116:119], a[20:23], a[208:211], v[116:119]
  s_cmp_lt_u32 s34, 9
  ds_read_b64_tr_b16 a[164:165], v13 offset:0
  v_add_u32 v67, s36, v67
  v_mfma_f32_16x16x32_bf16 v[148:151], a[20:23], a[212:215], v[148:151]
  s_cselect_b32 s34, s34, s35
  ds_read_b64_tr_b16 a[166:167], v13 offset:4096
  v_add_u32 v68, s36, v68
  v_mfma_f32_16x16x32_bf16 v[180:183], a[20:23], a[216:219], v[180:183]
  s_lshl_b32 s34, s34, 7
  ds_read_b64_tr_b16 a[168:169], v14 offset:0
  v_add_u32 v69, s36, v69
  v_mfma_f32_16x16x32_bf16 v[212:215], a[20:23], a[220:223], v[212:215]
  s_add_u32 s34, s34, s75
  ds_read_b64_tr_b16 a[170:171], v14 offset:4096
  v_add_u32 v70, s36, v70
  v_mfma_f32_16x16x32_bf16 v[120:123], a[24:27], a[208:211], v[120:123]
  s_and_b32 s38, s38, 1
  ds_read_b64_tr_b16 a[172:173], v15 offset:0
  v_add_u32 v71, s36, v71
  v_mfma_f32_16x16x32_bf16 v[152:155], a[24:27], a[212:215], v[152:155]
  s_mul_i32 s38, s38, 18432
  ds_read_b64_tr_b16 a[174:175], v15 offset:4096
  s_add_u32 s35, s74, s38
  v_mfma_f32_16x16x32_bf16 v[184:187], a[24:27], a[216:219], v[184:187]
  s_cmp_ge_u32 s40, 15
  s_cselect_b32 s35, 196608, s35
  s_cselect_b32 s34, 1073741824, s34
  v_mfma_f32_16x16x32_bf16 v[216:219], a[24:27], a[220:223], v[216:219]
  s_add_u32 s46, s46, 8192
  s_cmp_eq_u32 s46, 24576
  s_cselect_b32 s46, 0, s46
  v_mfma_f32_16x16x32_bf16 v[124:127], a[28:31], a[208:211], v[124:127]
  s_cmp_eq_u32 s46, 8192
  s_cselect_b32 s62, s51, s48
  s_add_u32 s63, s32, 262144
  v_mfma_f32_16x16x32_bf16 v[156:159], a[28:31], a[212:215], v[156:159]
  s_cmp_ge_u32 s63, s54
  s_cselect_b32 s63, s78, s63
  s_add_u32 s65, s46, s47
  v_mfma_f32_16x16x32_bf16 v[188:191], a[28:31], a[216:219], v[188:191]
  s_cmp_ge_u32 s40, 15
  s_cselect_b32 s65, 196608, s65
  s_cselect_b32 s63, 1073741824, s63
  v_mfma_f32_16x16x32_bf16 v[220:223], a[28:31], a[220:223], v[220:223]
  s_add_u32 s64, s63, 30720
  s_mov_b32 s33, s65
  s_sub_u32 s37, 0, s37
  s_waitcnt lgkmcnt(0)
  s_waitcnt vmcnt(8)
  s_barrier
  v_mfma_f32_16x16x32_bf16 v[96:99], a[32:35], a[228:231], v[96:99]
  s_mov_b32 m0, s35
  ds_read_b128 a[208:211], v58 offset:0
  v_mfma_f32_16x16x32_bf16 v[128:131], a[32:35], a[232:235], v[128:131]
  buffer_load_dwordx4 v53, s[8:11], s34 offen offset:0  lds
  v_mfma_f32_16x16x32_bf16 v[160:163], a[32:35], a[236:239], v[160:163]
  s_add_u32 s34, s34, 16384
  ds_read_b128 a[212:215], v58 offset:2048
  v_mfma_f32_16x16x32_bf16 v[192:195], a[32:35], a[240:243], v[192:195]
  buffer_load_dwordx4 v53, s[8:11], s34 offen offset:2048  lds
  v_mfma_f32_16x16x32_bf16 v[224:227], a[32:35], a[244:247], v[224:227]
  s_add_u32 s34, s34, 20480
  ds_read_b128 a[216:219], v58 offset:4096
  s_add_u32 m0, m0, 4096
  v_mfma_f32_16x16x32_bf16 v[100:103], a[36:39], a[228:231], v[100:103]
  buffer_load_dwordx4 v53, s[8:11], s34 offen offset:0  lds
  v_mfma_f32_16x16x32_bf16 v[132:135], a[36:39], a[232:235], v[132:135]
  s_add_u32 s34, s34, 16384
  ds_read_b128 a[220:223], v58 offset:6144
  v_mfma_f32_16x16x32_bf16 v[164:167], a[36:39], a[236:239], v[164:167]
  buffer_load_dwordx4 v53, s[8:11], s34 offen offset:2048  lds
  v_mfma_f32_16x16x32_bf16 v[196:199], a[36:39], a[240:243], v[196:199]
  s_add_u32 s34, s34, 20480
  ds_read_b128 a[224:227], v58 offset:8192
  s_add_u32 m0, m0, 4096
  v_mfma_f32_16x16x32_bf16 v[228:231], a[36:39], a[244:247], v[228:231]
  buffer_load_dwordx4 v53, s[8:11], s34 offen offset:0  lds
  v_mfma_f32_16x16x32_bf16 v[104:107], a[40:43], a[228:231], v[104:107]
  s_mov_b32 m0, s33
  ds_read_b64_tr_b16 a[0:1], v64
  s_add_u32 s40, s40, 1
  v_mfma_f32_16x16x32_bf16 v[136:139], a[40:43], a[232:235], v[136:139]
  s_ashr_i32 s41, s40, 1
  ds_read_b64_tr_b16 a[2:3], v64 offset:2048
  v_add_u32 v64, s62, v64
  v_mfma_f32_16x16x32_bf16 v[168:171], a[40:43], a[236:239], v[168:171]
  s_sub_u32 s41, s41, s53
  ds_read_b64_tr_b16 a[4:5], v65
  s_mul_i32 s41, s41, 2
  v_mfma_f32_16x16x32_bf16 v[200:203], a[40:43], a[240:243], v[200:203]
  buffer_load_dwordx4 v54, s[12:15], s63 offen offset:0  lds
  v_mfma_f32_16x16x32_bf16 v[232:235], a[40:43], a[244:247], v[232:235]
  s_lshr_b32 s38, s41, 1
  ds_read_b64_tr_b16 a[6:7], v65 offset:2048
  v_add_u32 v65, s62, v65
  v_mfma_f32_16x16x32_bf16 v[108:111], a[44:47], a[228:231], v[108:111]
  s_add_u32 s43, s38, s30
  ds_read_b64_tr_b16 a[8:9], v66
  s_and_b32 s43, s43, 31
  v_mfma_f32_16x16x32_bf16 v[140:143], a[44:47], a[232:235], v[140:143]
  s_lshl_b32 s43, s43, 12
  ds_read_b64_tr_b16 a[10:11], v66 offset:2048
  v_add_u32 v66, s62, v66
  v_mfma_f32_16x16x32_bf16 v[172:175], a[44:47], a[236:239], v[172:175]
  buffer_load_dwordx4 v55, s[12:15], s63 offen offset:1024  lds
  v_mfma_f32_16x16x32_bf16 v[204:207], a[44:47], a[240:243], v[204:207]
  s_and_b32 s38, s41, 1
  ds_read_b64_tr_b16 a[12:13], v67
  s_lshl_b32 s38, s38, 11
  v_mfma_f32_16x16x32_bf16 v[236:239], a[44:47], a[244:247], v[236:239]
  s_add_u32 s43, s43, s38
  ds_read_b64_tr_b16 a[14:15], v67 offset:2048
  v_add_u32 v67, s62, v67
  v_mfma_f32_16x16x32_bf16 v[112:115], a[48:51], a[228:231], v[112:115]
  s_bfe_u32 s42, s41, 0x10002
  ds_read_b64_tr_b16 a[16:17], v68
  s_lshl_b32 s42, s42, 14
  v_mfma_f32_16x16x32_bf16 v[144:147], a[48:51], a[232:235], v[144:147]
  s_and_b32 s38, s41, 3
  ds_read_b64_tr_b16 a[18:19], v68 offset:2048
  v_add_u32 v68, s62, v68
  v_mfma_f32_16x16x32_bf16 v[176:179], a[48:51], a[236:239], v[176:179]
  buffer_load_dwordx4 v54, s[12:15], s64 offen offset:2048  lds
  v_mfma_f32_16x16x32_bf16 v[208:211], a[48:51], a[240:243], v[208:211]
  s_lshl_b32 s38, s38, 11
  ds_read_b64_tr_b16 a[20:21], v69
  s_add_u32 s42, s42, s38
  v_mfma_f32_16x16x32_bf16 v[116:119], a[52:55], a[228:231], v[116:119]
  s_add_u32 s42, s42, s39
  ds_read_b64_tr_b16 a[22:23], v69 offset:2048
  v_add_u32 v69, s62, v69
  v_mfma_f32_16x16x32_bf16 v[148:151], a[52:55], a[232:235], v[148:151]
  s_cmp_ge_u32 s41, 16
  ds_read_b64_tr_b16 a[24:25], v70
  s_cselect_b32 s42, 196608, s42
  v_mfma_f32_16x16x32_bf16 v[180:183], a[52:55], a[236:239], v[180:183]
  s_cselect_b32 s43, 1073741824, s43
  ds_read_b64_tr_b16 a[26:27], v70 offset:2048
  v_add_u32 v70, s62, v70
  v_mfma_f32_16x16x32_bf16 v[212:215], a[52:55], a[240:243], v[212:215]
  buffer_load_dwordx4 v55, s[12:15], s64 offen offset:3072  lds
  v_mfma_f32_16x16x32_bf16 v[120:123], a[56:59], a[228:231], v[120:123]
  s_add_u32 s46, s46, 8192
  ds_read_b64_tr_b16 a[28:29], v71
  s_cmp_eq_u32 s46, 24576
  v_mfma_f32_16x16x32_bf16 v[152:155], a[56:59], a[232:235], v[152:155]
  s_cselect_b32 s46, 0, s46
  ds_read_b64_tr_b16 a[30:31], v71 offset:2048
  v_add_u32 v71, s62, v71
  v_mfma_f32_16x16x32_bf16 v[184:187], a[56:59], a[236:239], v[184:187]
  s_cmp_eq_u32 s46, 8192
  s_cselect_b32 s36, s51, s48
  s_add_u32 s32, s63, 262144
  v_mfma_f32_16x16x32_bf16 v[216:219], a[56:59], a[240:243], v[216:219]
  s_cmp_ge_u32 s32, s54
  s_cselect_b32 s32, s78, s32
  s_add_u32 s65, s46, s47
  v_mfma_f32_16x16x32_bf16 v[124:127], a[60:63], a[228:231], v[124:127]
  s_cmp_ge_u32 s40, 15
  s_cselect_b32 s65, 196608, s65
  s_cselect_b32 s32, 1073741824, s32
  v_mfma_f32_16x16x32_bf16 v[156:159], a[60:63], a[232:235], v[156:159]
  s_add_u32 s72, s32, 30720
  s_mov_b32 s33, s65
  v_mfma_f32_16x16x32_bf16 v[188:191], a[60:63], a[236:239], v[188:191]
  v_mfma_f32_16x16x32_bf16 v[220:223], a[60:63], a[240:243], v[220:223]
  s_waitcnt lgkmcnt(0)
  s_waitcnt vmcnt(13)
  s_barrier
  v_mfma_f32_16x16x32_bf16 v[96:99], a[0:3], a[208:211], v[96:99]
  s_mov_b32 m0, s33
  ds_read_b128 a[228:231], v59 offset:0
  s_add_u32 s40, s40, 1
  v_mfma_f32_16x16x32_bf16 v[128:131], a[0:3], a[212:215], v[128:131]
  buffer_load_dwordx4 v54, s[12:15], s32 offen offset:0  lds
  v_mfma_f32_16x16x32_bf16 v[160:163], a[0:3], a[216:219], v[160:163]
  s_add_u32 s38, s40, 3
  ds_read_b128 a[232:235], v59 offset:2048
  s_lshr_b32 s38, s38, 1
  v_mfma_f32_16x16x32_bf16 v[192:195], a[0:3], a[220:223], v[192:195]
  buffer_load_dwordx4 v55, s[12:15], s32 offen offset:1024  lds
  v_mfma_f32_16x16x32_bf16 v[224:227], a[0:3], a[224:227], v[224:227]
  s_add_u32 s34, s38, s52
  ds_read_b128 a[236:239], v59 offset:4096
  s_sub_u32 s35, s34, 9
  v_mfma_f32_16x16x32_bf16 v[100:103], a[4:7], a[208:211], v[100:103]
  buffer_load_dwordx4 v54, s[12:15], s72 offen offset:2048  lds
  v_mfma_f32_16x16x32_bf16 v[132:135], a[4:7], a[212:215], v[132:135]
  s_cmp_lt_u32 s34, 9
  ds_read_b128 a[240:243], v59 offset:6144
  v_add_u32 v58, s37, v58
  v_mfma_f32_16x16x32_bf16 v[164:167], a[4:7], a[216:219], v[164:167]
  buffer_load_dwordx4 v55, s[12:15], s72 offen offset:3072  lds
  v_mfma_f32_16x16x32_bf16 v[196:199], a[4:7], a[220:223], v[196:199]
  s_mov_b32 m0, s42
  ds_read_b128 a[244:247], v59 offset:8192
  v_add_u32 v59, s37, v59
  v_mfma_f32_16x16x32_bf16 v[228:231], a[4:7], a[224:227], v[228:231]
  buffer_load_dwordx4 v56, s[68:71], s43 offen offset:0 nt lds
  v_mfma_f32_16x16x32_bf16 v[104:107], a[8:11], a[208:211], v[104:107]
  s_cselect_b32 s34, s34, s35
  ds_read_b64_tr_b16 a[32:33], v64
  s_lshl_b32 s34, s34, 7
  v_mfma_f32_16x16x32_bf16 v[136:139], a[8:11], a[212:215], v[136:139]
  buffer_load_dwordx4 v57, s[68:71], s43 offen offset:1024 nt lds
  v_mfma_f32_16x16x32_bf16 v[168:171], a[8:11], a[216:219], v[168:171]
  s_add_u32 s34, s34, s75
  ds_read_b64_tr_b16 a[34:35], v64 offset:2048
  v_add_u32 v64, s36, v64
  v_mfma_f32_16x16x32_bf16 v[200:203], a[8:11], a[220:223], v[200:203]
  buffer_load_dwordx4 v56, s[68:71], s43 offen offset:2048 nt lds
  v_mfma_f32_16x16x32_bf16 v[232:235], a[8:11], a[224:227], v[232:235]
  s_and_b32 s38, s38, 1
  ds_read_b64_tr_b16 a[36:37], v65
  s_mul_i32 s38, s38, 18432
  v_mfma_f32_16x16x32_bf16 v[108:111], a[12:15], a[208:211], v[108:111]
  buffer_load_dwordx4 v57, s[68:71], s43 offen offset:3072 nt lds
  v_mfma_f32_16x16x32_bf16 v[140:143], a[12:15], a[212:215], v[140:143]
  s_add_u32 s35, s74, s38
  ds_read_b64_tr_b16 a[38:39], v65 offset:2048
  v_add_u32 v65, s36, v65
  v_mfma_f32_16x16x32_bf16 v[172:175], a[12:15], a[216:219], v[172:175]
  s_cmp_ge_u32 s40, 15
  ds_read_b64_tr_b16 a[40:41], v66
  s_cselect_b32 s35, 196608, s35
  v_mfma_f32_16x16x32_bf16 v[204:207], a[12:15], a[220:223], v[204:207]
  s_cselect_b32 s34, 1073741824, s34
  ds_read_b64_tr_b16 a[42:43], v66 offset:2048
  v_add_u32 v66, s36, v66
  v_mfma_f32_16x16x32_bf16 v[236:239], a[12:15], a[224:227], v[236:239]
  s_add_u32 s46, s46, 8192
  ds_read_b64_tr_b16 a[44:45], v67
  s_cmp_eq_u32 s46, 24576
  v_mfma_f32_16x16x32_bf16 v[112:115], a[16:19], a[208:211], v[112:115]
  s_cselect_b32 s46, 0, s46
  ds_read_b64_tr_b16 a[46:47], v67 offset:2048
  v_add_u32 v67, s36, v67
  v_mfma_f32_16x16x32_bf16 v[144:147], a[16:19], a[212:215], v[144:147]
  s_cmp_eq_u32 s46, 8192
  ds_read_b64_tr_b16 a[48:49], v68
  s_cselect_b32 s62, s51, s48
  v_mfma_f32_16x16x32_bf16 v[176:179], a[16:19], a[216:219], v[176:179]
  s_add_u32 s63, s32, 262144
  ds_read_b64_tr_b16 a[50:51], v68 offset:2048
  v_add_u32 v68, s36, v68
  v_mfma_f32_16x16x32_bf16 v[208:211], a[16:19], a[220:223], v[208:211]
  s_cmp_ge_u32 s63, s54
  ds_read_b64_tr_b16 a[52:53], v69
  s_cselect_b32 s63, s78, s63
  v_mfma_f32_16x16x32_bf16 v[116:119], a[20:23], a[208:211], v[116:119]
  s_add_u32 s65, s46, s47
  ds_read_b64_tr_b16 a[54:55], v69 offset:2048
  v_add_u32 v69, s36, v69
  v_mfma_f32_16x16x32_bf16 v[148:151], a[20:23], a[212:215], v[148:151]
  s_cmp_ge_u32 s40, 15
  ds_read_b64_tr_b16 a[56:57], v70
  s_cselect_b32 s65, 196608, s65
  v_mfma_f32_16x16x32_bf16 v[180:183], a[20:23], a[216:219], v[180:183]
  s_cselect_b32 s63, 1073741824, s63
  ds_read_b64_tr_b16 a[58:59], v70 offset:2048
  v_add_u32 v70, s36, v70
  v_mfma_f32_16x16x32_bf16 v[212:215], a[20:23], a[220:223], v[212:215]
  s_add_u32 s64, s63, 30720
  ds_read_b64_tr_b16 a[60:61], v71
  s_mov_b32 s33, s65
  v_mfma_f32_16x16x32_bf16 v[120:123], a[24:27], a[208:211], v[120:123]
  s_sub_u32 s37, 0, s37
  ds_read_b64_tr_b16 a[62:63], v71 offset:2048
  v_add_u32 v71, s36, v71
  v_mfma_f32_16x16x32_bf16 v[152:155], a[24:27], a[212:215], v[152:155]
  v_mfma_f32_16x16x32_bf16 v[184:187], a[24:27], a[216:219], v[184:187]
  v_mfma_f32_16x16x32_bf16 v[216:219], a[24:27], a[220:223], v[216:219]
  v_mfma_f32_16x16x32_bf16 v[124:127], a[28:31], a[208:211], v[124:127]
  v_mfma_f32_16x16x32_bf16 v[156:159], a[28:31], a[212:215], v[156:159]
  v_mfma_f32_16x16x32_bf16 v[188:191], a[28:31], a[216:219], v[188:191]
  v_mfma_f32_16x16x32_bf16 v[220:223], a[28:31], a[220:223], v[220:223]
  s_waitcnt lgkmcnt(0)
  s_waitcnt vmcnt(8)
  s_barrier
  v_mfma_f32_16x16x32_bf16 v[96:99], a[32:35], a[228:231], v[96:99]
  s_mov_b32 m0, s35
  ds_read_b128 a[208:211], v58 offset:0
  ds_read_b128 a[212:215], v58 offset:2048
  v_mfma_f32_16x16x32_bf16 v[128:131], a[32:35], a[232:235], v[128:131]
  buffer_load_dwordx4 v53, s[8:11], s34 offen offset:0  lds
  v_mfma_f32_16x16x32_bf16 v[160:163], a[32:35], a[236:239], v[160:163]
  s_add_u32 s34, s34, 16384
  ds_read_b128 a[216:219], v58 offset:4096
  ds_read_b128 a[220:223], v58 offset:6144
  v_mfma_f32_16x16x32_bf16 v[192:195], a[32:35], a[240:243], v[192:195]
  buffer_load_dwordx4 v53, s[8:11], s34 offen offset:2048  lds
  v_mfma_f32_16x16x32_bf16 v[224:227], a[32:35], a[244:247], v[224:227]
  s_add_u32 s34, s34, 20480
  ds_read_b128 a[224:227], v58 offset:8192
  s_add_u32 m0, m0, 4096
  v_mfma_f32_16x16x32_bf16 v[100:103], a[36:39], a[228:231], v[100:103]
  buffer_load_dwordx4 v53, s[8:11], s34 offen offset:0  lds
  ds_read_b64_tr_b16 a[0:1], v64
  v_mfma_f32_16x16x32_bf16 v[132:135], a[36:39], a[232:235], v[132:135]
  s_add_u32 s34, s34, 16384
  ds_read_b64_tr_b16 a[2:3], v64 offset:2048
  ds_read_b64_tr_b16 a[4:5], v65
  v_mfma_f32_16x16x32_bf16 v[164:167], a[36:39], a[236:239], v[164:167]
  buffer_load_dwordx4 v53, s[8:11], s34 offen offset:2048  lds
  v_mfma_f32_16x16x32_bf16 v[196:199], a[36:39], a[240:243], v[196:199]
  s_add_u32 s34, s34, 20480
  ds_read_b64_tr_b16 a[6:7], v65 offset:2048
  s_add_u32 m0, m0, 4096
  v_mfma_f32_16x16x32_bf16 v[228:231], a[36:39], a[244:247], v[228:231]
  buffer_load_dwordx4 v53, s[8:11], s34 offen offset:0  lds
  ds_read_b64_tr_b16 a[8:9], v66
  v_mfma_f32_16x16x32_bf16 v[104:107], a[40:43], a[228:231], v[104:107]
  s_mov_b32 m0, s33
  ds_read_b64_tr_b16 a[10:11], v66 offset:2048
  ds_read_b64_tr_b16 a[12:13], v67
  v_mfma_f32_16x16x32_bf16 v[136:139], a[40:43], a[232:235], v[136:139]
  s_nop 0
  ds_read_b64_tr_b16 a[14:15], v67 offset:2048
  ds_read_b64_tr_b16 a[16:17], v68
  v_mfma_f32_16x16x32_bf16 v[168:171], a[40:43], a[236:239], v[168:171]
  s_nop 0
  ds_read_b64_tr_b16 a[18:19], v68 offset:2048
  ds_read_b64_tr_b16 a[20:21], v69
  v_mfma_f32_16x16x32_bf16 v[200:203], a[40:43], a[240:243], v[200:203]
  buffer_load_dwordx4 v54, s[12:15], s63 offen offset:0  lds
  v_mfma_f32_16x16x32_bf16 v[232:235], a[40:43], a[244:247], v[232:235]
  s_nop 0
  ds_read_b64_tr_b16 a[22:23], v69 offset:2048
  ds_read_b64_tr_b16 a[24:25], v70
  v_mfma_f32_16x16x32_bf16 v[108:111], a[44:47], a[228:231], v[108:111]
  s_nop 0
  ds_read_b64_tr_b16 a[26:27], v70 offset:2048
  ds_read_b64_tr_b16 a[28:29], v71
  v_mfma_f32_16x16x32_bf16 v[140:143], a[44:47], a[232:235], v[140:143]
  s_nop 0
  ds_read_b64_tr_b16 a[30:31], v71 offset:2048
  ds_read_b128 a[112:115], v60 offset:16384
  v_mfma_f32_16x16x32_bf16 v[172:175], a[44:47], a[236:239], v[172:175]
  buffer_load_dwordx4 v55, s[12:15], s63 offen offset:1024  lds
  v_mfma_f32_16x16x32_bf16 v[204:207], a[44:47], a[240:243], v[204:207]
  s_nop 0
  ds_read_b128 a[116:119], v61 offset:16384
  ds_read_b128 a[120:123], v62 offset:16384
  v_mfma_f32_16x16x32_bf16 v[236:239], a[44:47], a[244:247], v[236:239]
  s_add_u32 s40, s40, 1
  ds_read_b128 a[124:127], v63 offset:16384
  v_add_u32 v64, s62, v64
  v_mfma_f32_16x16x32_bf16 v[112:115], a[48:51], a[228:231], v[112:115]
  s_ashr_i32 s41, s40, 1
  ds_read_b128 a[128:131], v60 offset:20480
  v_add_u32 v65, s62, v65
  v_mfma_f32_16x16x32_bf16 v[144:147], a[48:51], a[232:235], v[144:147]
  s_sub_u32 s41, s41, s53
  ds_read_b128 a[132:135], v61 offset:20480
  v_add_u32 v66, s62, v66
  v_mfma_f32_16x16x32_bf16 v[176:179], a[48:51], a[236:239], v[176:179]
  buffer_load_dwordx4 v54, s[12:15], s64 offen offset:2048  lds
  v_mfma_f32_16x16x32_bf16 v[208:211], a[48:51], a[240:243], v[208:211]
  s_mul_i32 s41, s41, 2
  ds_read_b128 a[136:139], v62 offset:20480
  v_add_u32 v67, s62, v67
  v_mfma_f32_16x16x32_bf16 v[116:119], a[52:55], a[228:231], v[116:119]
  s_lshr_b32 s38, s41, 1
  ds_read_b128 a[140:143], v63 offset:20480
  v_add_u32 v68, s62, v68
  v_mfma_f32_16x16x32_bf16 v[148:151], a[52:55], a[232:235], v[148:151]
  s_add_u32 s43, s38, s30
  ds_read_b64_tr_b16 a[176:177], v8 offset:16384
  v_add_u32 v69, s62, v69
  v_mfma_f32_16x16x32_bf16 v[180:183], a[52:55], a[236:239], v[180:183]
  s_and_b32 s43, s43, 31
  ds_read_b64_tr_b16 a[178:179], v8 offset:20480
  v_add_u32 v70, s62, v70
  v_mfma_f32_16x16x32_bf16 v[212:215], a[52:55], a[240:243], v[212:215]
  buffer_load_dwordx4 v55, s[12:15], s64 offen offset:3072  lds
  v_mfma_f32_16x16x32_bf16 v[120:123], a[56:59], a[228:231], v[120:123]
  s_lshl_b32 s43, s43, 12
  ds_read_b64_tr_b16 a[180:181], v9 offset:16384
  v_add_u32 v71, s62, v71
  v_mfma_f32_16x16x32_bf16 v[152:155], a[56:59], a[232:235], v[152:155]
  s_and_b32 s38, s41, 1
  ds_read_b64_tr_b16 a[182:183], v9 offset:20480
  s_lshl_b32 s38, s38, 11
  v_mfma_f32_16x16x32_bf16 v[184:187], a[56:59], a[236:239], v[184:187]
  s_add_u32 s43, s43, s38
  s_bfe_u32 s42, s41, 0x10002
  s_lshl_b32 s42, s42, 14
  v_mfma_f32_16x16x32_bf16 v[216:219], a[56:59], a[240:243], v[216:219]
  s_and_b32 s38, s41, 3
  s_lshl_b32 s38, s38, 11
  s_add_u32 s42, s42, s38
  v_mfma_f32_16x16x32_bf16 v[124:127], a[60:63], a[228:231], v[124:127]
  s_add_u32 s42, s42, s39
  s_cmp_ge_u32 s41, 16
  s_cselect_b32 s42, 196608, s42
  v_mfma_f32_16x16x32_bf16 v[156:159], a[60:63], a[232:235], v[156:159]
  s_cselect_b32 s43, 1073741824, s43
  s_add_u32 s46, s46, 8192
  s_cmp_eq_u32 s46, 24576
  v_mfma_f32_16x16x32_bf16 v[188:191], a[60:63], a[236:239], v[188:191]
  s_cselect_b32 s46, 0, s46
  s_cmp_eq_u32 s46, 8192
  s_cselect_b32 s36, s51, s48
  v_mfma_f32_16x16x32_bf16 v[220:223], a[60:63], a[240:243], v[220:223]
  s_add_u32 s32, s63, 262144
  s_cmp_ge_u32 s32, s54
  s_cselect_b32 s32, s78, s32
  s_add_u32 s65, s46, s47
  s_cmp_ge_u32 s40, 15
  s_cselect_b32 s65, 196608, s65
  s_cselect_b32 s32, 1073741824, s32
  s_add_u32 s72, s32, 30720
  s_mov_b32 s33, s65
  s_waitcnt lgkmcnt(0)
  s_waitcnt vmcnt(13)
  s_barrier
  v_mfma_f32_16x16x32_bf16 v[96:99], a[0:3], a[208:211], v[96:99]
  s_mov_b32 m0, s33
  ds_read_b128 a[228:231], v59 offset:0
  ds_read_b128 a[232:235], v59 offset:2048
  v_mfma_f32_16x16x32_bf16 v[128:131], a[0:3], a[212:215], v[128:131]
  buffer_load_dwordx4 v54, s[12:15], s32 offen offset:0  lds
  v_mfma_f32_16x16x32_bf16 v[160:163], a[0:3], a[216:219], v[160:163]
  s_nop 0
  ds_read_b128 a[236:239], v59 offset:4096
  ds_read_b128 a[240:243], v59 offset:6144
  v_mfma_f32_16x16x32_bf16 v[192:195], a[0:3], a[220:223], v[192:195]
  buffer_load_dwordx4 v55, s[12:15], s32 offen offset:1024  lds
  v_mfma_f32_16x16x32_bf16 v[224:227], a[0:3], a[224:227], v[224:227]
  s_nop 0
  ds_read_b128 a[244:247], v59 offset:8192
  ds_read_b64_tr_b16 a[32:33], v64
  v_mfma_f32_16x16x32_bf16 v[100:103], a[4:7], a[208:211], v[100:103]
  buffer_load_dwordx4 v54, s[12:15], s72 offen offset:2048  lds
  v_mfma_f32_16x16x32_bf16 v[132:135], a[4:7], a[212:215], v[132:135]
  s_nop 0
  ds_read_b64_tr_b16 a[34:35], v64 offset:2048
  ds_read_b64_tr_b16 a[36:37], v65
  v_mfma_f32_16x16x32_bf16 v[164:167], a[4:7], a[216:219], v[164:167]
  buffer_load_dwordx4 v55, s[12:15], s72 offen offset:3072  lds
  v_mfma_f32_16x16x32_bf16 v[196:199], a[4:7], a[220:223], v[196:199]
  s_mov_b32 m0, s42
  ds_read_b64_tr_b16 a[38:39], v65 offset:2048
  ds_read_b64_tr_b16 a[40:41], v66
  v_mfma_f32_16x16x32_bf16 v[228:231], a[4:7], a[224:227], v[228:231]
  buffer_load_dwordx4 v56, s[68:71], s43 offen offset:0 nt lds
  v_mfma_f32_16x16x32_bf16 v[104:107], a[8:11], a[208:211], v[104:107]
  s_nop 0
  ds_read_b64_tr_b16 a[42:43], v66 offset:2048
  ds_read_b64_tr_b16 a[44:45], v67
  v_mfma_f32_16x16x32_bf16 v[136:139], a[8:11], a[212:215], v[136:139]
  buffer_load_dwordx4 v57, s[68:71], s43 offen offset:1024 nt lds
  v_mfma_f32_16x16x32_bf16 v[168:171], a[8:11], a[216:219], v[168:171]
  s_nop 0
  ds_read_b64_tr_b16 a[46:47], v67 offset:2048
  ds_read_b64_tr_b16 a[48:49], v68
  v_mfma_f32_16x16x32_bf16 v[200:203], a[8:11], a[220:223], v[200:203]
  buffer_load_dwordx4 v56, s[68:71], s43 offen offset:2048 nt lds
  v_mfma_f32_16x16x32_bf16 v[232:235], a[8:11], a[224:227], v[232:235]
  s_nop 0
  ds_read_b64_tr_b16 a[50:51], v68 offset:2048
  ds_read_b64_tr_b16 a[52:53], v69
  v_mfma_f32_16x16x32_bf16 v[108:111], a[12:15], a[208:211], v[108:111]
  buffer_load_dwordx4 v57, s[68:71], s43 offen offset:3072 nt lds
  v_mfma_f32_16x16x32_bf16 v[140:143], a[12:15], a[212:215], v[140:143]
  s_nop 0
  ds_read_b64_tr_b16 a[54:55], v69 offset:2048
  ds_read_b64_tr_b16 a[56:57], v70
  v_mfma_f32_16x16x32_bf16 v[172:175], a[12:15], a[216:219], v[172:175]
  s_nop 0
  ds_read_b64_tr_b16 a[58:59], v70 offset:2048
  ds_read_b64_tr_b16 a[60:61], v71
  v_mfma_f32_16x16x32_bf16 v[204:207], a[12:15], a[220:223], v[204:207]
  s_nop 0
  ds_read_b64_tr_b16 a[62:63], v71 offset:2048
  ds_read_b64_tr_b16 a[184:185], v10 offset:16384
  v_mfma_f32_16x16x32_bf16 v[236:239], a[12:15], a[224:227], v[236:239]
  s_add_u32 s40, s40, 1
  ds_read_b64_tr_b16 a[186:187], v10 offset:20480
  v_add_u32 v58, s37, v58
  v_mfma_f32_16x16x32_bf16 v[112:115], a[16:19], a[208:211], v[112:115]
  s_add_u32 s38, s40, 3
  ds_read_b64_tr_b16 a[188:189], v11 offset:16384
  v_add_u32 v59, s37, v59
  v_mfma_f32_16x16x32_bf16 v[144:147], a[16:19], a[212:215], v[144:147]
  s_lshr_b32 s38, s38, 1
  ds_read_b64_tr_b16 a[190:191], v11 offset:20480
  v_add_u32 v64, s36, v64
  v_mfma_f32_16x16x32_bf16 v[176:179], a[16:19], a[216:219], v[176:179]
  s_add_u32 s34, s38, s52
  ds_read_b64_tr_b16 a[192:193], v12 offset:16384
  v_add_u32 v65, s36, v65
  v_mfma_f32_16x16x32_bf16 v[208:211], a[16:19], a[220:223], v[208:211]
  s_sub_u32 s35, s34, 9
  ds_read_b64_tr_b16 a[194:195], v12 offset:20480
  v_add_u32 v66, s36, v66
  v_mfma_f32_16x16x32_bf16 v[116:119], a[20:23], a[208:211], v[116:119]
  s_cmp_lt_u32 s34, 9
  ds_read_b64_tr_b16 a[196:197], v13 offset:16384
  v_add_u32 v67, s36, v67
  v_mfma_f32_16x16x32_bf16 v[148:151], a[20:23], a[212:215], v[148:151]
  s_cselect_b32 s34, s34, s35
  ds_read_b64_tr_b16 a[198:199], v13 offset:20480
  v_add_u32 v68, s36, v68
  v_mfma_f32_16x16x32_bf16 v[180:183], a[20:23], a[216:219], v[180:183]
  s_lshl_b32 s34, s34, 7
  ds_read_b64_tr_b16 a[200:201], v14 offset:16384
  v_add_u32 v69, s36, v69
  v_mfma_f32_16x16x32_bf16 v[212:215], a[20:23], a[220:223], v[212:215]
  s_add_u32 s34, s34, s75
  ds_read_b64_tr_b16 a[202:203], v14 offset:20480
  v_add_u32 v70, s36, v70
  v_mfma_f32_16x16x32_bf16 v[120:123], a[24:27], a[208:211], v[120:123]
  s_and_b32 s38, s38, 1
  ds_read_b64_tr_b16 a[204:205], v15 offset:16384
  v_add_u32 v71, s36, v71
  v_mfma_f32_16x16x32_bf16 v[152:155], a[24:27], a[212:215], v[152:155]
  s_mul_i32 s38, s38, 18432
  ds_read_b64_tr_b16 a[206:207], v15 offset:20480
  s_add_u32 s35, s74, s38
  v_mfma_f32_16x16x32_bf16 v[184:187], a[24:27], a[216:219], v[184:187]
  s_cmp_ge_u32 s40, 15
  s_cselect_b32 s35, 196608, s35
  s_cselect_b32 s34, 1073741824, s34
  v_mfma_f32_16x16x32_bf16 v[216:219], a[24:27], a[220:223], v[216:219]
  s_add_u32 s46, s46, 8192
  s_cmp_eq_u32 s46, 24576
  s_cselect_b32 s46, 0, s46
  v_mfma_f32_16x16x32_bf16 v[124:127], a[28:31], a[208:211], v[124:127]
  s_cmp_eq_u32 s46, 8192
  s_cselect_b32 s62, s51, s48
  s_add_u32 s63, s32, 262144
  v_mfma_f32_16x16x32_bf16 v[156:159], a[28:31], a[212:215], v[156:159]
  s_cmp_ge_u32 s63, s54
  s_cselect_b32 s63, s78, s63
  s_add_u32 s65, s46, s47
  v_mfma_f32_16x16x32_bf16 v[188:191], a[28:31], a[216:219], v[188:191]
  s_cmp_ge_u32 s40, 15
  s_cselect_b32 s65, 196608, s65
  s_cselect_b32 s63, 1073741824, s63
  v_mfma_f32_16x16x32_bf16 v[220:223], a[28:31], a[220:223], v[220:223]
  s_add_u32 s64, s63, 30720
  s_mov_b32 s33, s65
  s_sub_u32 s37, 0, s37
  s_waitcnt lgkmcnt(0)
  s_waitcnt vmcnt(8)
  s_barrier
  v_mfma_f32_16x16x32_bf16 v[96:99], a[32:35], a[228:231], v[96:99]
  s_mov_b32 m0, s35
  ds_read_b128 a[208:211], v58 offset:0
  v_mfma_f32_16x16x32_bf16 v[128:131], a[32:35], a[232:235], v[128:131]
  buffer_load_dwordx4 v53, s[8:11], s34 offen offset:0  lds
  v_mfma_f32_16x16x32_bf16 v[160:163], a[32:35], a[236:239], v[160:163]
  s_add_u32 s34, s34, 16384
  ds_read_b128 a[212:215], v58 offset:2048
  v_mfma_f32_16x16x32_bf16 v[192:195], a[32:35], a[240:243], v[192:195]
  buffer_load_dwordx4 v53, s[8:11], s34 offen offset:2048  lds
  v_mfma_f32_16x16x32_bf16 v[224:227], a[32:35], a[244:247], v[224:227]
  s_add_u32 s34, s34, 20480
  ds_read_b128 a[216:219], v58 offset:4096
  s_add_u32 m0, m0, 4096
  v_mfma_f32_16x16x32_bf16 v[100:103], a[36:39], a[228:231], v[100:103]
  buffer_load_dwordx4 v53, s[8:11], s34 offen offset:0  lds
  v_mfma_f32_16x16x32_bf16 v[132:135], a[36:39], a[232:235], v[132:135]
  s_add_u32 s34, s34, 16384
  ds_read_b128 a[220:223], v58 offset:6144
  v_mfma_f32_16x16x32_bf16 v[164:167], a[36:39], a[236:239], v[164:167]
  buffer_load_dwordx4 v53, s[8:11], s34 offen offset:2048  lds
  v_mfma_f32_16x16x32_bf16 v[196:199], a[36:39], a[240:243], v[196:199]
  s_add_u32 s34, s34, 20480
  ds_read_b128 a[224:227], v58 offset:8192
  s_add_u32 m0, m0, 4096
  v_mfma_f32_16x16x32_bf16 v[228:231], a[36:39], a[244:247], v[228:231]
  buffer_load_dwordx4 v53, s[8:11], s34 offen offset:0  lds
  v_mfma_f32_16x16x32_bf16 v[104:107], a[40:43], a[228:231], v[104:107]
  s_mov_b32 m0, s33
  ds_read_b64_tr_b16 a[0:1], v64
  s_add_u32 s40, s40, 1
  v_mfma_f32_16x16x32_bf16 v[136:139], a[40:43], a[232:235], v[136:139]
  s_ashr_i32 s41, s40, 1
  ds_read_b64_tr_b16 a[2:3], v64 offset:2048
  v_add_u32 v64, s62, v64
  v_mfma_f32_16x16x32_bf16 v[168:171], a[40:43], a[236:239], v[168:171]
  s_sub_u32 s41, s41, s53
  ds_read_b64_tr_b16 a[4:5], v65
  s_mul_i32 s41, s41, 2
  v_mfma_f32_16x16x32_bf16 v[200:203], a[40:43], a[240:243], v[200:203]
  buffer_load_dwordx4 v54, s[12:15], s63 offen offset:0  lds
  v_mfma_f32_16x16x32_bf16 v[232:235], a[40:43], a[244:247], v[232:235]
  s_lshr_b32 s38, s41, 1
  ds_read_b64_tr_b16 a[6:7], v65 offset:2048
  v_add_u32 v65, s62, v65
  v_mfma_f32_16x16x32_bf16 v[108:111], a[44:47], a[228:231], v[108:111]
  s_add_u32 s43, s38, s30
  ds_read_b64_tr_b16 a[8:9], v66
  s_and_b32 s43, s43, 31
  v_mfma_f32_16x16x32_bf16 v[140:143], a[44:47], a[232:235], v[140:143]
  s_lshl_b32 s43, s43, 12
  ds_read_b64_tr_b16 a[10:11], v66 offset:2048
  v_add_u32 v66, s62, v66
  v_mfma_f32_16x16x32_bf16 v[172:175], a[44:47], a[236:239], v[172:175]
  buffer_load_dwordx4 v55, s[12:15], s63 offen offset:1024  lds
  v_mfma_f32_16x16x32_bf16 v[204:207], a[44:47], a[240:243], v[204:207]
  s_and_b32 s38, s41, 1
  ds_read_b64_tr_b16 a[12:13], v67
  s_lshl_b32 s38, s38, 11
  v_mfma_f32_16x16x32_bf16 v[236:239], a[44:47], a[244:247], v[236:239]
  s_add_u32 s43, s43, s38
  ds_read_b64_tr_b16 a[14:15], v67 offset:2048
  v_add_u32 v67, s62, v67
  v_mfma_f32_16x16x32_bf16 v[112:115], a[48:51], a[228:231], v[112:115]
  s_bfe_u32 s42, s41, 0x10002
  ds_read_b64_tr_b16 a[16:17], v68
  s_lshl_b32 s42, s42, 14
  v_mfma_f32_16x16x32_bf16 v[144:147], a[48:51], a[232:235], v[144:147]
  s_and_b32 s38, s41, 3
  ds_read_b64_tr_b16 a[18:19], v68 offset:2048
  v_add_u32 v68, s62, v68
  v_mfma_f32_16x16x32_bf16 v[176:179], a[48:51], a[236:239], v[176:179]
  buffer_load_dwordx4 v54, s[12:15], s64 offen offset:2048  lds
  v_mfma_f32_16x16x32_bf16 v[208:211], a[48:51], a[240:243], v[208:211]
  s_lshl_b32 s38, s38, 11
  ds_read_b64_tr_b16 a[20:21], v69
  s_add_u32 s42, s42, s38
  v_mfma_f32_16x16x32_bf16 v[116:119], a[52:55], a[228:231], v[116:119]
  s_add_u32 s42, s42, s39
  ds_read_b64_tr_b16 a[22:23], v69 offset:2048
  v_add_u32 v69, s62, v69
  v_mfma_f32_16x16x32_bf16 v[148:151], a[52:55], a[232:235], v[148:151]
  s_cmp_ge_u32 s41, 16
  ds_read_b64_tr_b16 a[24:25], v70
  s_cselect_b32 s42, 196608, s42
  v_mfma_f32_16x16x32_bf16 v[180:183], a[52:55], a[236:239], v[180:183]
  s_cselect_b32 s43, 1073741824, s43
  ds_read_b64_tr_b16 a[26:27], v70 offset:2048
  v_add_u32 v70, s62, v70
  v_mfma_f32_16x16x32_bf16 v[212:215], a[52:55], a[240:243], v[212:215]
  buffer_load_dwordx4 v55, s[12:15], s64 offen offset:3072  lds
  v_mfma_f32_16x16x32_bf16 v[120:123], a[56:59], a[228:231], v[120:123]
  s_add_u32 s46, s46, 8192
  ds_read_b64_tr_b16 a[28:29], v71
  s_cmp_eq_u32 s46, 24576
  v_mfma_f32_16x16x32_bf16 v[152:155], a[56:59], a[232:235], v[152:155]
  s_cselect_b32 s46, 0, s46
  ds_read_b64_tr_b16 a[30:31], v71 offset:2048
  v_add_u32 v71, s62, v71
  v_mfma_f32_16x16x32_bf16 v[184:187], a[56:59], a[236:239], v[184:187]
  s_cmp_eq_u32 s46, 8192
  s_cselect_b32 s36, s51, s48
  s_add_u32 s32, s63, 262144
  v_mfma_f32_16x16x32_bf16 v[216:219], a[56:59], a[240:243], v[216:219]
  s_cmp_ge_u32 s32, s54
  s_cselect_b32 s32, s78, s32
  s_add_u32 s65, s46, s47
  v_mfma_f32_16x16x32_bf16 v[124:127], a[60:63], a[228:231], v[124:127]
  s_cmp_ge_u32 s40, 15
  s_cselect_b32 s65, 196608, s65
  s_cselect_b32 s32, 1073741824, s32
  v_mfma_f32_16x16x32_bf16 v[156:159], a[60:63], a[232:235], v[156:159]
  s_add_u32 s72, s32, 30720
  s_mov_b32 s33, s65
  v_mfma_f32_16x16x32_bf16 v[188:191], a[60:63], a[236:239], v[188:191]
  v_mfma_f32_16x16x32_bf16 v[220:223], a[60:63], a[240:243], v[220:223]
  s_branch L_qb
L_qeb:
  s_waitcnt lgkmcnt(0)
  v_mov_b32 v64, v8
  v_mov_b32 v65, v9
  v_mov_b32 v66, v10
  v_mov_b32 v67, v11
  v_mov_b32 v68, v12
  v_mov_b32 v69, v13
  v_mov_b32 v70, v14
  v_mov_b32 v71, v15
  s_load_dword s31, s[6:7], 0
  s_lshr_b32 s38, s2, 5
  s_lshl_b32 s38, s38, 3
  s_add_u32 s38, s38, s3
  s_lshl_b32 s38, s38, 8
  s_add_u32 s38, s38, 50331648
  s_add_u32 s38, s38, 64
  s_load_dword s41, s[82:83], s38
  v_and_b32 v1, 63, v0
  s_lshl_b32 s38, s29, 11
  s_add_u32 s38, s38, 155648
  v_lshl_add_u32 v1, v1, 4, s38
  v_pk_mul_f32 v[96:97], v[96:97], s[48:49] op_sel:[0,1] op_sel_hi:[1,1]
  v_pk_mul_f32 v[98:99], v[98:99], s[48:49] op_sel:[0,1] op_sel_hi:[1,1]
  v_pk_mul_f32 v[100:101], v[100:101], s[48:49] op_sel:[0,1] op_sel_hi:[1,1]
  v_pk_mul_f32 v[102:103], v[102:103], s[48:49] op_sel:[0,1] op_sel_hi:[1,1]
  v_cvt_pk_bf16_f32 v4, v96, v97
  v_cvt_pk_bf16_f32 v5, v98, v99
  v_cvt_pk_bf16_f32 v6, v100, v101
  v_cvt_pk_bf16_f32 v7, v102, v103
  v_pk_mul_f32 v[104:105], v[104:105], s[48:49] op_sel:[0,1] op_sel_hi:[1,1]
  v_pk_mul_f32 v[106:107], v[106:107], s[48:49] op_sel:[0,1] op_sel_hi:[1,1]
  v_permlane32_swap_b32 v4, v6
  v_permlane32_swap_b32 v5, v7
  v_pk_mul_f32 v[108:109], v[108:109], s[48:49] op_sel:[0,1] op_sel_hi:[1,1]
  v_pk_mul_f32 v[110:111], v[110:111], s[48:49] op_sel:[0,1] op_sel_hi:[1,1]
  v_permlane16_swap_b32 v4, v6
  v_permlane16_swap_b32 v5, v7
  v_cvt_pk_bf16_f32 v20, v104, v105
  v_accvgpr_write_b32 a0, v4
  v_accvgpr_write_b32 a2, v6
  v_accvgpr_write_b32 a1, v5
  v_accvgpr_write_b32 a3, v7
  v_cvt_pk_bf16_f32 v21, v106, v107
  v_cvt_pk_bf16_f32 v22, v108, v109
  v_cvt_pk_bf16_f32 v23, v110, v111
  v_pk_mul_f32 v[112:113], v[112:113], s[48:49] op_sel:[0,1] op_sel_hi:[1,1]
  v_pk_mul_f32 v[114:115], v[114:115], s[48:49] op_sel:[0,1] op_sel_hi:[1,1]
  v_permlane32_swap_b32 v20, v22
  v_permlane32_swap_b32 v21, v23
  v_pk_mul_f32 v[116:117], v[116:117], s[48:49] op_sel:[0,1] op_sel_hi:[1,1]
  v_pk_mul_f32 v[118:119], v[118:119], s[48:49] op_sel:[0,1] op_sel_hi:[1,1]
  v_permlane16_swap_b32 v20, v22
  v_permlane16_swap_b32 v21, v23
  v_cvt_pk_bf16_f32 v4, v112, v113
  v_accvgpr_write_b32 a4, v20
  v_accvgpr_write_b32 a6, v22
  v_accvgpr_write_b32 a5, v21
  v_accvgpr_write_b32 a7, v23
  v_cvt_pk_bf16_f32 v5, v114, v115
  v_cvt_pk_bf16_f32 v6, v116, v117
  v_cvt_pk_bf16_f32 v7, v118, v119
  v_pk_mul_f32 v[120:121], v[120:121], s[48:49] op_sel:[0,1] op_sel_hi:[1,1]
  v_pk_mul_f32 v[122:123], v[122:123], s[48:49] op_sel:[0,1] op_sel_hi:[1,1]
  v_permlane32_swap_b32 v4, v6
  v_permlane32_swap_b32 v5, v7
  v_pk_mul_f32 v[124:125], v[124:125], s[48:49] op_sel:[0,1] op_sel_hi:[1,1]
  v_pk_mul_f32 v[126:127], v[126:127], s[48:49] op_sel:[0,1] op_sel_hi:[1,1]
  v_permlane16_swap_b32 v4, v6
  v_permlane16_swap_b32 v5, v7
  v_cvt_pk_bf16_f32 v20, v120, v121
  v_accvgpr_write_b32 a8, v4
  v_accvgpr_write_b32 a10, v6
  v_accvgpr_write_b32 a9, v5
  v_accvgpr_write_b32 a11, v7
  v_cvt_pk_bf16_f32 v21, v122, v123
  v_cvt_pk_bf16_f32 v22, v124, v125
  v_cvt_pk_bf16_f32 v23, v126, v127
  v_pk_mul_f32 v[128:129], v[128:129], s[48:49] op_sel:[0,1] op_sel_hi:[1,1]
  v_pk_mul_f32 v[130:131], v[130:131], s[48:49] op_sel:[0,1] op_sel_hi:[1,1]
  v_permlane32_swap_b32 v20, v22
  v_permlane32_swap_b32 v21, v23
  v_pk_mul_f32 v[132:133], v[132:133], s[48:49] op_sel:[0,1] op_sel_hi:[1,1]
  v_pk_mul_f32 v[134:135], v[134:135], s[48:49] op_sel:[0,1] op_sel_hi:[1,1]
  v_permlane16_swap_b32 v20, v22
  v_permlane16_swap_b32 v21, v23
  v_cvt_pk_bf16_f32 v4, v128, v129
  v_accvgpr_write_b32 a12, v20
  v_accvgpr_write_b32 a14, v22
  v_accvgpr_write_b32 a13, v21
  v_accvgpr_write_b32 a15, v23
  v_cvt_pk_bf16_f32 v5, v130, v131
  v_cvt_pk_bf16_f32 v6, v132, v133
  v_cvt_pk_bf16_f32 v7, v134, v135
  v_pk_mul_f32 v[136:137], v[136:137], s[48:49] op_sel:[0,1] op_sel_hi:[1,1]
  v_pk_mul_f32 v[138:139], v[138:139], s[48:49] op_sel:[0,1] op_sel_hi:[1,1]
  v_permlane32_swap_b32 v4, v6
  v_permlane32_swap_b32 v5, v7
  v_pk_mul_f32 v[140:141], v[140:141], s[48:49] op_sel:[0,1] op_sel_hi:[1,1]
  v_pk_mul_f32 v[142:143], v[142:143], s[48:49] op_sel:[0,1] op_sel_hi:[1,1]
  v_permlane16_swap_b32 v4, v6
  v_permlane16_swap_b32 v5, v7
  v_cvt_pk_bf16_f32 v20, v136, v137
  v_accvgpr_write_b32 a16, v4
  v_accvgpr_write_b32 a18, v6
  v_accvgpr_write_b32 a17, v5
  v_accvgpr_write_b32 a19, v7
  v_cvt_pk_bf16_f32 v21, v138, v139
  v_cvt_pk_bf16_f32 v22, v140, v141
  v_cvt_pk_bf16_f32 v23, v142, v143
  v_pk_mul_f32 v[144:145], v[144:145], s[48:49] op_sel:[0,1] op_sel_hi:[1,1]
  v_pk_mul_f32 v[146:147], v[146:147], s[48:49] op_sel:[0,1] op_sel_hi:[1,1]
  v_permlane32_swap_b32 v20, v22
  v_permlane32_swap_b32 v21, v23
  v_pk_mul_f32 v[148:149], v[148:149], s[48:49] op_sel:[0,1] op_sel_hi:[1,1]
  v_pk_mul_f32 v[150:151], v[150:151], s[48:49] op_sel:[0,1] op_sel_hi:[1,1]
  v_permlane16_swap_b32 v20, v22
  v_permlane16_swap_b32 v21, v23
  v_cvt_pk_bf16_f32 v4, v144, v145
  v_accvgpr_write_b32 a20, v20
  v_accvgpr_write_b32 a22, v22
  v_accvgpr_write_b32 a21, v21
  v_accvgpr_write_b32 a23, v23
  v_cvt_pk_bf16_f32 v5, v146, v147
  v_cvt_pk_bf16_f32 v6, v148, v149
  v_cvt_pk_bf16_f32 v7, v150, v151
  v_pk_mul_f32 v[152:153], v[152:153], s[48:49] op_sel:[0,1] op_sel_hi:[1,1]
  v_pk_mul_f32 v[154:155], v[154:155], s[48:49] op_sel:[0,1] op_sel_hi:[1,1]
  v_permlane32_swap_b32 v4, v6
  v_permlane32_swap_b32 v5, v7
  v_pk_mul_f32 v[156:157], v[156:157], s[48:49] op_sel:[0,1] op_sel_hi:[1,1]
  v_pk_mul_f32 v[158:159], v[158:159], s[48:49] op_sel:[0,1] op_sel_hi:[1,1]
  v_permlane16_swap_b32 v4, v6
  v_permlane16_swap_b32 v5, v7
  v_cvt_pk_bf16_f32 v20, v152, v153
  v_accvgpr_write_b32 a24, v4
  v_accvgpr_write_b32 a26, v6
  v_accvgpr_write_b32 a25, v5
  v_accvgpr_write_b32 a27, v7
  v_cvt_pk_bf16_f32 v21, v154, v155
  v_cvt_pk_bf16_f32 v22, v156, v157
  v_cvt_pk_bf16_f32 v23, v158, v159
  v_pk_mul_f32 v[160:161], v[160:161], s[48:49] op_sel:[0,1] op_sel_hi:[1,1]
  v_pk_mul_f32 v[162:163], v[162:163], s[48:49] op_sel:[0,1] op_sel_hi:[1,1]
  v_permlane32_swap_b32 v20, v22
  v_permlane32_swap_b32 v21, v23
  v_pk_mul_f32 v[164:165], v[164:165], s[48:49] op_sel:[0,1] op_sel_hi:[1,1]
  v_pk_mul_f32 v[166:167], v[166:167], s[48:49] op_sel:[0,1] op_sel_hi:[1,1]
  v_permlane16_swap_b32 v20, v22
  v_permlane16_swap_b32 v21, v23
  v_cvt_pk_bf16_f32 v4, v160, v161
  v_accvgpr_write_b32 a28, v20
  v_accvgpr_write_b32 a30, v22
  v_accvgpr_write_b32 a29, v21
  v_accvgpr_write_b32 a31, v23
  v_cvt_pk_bf16_f32 v5, v162, v163
  v_cvt_pk_bf16_f32 v6, v164, v165
  v_cvt_pk_bf16_f32 v7, v166, v167
  v_pk_mul_f32 v[168:169], v[168:169], s[48:49] op_sel:[0,1] op_sel_hi:[1,1]
  v_pk_mul_f32 v[170:171], v[170:171], s[48:49] op_sel:[0,1] op_sel_hi:[1,1]
  v_permlane32_swap_b32 v4, v6
  v_permlane32_swap_b32 v5, v7
  v_pk_mul_f32 v[172:173], v[172:173], s[48:49] op_sel:[0,1] op_sel_hi:[1,1]
  v_pk_mul_f32 v[174:175], v[174:175], s[48:49] op_sel:[0,1] op_sel_hi:[1,1]
  v_permlane16_swap_b32 v4, v6
  v_permlane16_swap_b32 v5, v7
  v_cvt_pk_bf16_f32 v20, v168, v169
  v_accvgpr_write_b32 a32, v4
  v_accvgpr_write_b32 a34, v6
  v_accvgpr_write_b32 a33, v5
  v_accvgpr_write_b32 a35, v7
  v_cvt_pk_bf16_f32 v21, v170, v171
  v_cvt_pk_bf16_f32 v22, v172, v173
  v_cvt_pk_bf16_f32 v23, v174, v175
  v_pk_mul_f32 v[176:177], v[176:177], s[48:49] op_sel:[0,1] op_sel_hi:[1,1]
  v_pk_mul_f32 v[178:179], v[178:179], s[48:49] op_sel:[0,1] op_sel_hi:[1,1]
  v_permlane32_swap_b32 v20, v22
  v_permlane32_swap_b32 v21, v23
  v_pk_mul_f32 v[180:181], v[180:181], s[48:49] op_sel:[0,1] op_sel_hi:[1,1]
  v_pk_mul_f32 v[182:183], v[182:183], s[48:49] op_sel:[0,1] op_sel_hi:[1,1]
  v_permlane16_swap_b32 v20, v22
  v_permlane16_swap_b32 v21, v23
  v_cvt_pk_bf16_f32 v4, v176, v177
  v_accvgpr_write_b32 a36, v20
  v_accvgpr_write_b32 a38, v22
  v_accvgpr_write_b32 a37, v21
  v_accvgpr_write_b32 a39, v23
  v_cvt_pk_bf16_f32 v5, v178, v179
  v_cvt_pk_bf16_f32 v6, v180, v181
  v_cvt_pk_bf16_f32 v7, v182, v183
  s_waitcnt lgkmcnt(0)
  s_waitcnt vmcnt(0)
  s_barrier
  ds_read_b128 a[72:75], v1 offset:0
  ds_read_b128 a[76:79], v1 offset:1024
  v_pk_mul_f32 v[184:185], v[184:185], s[48:49] op_sel:[0,1] op_sel_hi:[1,1]
  v_pk_mul_f32 v[186:187], v[186:187], s[48:49] op_sel:[0,1] op_sel_hi:[1,1]
  v_permlane32_swap_b32 v4, v6
  v_permlane32_swap_b32 v5, v7
  v_pk_mul_f32 v[188:189], v[188:189], s[48:49] op_sel:[0,1] op_sel_hi:[1,1]
  v_pk_mul_f32 v[190:191], v[190:191], s[48:49] op_sel:[0,1] op_sel_hi:[1,1]
  v_permlane16_swap_b32 v4, v6
  v_permlane16_swap_b32 v5, v7
  v_cvt_pk_bf16_f32 v20, v184, v185
  v_accvgpr_write_b32 a40, v4
  v_accvgpr_write_b32 a42, v6
  v_accvgpr_write_b32 a41, v5
  v_accvgpr_write_b32 a43, v7
  v_cvt_pk_bf16_f32 v21, v186, v187
  v_cvt_pk_bf16_f32 v22, v188, v189
  v_cvt_pk_bf16_f32 v23, v190, v191
  v_pk_mul_f32 v[192:193], v[192:193], s[48:49] op_sel:[0,1] op_sel_hi:[1,1]
  v_pk_mul_f32 v[194:195], v[194:195], s[48:49] op_sel:[0,1] op_sel_hi:[1,1]
  v_permlane32_swap_b32 v20, v22
  v_permlane32_swap_b32 v21, v23
  v_pk_mul_f32 v[196:197], v[196:197], s[48:49] op_sel:[0,1] op_sel_hi:[1,1]
  v_pk_mul_f32 v[198:199], v[198:199], s[48:49] op_sel:[0,1] op_sel_hi:[1,1]
  v_permlane16_swap_b32 v20, v22
  v_permlane16_swap_b32 v21, v23
  v_cvt_pk_bf16_f32 v4, v192, v193
  v_accvgpr_write_b32 a44, v20
  v_accvgpr_write_b32 a46, v22
  v_accvgpr_write_b32 a45, v21
  v_accvgpr_write_b32 a47, v23
  v_cvt_pk_bf16_f32 v5, v194, v195
  v_cvt_pk_bf16_f32 v6, v196, v197
  v_cvt_pk_bf16_f32 v7, v198, v199
  v_pk_mul_f32 v[200:201], v[200:201], s[48:49] op_sel:[0,1] op_sel_hi:[1,1]
  v_pk_mul_f32 v[202:203], v[202:203], s[48:49] op_sel:[0,1] op_sel_hi:[1,1]
  v_permlane32_swap_b32 v4, v6
  v_permlane32_swap_b32 v5, v7
  v_pk_mul_f32 v[204:205], v[204:205], s[48:49] op_sel:[0,1] op_sel_hi:[1,1]
  v_pk_mul_f32 v[206:207], v[206:207], s[48:49] op_sel:[0,1] op_sel_hi:[1,1]
  v_permlane16_swap_b32 v4, v6
  v_permlane16_swap_b32 v5, v7
  v_cvt_pk_bf16_f32 v20, v200, v201
  v_accvgpr_write_b32 a48, v4
  v_accvgpr_write_b32 a50, v6
  v_accvgpr_write_b32 a49, v5
  v_accvgpr_write_b32 a51, v7
  v_cvt_pk_bf16_f32 v21, v202, v203
  v_cvt_pk_bf16_f32 v22, v204, v205
  v_cvt_pk_bf16_f32 v23, v206, v207
  v_pk_mul_f32 v[208:209], v[208:209], s[48:49] op_sel:[0,1] op_sel_hi:[1,1]
  v_pk_mul_f32 v[210:211], v[210:211], s[48:49] op_sel:[0,1] op_sel_hi:[1,1]
  v_permlane32_swap_b32 v20, v22
  v_permlane32_swap_b32 v21, v23
  v_pk_mul_f32 v[212:213], v[212:213], s[48:49] op_sel:[0,1] op_sel_hi:[1,1]
  v_pk_mul_f32 v[214:215], v[214:215], s[48:49] op_sel:[0,1] op_sel_hi:[1,1]
  v_permlane16_swap_b32 v20, v22
  v_permlane16_swap_b32 v21, v23
  v_cvt_pk_bf16_f32 v4, v208, v209
  v_accvgpr_write_b32 a52, v20
  v_accvgpr_write_b32 a54, v22
  v_accvgpr_write_b32 a53, v21
  v_accvgpr_write_b32 a55, v23
  v_cvt_pk_bf16_f32 v5, v210, v211
  v_cvt_pk_bf16_f32 v6, v212, v213
  v_cvt_pk_bf16_f32 v7, v214, v215
  v_pk_mul_f32 v[216:217], v[216:217], s[48:49] op_sel:[0,1] op_sel_hi:[1,1]
  v_pk_mul_f32 v[218:219], v[218:219], s[48:49] op_sel:[0,1] op_sel_hi:[1,1]
  v_permlane32_swap_b32 v4, v6
  v_permlane32_swap_b32 v5, v7
  v_pk_mul_f32 v[220:221], v[220:221], s[48:49] op_sel:[0,1] op_sel_hi:[1,1]
  v_pk_mul_f32 v[222:223], v[222:223], s[48:49] op_sel:[0,1] op_sel_hi:[1,1]
  v_permlane16_swap_b32 v4, v6
  v_permlane16_swap_b32 v5, v7
  v_cvt_pk_bf16_f32 v20, v216, v217
  v_accvgpr_write_b32 a56, v4
  v_accvgpr_write_b32 a58, v6
  v_accvgpr_write_b32 a57, v5
  v_accvgpr_write_b32 a59, v7
  v_cvt_pk_bf16_f32 v21, v218, v219
  v_cvt_pk_bf16_f32 v22, v220, v221
  v_cvt_pk_bf16_f32 v23, v222, v223
  v_pk_mul_f32 v[224:225], v[224:225], s[48:49] op_sel:[0,1] op_sel_hi:[1,1]
  v_pk_mul_f32 v[226:227], v[226:227], s[48:49] op_sel:[0,1] op_sel_hi:[1,1]
  v_permlane32_swap_b32 v20, v22
  v_permlane32_swap_b32 v21, v23
  v_pk_mul_f32 v[228:229], v[228:229], s[48:49] op_sel:[0,1] op_sel_hi:[1,1]
  v_pk_mul_f32 v[230:231], v[230:231], s[48:49] op_sel:[0,1] op_sel_hi:[1,1]
  v_permlane16_swap_b32 v20, v22
  v_permlane16_swap_b32 v21, v23
  v_cvt_pk_bf16_f32 v4, v224, v225
  v_accvgpr_write_b32 a60, v20
  v_accvgpr_write_b32 a62, v22
  v_accvgpr_write_b32 a61, v21
  v_accvgpr_write_b32 a63, v23
  v_cvt_pk_bf16_f32 v5, v226, v227
  v_cvt_pk_bf16_f32 v6, v228, v229
  v_cvt_pk_bf16_f32 v7, v230, v231
  v_pk_mul_f32 v[232:233], v[232:233], s[48:49] op_sel:[0,1] op_sel_hi:[1,1]
  v_pk_mul_f32 v[234:235], v[234:235], s[48:49] op_sel:[0,1] op_sel_hi:[1,1]
  v_permlane32_swap_b32 v4, v6
  v_permlane32_swap_b32 v5, v7
  v_pk_mul_f32 v[236:237], v[236:237], s[48:49] op_sel:[0,1] op_sel_hi:[1,1]
  v_pk_mul_f32 v[238:239], v[238:239], s[48:49] op_sel:[0,1] op_sel_hi:[1,1]
  v_permlane16_swap_b32 v4, v6
  v_permlane16_swap_b32 v5, v7
  v_cvt_pk_bf16_f32 v20, v232, v233
  v_accvgpr_write_b32 a64, v4
  v_accvgpr_write_b32 a66, v6
  v_accvgpr_write_b32 a65, v5
  v_accvgpr_write_b32 a67, v7
  v_cvt_pk_bf16_f32 v21, v234, v235
  v_cvt_pk_bf16_f32 v22, v236, v237
  v_cvt_pk_bf16_f32 v23, v238, v239
  s_nop 0
  s_nop 0
  v_permlane32_swap_b32 v20, v22
  v_permlane32_swap_b32 v21, v23
  s_nop 0
  s_nop 0
  v_permlane16_swap_b32 v20, v22
  v_permlane16_swap_b32 v21, v23
  s_nop 0
  v_accvgpr_write_b32 a68, v20
  v_accvgpr_write_b32 a70, v22
  v_accvgpr_write_b32 a69, v21
  v_accvgpr_write_b32 a71, v23
  v_mov_b32 v72, 0
  v_mov_b32 v73, 0
  v_mov_b32 v74, 0
  v_mov_b32 v75, 0
  v_mov_b32 v76, 0
  v_mov_b32 v88, 0
  v_mov_b32 v89, 0
  v_mov_b32 v90, 0
  v_mov_b32 v91, 0
  v_mov_b32 v92, 0
  v_mov_b32 v93, 0
  v_mov_b32 v94, 0
  v_mov_b32 v95, 0
  s_mov_b32 s8, s24
  s_mov_b32 s9, s25
  s_mov_b32 s10, s26
  s_lshl_b32 s38, s4, 1
  s_add_u32 s38, s38, s29
  s_mul_i32 s38, s38, 36864
  s_sub_u32 s78, s50, s38
  s_mul_i32 s77, s29, 9216
  s_add_u32 s78, s78, s77
  s_movk_i32 s52, 18432
  s_lshl_b32 s79, s4, 2
  s_mov_b32 s36, 0x75eca864
  s_mov_b32 s37, 0xfdb9
  s_mov_b32 s34, 0
  s_mov_b32 s51, 0x53800000
  s_mov_b32 s40, 0
  s_mov_b32 s45, 0
  s_lshr_b32 s38, s2, 5
  s_lshl_b32 s38, s38, 3
  s_add_u32 s38, s38, s3
  s_lshl_b32 s38, s38, 8
  s_add_u32 s38, s38, 50331648
  s_add_u32 s38, s38, 64
  v_and_b32 v1, 7, v0
  s_lshr_b32 s80, s3, 2
  s_lshl_b32 s80, s80, 3
  s_add_u32 s80, s80, s5
  s_lshl_b32 s80, s80, 2
  s_add_u32 s80, s80, s4
  s_mul_i32 s80, s80, 41472
  s_add_u32 s80, s80, 33554432
  s_mov_b32 s81, 2654208
  v_mad_u32_u24 v2, v1, s81, v1
  v_sub_u32 v2, v2, v1
  v_add_u32 v2, s80, v2
  v_mov_b32 v3, s38
  v_cmp_gt_u32 vcc, 4, v1
  s_nop 1
  v_cndmask_b32 v2, v3, v2, vcc
  global_load_dword v50, v2, s[82:83] sc1
  s_cmp_eq_u32 s31, 0
  s_cbranch_scc1 L_tagb
L_tagbb:
  s_waitcnt lgkmcnt(0)
  v_mfma_f32_16x16x32_bf16 v[80:83], a[80:83], a[0:3], 0
  v_mfma_f32_16x16x32_bf16 v[80:83], a[84:87], a[4:7], v[80:83]
  v_mfma_f32_16x16x32_bf16 v[80:83], a[88:91], a[8:11], v[80:83]
  v_mfma_f32_16x16x32_bf16 v[80:83], a[92:95], a[12:15], v[80:83]
  v_mfma_f32_16x16x32_bf16 v[84:87], a[96:99], a[0:3], 0
  v_mfma_f32_16x16x32_bf16 v[84:87], a[100:103], a[4:7], v[84:87]
  v_mfma_f32_16x16x32_bf16 v[84:87], a[104:107], a[8:11], v[84:87]
  v_mfma_f32_16x16x32_bf16 v[84:87], a[108:111], a[12:15], v[84:87]
  s_nop 3
  v_exp_f32 v80, v80
  s_nop 0
  v_exp_f32 v81, v81
  s_nop 0
  v_exp_f32 v82, v82
  s_nop 0
  v_exp_f32 v83, v83
  s_nop 0
  v_exp_f32 v84, v84
  s_nop 0
  v_exp_f32 v85, v85
  s_nop 0
  v_exp_f32 v86, v86
  s_nop 0
  v_exp_f32 v87, v87
  v_mfma_f32_16x16x32_bf16 v[88:91], a[80:83], a[16:19], 0
  v_add_f32 v72, v72, v80
  v_mfma_f32_16x16x32_bf16 v[88:91], a[84:87], a[20:23], v[88:91]
  v_add_f32 v72, v72, v81
  v_add_f32 v72, v72, v82
  v_mfma_f32_16x16x32_bf16 v[88:91], a[88:91], a[24:27], v[88:91]
  v_add_f32 v72, v72, v83
  v_mfma_f32_16x16x32_bf16 v[88:91], a[92:95], a[28:31], v[88:91]
  v_cvt_pk_bf16_f32 v80, v80, v81
  v_cvt_pk_bf16_f32 v81, v82, v83
  v_mfma_f32_16x16x32_bf16 v[92:95], a[96:99], a[16:19], 0
  v_cvt_pk_bf16_f32 v82, v84, v85
  v_mfma_f32_16x16x32_bf16 v[92:95], a[100:103], a[20:23], v[92:95]
  v_cvt_pk_bf16_f32 v83, v86, v87
  v_add_f32 v72, v72, v84
  v_mfma_f32_16x16x32_bf16 v[92:95], a[104:107], a[24:27], v[92:95]
  v_add_f32 v72, v72, v85
  v_mfma_f32_16x16x32_bf16 v[92:95], a[108:111], a[28:31], v[92:95]
  v_add_f32 v72, v72, v86
  v_add_f32 v72, v72, v87
  v_mfma_f32_16x16x32_bf16 v[96:99], a[144:147], v[80:83], 0
  v_exp_f32 v88, v88
  v_mfma_f32_16x16x32_bf16 v[100:103], a[148:151], v[80:83], 0
  v_exp_f32 v89, v89
  v_mfma_f32_16x16x32_bf16 v[104:107], a[152:155], v[80:83], 0
  v_exp_f32 v90, v90
  v_mfma_f32_16x16x32_bf16 v[108:111], a[156:159], v[80:83], 0
  v_exp_f32 v91, v91
  v_mfma_f32_16x16x32_bf16 v[112:115], a[160:163], v[80:83], 0
  v_exp_f32 v92, v92
  v_mfma_f32_16x16x32_bf16 v[116:119], a[164:167], v[80:83], 0
  v_exp_f32 v93, v93
  v_mfma_f32_16x16x32_bf16 v[120:123], a[168:171], v[80:83], 0
  v_exp_f32 v94, v94
  v_mfma_f32_16x16x32_bf16 v[124:127], a[172:175], v[80:83], 0
  v_exp_f32 v95, v95
  v_mfma_f32_16x16x32_bf16 v[80:83], a[80:83], a[32:35], 0
  v_add_f32 v73, v73, v88
  v_mfma_f32_16x16x32_bf16 v[80:83], a[84:87], a[36:39], v[80:83]
  v_add_f32 v73, v73, v89
  v_add_f32 v73, v73, v90
  v_mfma_f32_16x16x32_bf16 v[80:83], a[88:91], a[40:43], v[80:83]
  v_add_f32 v73, v73, v91
  v_mfma_f32_16x16x32_bf16 v[80:83], a[92:95], a[44:47], v[80:83]
  v_cvt_pk_bf16_f32 v88, v88, v89
  v_cvt_pk_bf16_f32 v89, v90, v91
  v_mfma_f32_16x16x32_bf16 v[84:87], a[96:99], a[32:35], 0
  v_cvt_pk_bf16_f32 v90, v92, v93
  v_mfma_f32_16x16x32_bf16 v[84:87], a[100:103], a[36:39], v[84:87]
  v_cvt_pk_bf16_f32 v91, v94, v95
  v_add_f32 v73, v73, v92
  v_mfma_f32_16x16x32_bf16 v[84:87], a[104:107], a[40:43], v[84:87]
  v_add_f32 v73, v73, v93
  v_mfma_f32_16x16x32_bf16 v[84:87], a[108:111], a[44:47], v[84:87]
  v_add_f32 v73, v73, v94
  v_add_f32 v73, v73, v95
  v_mfma_f32_16x16x32_bf16 v[128:131], a[144:147], v[88:91], 0
  v_exp_f32 v80, v80
  v_mfma_f32_16x16x32_bf16 v[132:135], a[148:151], v[88:91], 0
  v_exp_f32 v81, v81
  v_mfma_f32_16x16x32_bf16 v[136:139], a[152:155], v[88:91], 0
  v_exp_f32 v82, v82
  v_mfma_f32_16x16x32_bf16 v[140:143], a[156:159], v[88:91], 0
  v_exp_f32 v83, v83
  v_mfma_f32_16x16x32_bf16 v[144:147], a[160:163], v[88:91], 0
  v_exp_f32 v84, v84
  v_mfma_f32_16x16x32_bf16 v[148:151], a[164:167], v[88:91], 0
  v_exp_f32 v85, v85
  v_mfma_f32_16x16x32_bf16 v[152:155], a[168:171], v[88:91], 0
  v_exp_f32 v86, v86
  v_mfma_f32_16x16x32_bf16 v[156:159], a[172:175], v[88:91], 0
  v_exp_f32 v87, v87
  v_mfma_f32_16x16x32_bf16 v[88:91], a[80:83], a[48:51], 0
  v_add_f32 v74, v74, v80
  v_mfma_f32_16x16x32_bf16 v[88:91], a[84:87], a[52:55], v[88:91]
  v_add_f32 v74, v74, v81
  v_add_f32 v74, v74, v82
  v_mfma_f32_16x16x32_bf16 v[88:91], a[88:91], a[56:59], v[88:91]
  v_add_f32 v74, v74, v83
  v_mfma_f32_16x16x32_bf16 v[88:91], a[92:95], a[60:63], v[88:91]
  v_cvt_pk_bf16_f32 v80, v80, v81
  v_cvt_pk_bf16_f32 v81, v82, v83
  v_mfma_f32_16x16x32_bf16 v[92:95], a[96:99], a[48:51], 0
  v_cvt_pk_bf16_f32 v82, v84, v85
  v_mfma_f32_16x16x32_bf16 v[92:95], a[100:103], a[52:55], v[92:95]
  v_cvt_pk_bf16_f32 v83, v86, v87
  v_add_f32 v74, v74, v84
  v_mfma_f32_16x16x32_bf16 v[92:95], a[104:107], a[56:59], v[92:95]
  v_add_f32 v74, v74, v85
  v_mfma_f32_16x16x32_bf16 v[92:95], a[108:111], a[60:63], v[92:95]
  v_add_f32 v74, v74, v86
  v_add_f32 v74, v74, v87
  v_mfma_f32_16x16x32_bf16 v[160:163], a[144:147], v[80:83], 0
  v_exp_f32 v88, v88
  v_mfma_f32_16x16x32_bf16 v[164:167], a[148:151], v[80:83], 0
  v_exp_f32 v89, v89
  v_mfma_f32_16x16x32_bf16 v[168:171], a[152:155], v[80:83], 0
  v_exp_f32 v90, v90
  v_mfma_f32_16x16x32_bf16 v[172:175], a[156:159], v[80:83], 0
  v_exp_f32 v91, v91
  v_mfma_f32_16x16x32_bf16 v[176:179], a[160:163], v[80:83], 0
  v_exp_f32 v92, v92
  v_mfma_f32_16x16x32_bf16 v[180:183], a[164:167], v[80:83], 0
  v_exp_f32 v93, v93
  v_mfma_f32_16x16x32_bf16 v[184:187], a[168:171], v[80:83], 0
  v_exp_f32 v94, v94
  v_mfma_f32_16x16x32_bf16 v[188:191], a[172:175], v[80:83], 0
  v_exp_f32 v95, v95
  v_mfma_f32_16x16x32_bf16 v[80:83], a[80:83], a[64:67], 0
  v_add_f32 v75, v75, v88
  v_mfma_f32_16x16x32_bf16 v[80:83], a[84:87], a[68:71], v[80:83]
  v_add_f32 v75, v75, v89
  v_add_f32 v75, v75, v90
  v_mfma_f32_16x16x32_bf16 v[80:83], a[88:91], a[72:75], v[80:83]
  v_add_f32 v75, v75, v91
  v_mfma_f32_16x16x32_bf16 v[80:83], a[92:95], a[76:79], v[80:83]
  v_cvt_pk_bf16_f32 v88, v88, v89
  v_cvt_pk_bf16_f32 v89, v90, v91
  v_mfma_f32_16x16x32_bf16 v[84:87], a[96:99], a[64:67], 0
  v_cvt_pk_bf16_f32 v90, v92, v93
  v_mfma_f32_16x16x32_bf16 v[84:87], a[100:103], a[68:71], v[84:87]
  v_cvt_pk_bf16_f32 v91, v94, v95
  v_add_f32 v75, v75, v92
  v_mfma_f32_16x16x32_bf16 v[84:87], a[104:107], a[72:75], v[84:87]
  v_add_f32 v75, v75, v93
  v_mfma_f32_16x16x32_bf16 v[84:87], a[108:111], a[76:79], v[84:87]
  v_add_f32 v75, v75, v94
  v_add_f32 v75, v75, v95
  v_mfma_f32_16x16x32_bf16 v[192:195], a[144:147], v[88:91], 0
  v_exp_f32 v80, v80
  v_mfma_f32_16x16x32_bf16 v[196:199], a[148:151], v[88:91], 0
  v_exp_f32 v81, v81
  v_mfma_f32_16x16x32_bf16 v[200:203], a[152:155], v[88:91], 0
  v_exp_f32 v82, v82
  v_mfma_f32_16x16x32_bf16 v[204:207], a[156:159], v[88:91], 0
  v_exp_f32 v83, v83
  v_mfma_f32_16x16x32_bf16 v[208:211], a[160:163], v[88:91], 0
  v_exp_f32 v84, v84
  v_mfma_f32_16x16x32_bf16 v[212:215], a[164:167], v[88:91], 0
  v_exp_f32 v85, v85
  v_mfma_f32_16x16x32_bf16 v[216:219], a[168:171], v[88:91], 0
  v_exp_f32 v86, v86
  v_mfma_f32_16x16x32_bf16 v[220:223], a[172:175], v[88:91], 0
  v_exp_f32 v87, v87
  s_waitcnt lgkmcnt(0)
  v_mfma_f32_16x16x32_bf16 v[88:91], a[112:115], a[0:3], 0
  ds_read_b128 a[80:83], v60 offset:0
  v_add_f32 v76, v76, v80
  v_mfma_f32_16x16x32_bf16 v[88:91], a[116:119], a[4:7], v[88:91]
  v_add_f32 v76, v76, v81
  v_add_f32 v76, v76, v82
  v_mfma_f32_16x16x32_bf16 v[88:91], a[120:123], a[8:11], v[88:91]
  ds_read_b128 a[84:87], v61 offset:0
  v_add_f32 v76, v76, v83
  v_mfma_f32_16x16x32_bf16 v[88:91], a[124:127], a[12:15], v[88:91]
  v_cvt_pk_bf16_f32 v80, v80, v81
  v_cvt_pk_bf16_f32 v81, v82, v83
  v_mfma_f32_16x16x32_bf16 v[92:95], a[128:131], a[0:3], 0
  ds_read_b128 a[88:91], v62 offset:0
  v_cvt_pk_bf16_f32 v82, v84, v85
  v_mfma_f32_16x16x32_bf16 v[92:95], a[132:135], a[4:7], v[92:95]
  v_cvt_pk_bf16_f32 v83, v86, v87
  v_add_f32 v76, v76, v84
  v_mfma_f32_16x16x32_bf16 v[92:95], a[136:139], a[8:11], v[92:95]
  ds_read_b128 a[92:95], v63 offset:0
  v_add_f32 v76, v76, v85
  v_mfma_f32_16x16x32_bf16 v[92:95], a[140:143], a[12:15], v[92:95]
  v_add_f32 v76, v76, v86
  v_add_f32 v76, v76, v87
  v_mfma_f32_16x16x32_bf16 v[224:227], a[144:147], v[80:83], 0
  v_exp_f32 v88, v88
  v_mfma_f32_16x16x32_bf16 v[228:231], a[148:151], v[80:83], 0
  ds_read_b128 a[96:99], v60 offset:4096
  v_exp_f32 v89, v89
  v_mfma_f32_16x16x32_bf16 v[232:235], a[152:155], v[80:83], 0
  v_exp_f32 v90, v90
  v_mfma_f32_16x16x32_bf16 v[236:239], a[156:159], v[80:83], 0
  v_exp_f32 v91, v91
  v_mfma_f32_16x16x32_bf16 v[240:243], a[160:163], v[80:83], 0
  v_exp_f32 v92, v92
  v_mfma_f32_16x16x32_bf16 v[244:247], a[164:167], v[80:83], 0
  v_exp_f32 v93, v93
  v_mfma_f32_16x16x32_bf16 v[248:251], a[168:171], v[80:83], 0
  v_exp_f32 v94, v94
  v_mfma_f32_16x16x32_bf16 v[252:255], a[172:175], v[80:83], 0
  v_exp_f32 v95, v95
  v_mfma_f32_16x16x32_bf16 v[80:83], a[112:115], a[16:19], 0
  ds_read_b128 a[100:103], v61 offset:4096
  v_add_f32 v72, v72, v88
  v_mfma_f32_16x16x32_bf16 v[80:83], a[116:119], a[20:23], v[80:83]
  v_add_f32 v72, v72, v89
  v_add_f32 v72, v72, v90
  v_mfma_f32_16x16x32_bf16 v[80:83], a[120:123], a[24:27], v[80:83]
  ds_read_b128 a[104:107], v62 offset:4096
  v_add_f32 v72, v72, v91
  v_mfma_f32_16x16x32_bf16 v[80:83], a[124:127], a[28:31], v[80:83]
  ds_read_b128 a[108:111], v63 offset:4096
  v_cvt_pk_bf16_f32 v88, v88, v89
  v_cvt_pk_bf16_f32 v89, v90, v91
  v_mfma_f32_16x16x32_bf16 v[84:87], a[128:131], a[16:19], 0
  ds_read_b64_tr_b16 a[144:145], v64 offset:0
  v_cvt_pk_bf16_f32 v90, v92, v93
  v_mfma_f32_16x16x32_bf16 v[84:87], a[132:135], a[20:23], v[84:87]
  v_cvt_pk_bf16_f32 v91, v94, v95
  v_add_f32 v72, v72, v92
  v_mfma_f32_16x16x32_bf16 v[84:87], a[136:139], a[24:27], v[84:87]
  ds_read_b64_tr_b16 a[146:147], v64 offset:4096
  v_add_f32 v72, v72, v93
  v_mfma_f32_16x16x32_bf16 v[84:87], a[140:143], a[28:31], v[84:87]
  v_add_f32 v72, v72, v94
  v_add_f32 v72, v72, v95
  v_mfma_f32_16x16x32_bf16 v[96:99], a[176:179], v[88:91], v[96:99]
  v_exp_f32 v80, v80
  v_mfma_f32_16x16x32_bf16 v[100:103], a[180:183], v[88:91], v[100:103]
  v_exp_f32 v81, v81
  v_mfma_f32_16x16x32_bf16 v[104:107], a[184:187], v[88:91], v[104:107]
  v_exp_f32 v82, v82
  v_mfma_f32_16x16x32_bf16 v[108:111], a[188:191], v[88:91], v[108:111]
  v_exp_f32 v83, v83
  v_mfma_f32_16x16x32_bf16 v[112:115], a[192:195], v[88:91], v[112:115]
  v_exp_f32 v84, v84
  v_mfma_f32_16x16x32_bf16 v[116:119], a[196:199], v[88:91], v[116:119]
  ds_read_b64_tr_b16 a[148:149], v65 offset:0
  v_exp_f32 v85, v85
  v_mfma_f32_16x16x32_bf16 v[120:123], a[200:203], v[88:91], v[120:123]
  v_exp_f32 v86, v86
  v_mfma_f32_16x16x32_bf16 v[124:127], a[204:207], v[88:91], v[124:127]
  v_exp_f32 v87, v87
  v_mfma_f32_16x16x32_bf16 v[88:91], a[112:115], a[32:35], 0
  ds_read_b64_tr_b16 a[150:151], v65 offset:4096
  v_add_f32 v73, v73, v80
  v_mfma_f32_16x16x32_bf16 v[88:91], a[116:119], a[36:39], v[88:91]
  v_add_f32 v73, v73, v81
  v_add_f32 v73, v73, v82
  v_mfma_f32_16x16x32_bf16 v[88:91], a[120:123], a[40:43], v[88:91]
  ds_read_b64_tr_b16 a[152:153], v66 offset:0
  v_add_f32 v73, v73, v83
  v_mfma_f32_16x16x32_bf16 v[88:91], a[124:127], a[44:47], v[88:91]
  v_cvt_pk_bf16_f32 v80, v80, v81
  v_cvt_pk_bf16_f32 v81, v82, v83
  v_mfma_f32_16x16x32_bf16 v[92:95], a[128:131], a[32:35], 0
  ds_read_b64_tr_b16 a[154:155], v66 offset:4096
  v_cvt_pk_bf16_f32 v82, v84, v85
  v_mfma_f32_16x16x32_bf16 v[92:95], a[132:135], a[36:39], v[92:95]
  v_cvt_pk_bf16_f32 v83, v86, v87
  v_add_f32 v73, v73, v84
  v_mfma_f32_16x16x32_bf16 v[92:95], a[136:139], a[40:43], v[92:95]
  ds_read_b64_tr_b16 a[156:157], v67 offset:0
  v_add_f32 v73, v73, v85
  v_mfma_f32_16x16x32_bf16 v[92:95], a[140:143], a[44:47], v[92:95]
  v_add_f32 v73, v73, v86
  v_add_f32 v73, v73, v87
  v_mfma_f32_16x16x32_bf16 v[128:131], a[176:179], v[80:83], v[128:131]
  v_exp_f32 v88, v88
  v_mfma_f32_16x16x32_bf16 v[132:135], a[180:183], v[80:83], v[132:135]
  v_exp_f32 v89, v89
  v_mfma_f32_16x16x32_bf16 v[136:139], a[184:187], v[80:83], v[136:139]
  ds_read_b64_tr_b16 a[158:159], v67 offset:4096
  v_exp_f32 v90, v90
  v_mfma_f32_16x16x32_bf16 v[140:143], a[188:191], v[80:83], v[140:143]
  v_exp_f32 v91, v91
  v_mfma_f32_16x16x32_bf16 v[144:147], a[192:195], v[80:83], v[144:147]
  v_exp_f32 v92, v92
  v_mfma_f32_16x16x32_bf16 v[148:151], a[196:199], v[80:83], v[148:151]
  v_exp_f32 v93, v93
  v_mfma_f32_16x16x32_bf16 v[152:155], a[200:203], v[80:83], v[152:155]
  v_exp_f32 v94, v94
  v_mfma_f32_16x16x32_bf16 v[156:159], a[204:207], v[80:83], v[156:159]
  v_exp_f32 v95, v95
  v_mfma_f32_16x16x32_bf16 v[80:83], a[112:115], a[48:51], 0
  ds_read_b64_tr_b16 a[160:161], v68 offset:0
  v_add_f32 v74, v74, v88
  v_mfma_f32_16x16x32_bf16 v[80:83], a[116:119], a[52:55], v[80:83]
  v_add_f32 v74, v74, v89
  v_add_f32 v74, v74, v90
  v_mfma_f32_16x16x32_bf16 v[80:83], a[120:123], a[56:59], v[80:83]
  ds_read_b64_tr_b16 a[162:163], v68 offset:4096
  v_add_f32 v74, v74, v91
  v_mfma_f32_16x16x32_bf16 v[80:83], a[124:127], a[60:63], v[80:83]
  v_cvt_pk_bf16_f32 v88, v88, v89
  v_cvt_pk_bf16_f32 v89, v90, v91
  v_mfma_f32_16x16x32_bf16 v[84:87], a[128:131], a[48:51], 0
  ds_read_b64_tr_b16 a[164:165], v69 offset:0
  v_cvt_pk_bf16_f32 v90, v92, v93
  v_mfma_f32_16x16x32_bf16 v[84:87], a[132:135], a[52:55], v[84:87]
  ds_read_b64_tr_b16 a[166:167], v69 offset:4096
  v_cvt_pk_bf16_f32 v91, v94, v95
  v_add_f32 v74, v74, v92
  v_mfma_f32_16x16x32_bf16 v[84:87], a[136:139], a[56:59], v[84:87]
  ds_read_b64_tr_b16 a[168:169], v70 offset:0
  v_add_f32 v74, v74, v93
  v_mfma_f32_16x16x32_bf16 v[84:87], a[140:143], a[60:63], v[84:87]
  v_add_f32 v74, v74, v94
  v_add_f32 v74, v74, v95
  v_mfma_f32_16x16x32_bf16 v[160:163], a[176:179], v[88:91], v[160:163]
  v_exp_f32 v80, v80
  v_mfma_f32_16x16x32_bf16 v[164:167], a[180:183], v[88:91], v[164:167]
  v_exp_f32 v81, v81
  v_mfma_f32_16x16x32_bf16 v[168:171], a[184:187], v[88:91], v[168:171]
  v_exp_f32 v82, v82
  v_mfma_f32_16x16x32_bf16 v[172:175], a[188:191], v[88:91], v[172:175]
  v_exp_f32 v83, v83
  v_mfma_f32_16x16x32_bf16 v[176:179], a[192:195], v[88:91], v[176:179]
  v_exp_f32 v84, v84
  v_mfma_f32_16x16x32_bf16 v[180:183], a[196:199], v[88:91], v[180:183]
  v_exp_f32 v85, v85
  v_mfma_f32_16x16x32_bf16 v[184:187], a[200:203], v[88:91], v[184:187]
  ds_read_b64_tr_b16 a[170:171], v70 offset:4096
  v_exp_f32 v86, v86
  v_mfma_f32_16x16x32_bf16 v[188:191], a[204:207], v[88:91], v[188:191]
  v_exp_f32 v87, v87
  v_mfma_f32_16x16x32_bf16 v[88:91], a[112:115], a[64:67], 0
  ds_read_b64_tr_b16 a[172:173], v71 offset:0
  v_add_f32 v75, v75, v80
  v_mfma_f32_16x16x32_bf16 v[88:91], a[116:119], a[68:71], v[88:91]
  v_add_f32 v75, v75, v81
  v_add_f32 v75, v75, v82
  v_mfma_f32_16x16x32_bf16 v[88:91], a[120:123], a[72:75], v[88:91]
  ds_read_b64_tr_b16 a[174:175], v71 offset:4096
  v_add_f32 v75, v75, v83
  v_mfma_f32_16x16x32_bf16 v[88:91], a[124:127], a[76:79], v[88:91]
  v_cvt_pk_bf16_f32 v80, v80, v81
  v_cvt_pk_bf16_f32 v81, v82, v83
  v_mfma_f32_16x16x32_bf16 v[92:95], a[128:131], a[64:67], 0
  v_cvt_pk_bf16_f32 v82, v84, v85
  v_mfma_f32_16x16x32_bf16 v[92:95], a[132:135], a[68:71], v[92:95]
  v_cvt_pk_bf16_f32 v83, v86, v87
  v_add_f32 v75, v75, v84
  v_mfma_f32_16x16x32_bf16 v[92:95], a[136:139], a[72:75], v[92:95]
  v_add_f32 v75, v75, v85
  v_mfma_f32_16x16x32_bf16 v[92:95], a[140:143], a[76:79], v[92:95]
  v_add_f32 v75, v75, v86
  v_add_f32 v75, v75, v87
  v_mfma_f32_16x16x32_bf16 v[192:195], a[176:179], v[80:83], v[192:195]
  v_exp_f32 v88, v88
  v_mfma_f32_16x16x32_bf16 v[196:199], a[180:183], v[80:83], v[196:199]
  v_exp_f32 v89, v89
  v_mfma_f32_16x16x32_bf16 v[200:203], a[184:187], v[80:83], v[200:203]
  v_exp_f32 v90, v90
  v_mfma_f32_16x16x32_bf16 v[204:207], a[188:191], v[80:83], v[204:207]
  v_exp_f32 v91, v91
  v_mfma_f32_16x16x32_bf16 v[208:211], a[192:195], v[80:83], v[208:211]
  v_exp_f32 v92, v92
  v_mfma_f32_16x16x32_bf16 v[212:215], a[196:199], v[80:83], v[212:215]
  v_exp_f32 v93, v93
  v_mfma_f32_16x16x32_bf16 v[216:219], a[200:203], v[80:83], v[216:219]
  v_exp_f32 v94, v94
  v_mfma_f32_16x16x32_bf16 v[220:223], a[204:207], v[80:83], v[220:223]
  v_exp_f32 v95, v95
  s_mov_b32 s40, 2
L_ab:
  s_waitcnt lgkmcnt(0)
  s_barrier
  v_mfma_f32_16x16x32_bf16 v[80:83], a[80:83], a[0:3], 0
  ds_read_b128 a[112:115], v60 offset:16384
  v_add_f32 v76, v76, v88
  v_mfma_f32_16x16x32_bf16 v[80:83], a[84:87], a[4:7], v[80:83]
  v_add_f32 v76, v76, v89
  v_add_f32 v76, v76, v90
  v_mfma_f32_16x16x32_bf16 v[80:83], a[88:91], a[8:11], v[80:83]
  ds_read_b128 a[116:119], v61 offset:16384
  v_add_f32 v76, v76, v91
  v_mfma_f32_16x16x32_bf16 v[80:83], a[92:95], a[12:15], v[80:83]
  v_cvt_pk_bf16_f32 v88, v88, v89
  v_cvt_pk_bf16_f32 v89, v90, v91
  v_mfma_f32_16x16x32_bf16 v[84:87], a[96:99], a[0:3], 0
  ds_read_b128 a[120:123], v62 offset:16384
  v_cvt_pk_bf16_f32 v90, v92, v93
  v_mfma_f32_16x16x32_bf16 v[84:87], a[100:103], a[4:7], v[84:87]
  v_cvt_pk_bf16_f32 v91, v94, v95
  v_add_f32 v76, v76, v92
  v_mfma_f32_16x16x32_bf16 v[84:87], a[104:107], a[8:11], v[84:87]
  ds_read_b128 a[124:127], v63 offset:16384
  v_add_f32 v76, v76, v93
  v_mfma_f32_16x16x32_bf16 v[84:87], a[108:111], a[12:15], v[84:87]
  v_add_f32 v76, v76, v94
  v_add_f32 v76, v76, v95
  v_mfma_f32_16x16x32_bf16 v[224:227], a[176:179], v[88:91], v[224:227]
  v_exp_f32 v80, v80
  v_mfma_f32_16x16x32_bf16 v[228:231], a[180:183], v[88:91], v[228:231]
  ds_read_b128 a[128:131], v60 offset:20480
  v_exp_f32 v81, v81
  v_mfma_f32_16x16x32_bf16 v[232:235], a[184:187], v[88:91], v[232:235]
  v_exp_f32 v82, v82
  v_mfma_f32_16x16x32_bf16 v[236:239], a[188:191], v[88:91], v[236:239]
  v_exp_f32 v83, v83
  v_mfma_f32_16x16x32_bf16 v[240:243], a[192:195], v[88:91], v[240:243]
  v_exp_f32 v84, v84
  v_mfma_f32_16x16x32_bf16 v[244:247], a[196:199], v[88:91], v[244:247]
  v_exp_f32 v85, v85
  v_mfma_f32_16x16x32_bf16 v[248:251], a[200:203], v[88:91], v[248:251]
  v_exp_f32 v86, v86
  v_mfma_f32_16x16x32_bf16 v[252:255], a[204:207], v[88:91], v[252:255]
  v_exp_f32 v87, v87
  v_mfma_f32_16x16x32_bf16 v[88:91], a[80:83], a[16:19], 0
  ds_read_b128 a[132:135], v61 offset:20480
  v_add_f32 v72, v72, v80
  v_mfma_f32_16x16x32_bf16 v[88:91], a[84:87], a[20:23], v[88:91]
  v_add_f32 v72, v72, v81
  v_add_f32 v72, v72, v82
  v_mfma_f32_16x16x32_bf16 v[88:91], a[88:91], a[24:27], v[88:91]
  ds_read_b128 a[136:139], v62 offset:20480
  v_add_f32 v72, v72, v83
  v_mfma_f32_16x16x32_bf16 v[88:91], a[92:95], a[28:31], v[88:91]
  ds_read_b128 a[140:143], v63 offset:20480
  v_cvt_pk_bf16_f32 v80, v80, v81
  v_cvt_pk_bf16_f32 v81, v82, v83
  v_mfma_f32_16x16x32_bf16 v[92:95], a[96:99], a[16:19], 0
  ds_read_b64_tr_b16 a[176:177], v64 offset:16384
  v_cvt_pk_bf16_f32 v82, v84, v85
  v_mfma_f32_16x16x32_bf16 v[92:95], a[100:103], a[20:23], v[92:95]
  v_cvt_pk_bf16_f32 v83, v86, v87
  v_add_f32 v72, v72, v84
  v_mfma_f32_16x16x32_bf16 v[92:95], a[104:107], a[24:27], v[92:95]
  ds_read_b64_tr_b16 a[178:179], v64 offset:20480
  v_add_f32 v72, v72, v85
  v_mfma_f32_16x16x32_bf16 v[92:95], a[108:111], a[28:31], v[92:95]
  v_add_f32 v72, v72, v86
  v_add_f32 v72, v72, v87
  v_mfma_f32_16x16x32_bf16 v[96:99], a[144:147], v[80:83], v[96:99]
  v_exp_f32 v88, v88
  v_mfma_f32_16x16x32_bf16 v[100:103], a[148:151], v[80:83], v[100:103]
  v_exp_f32 v89, v89
  v_mfma_f32_16x16x32_bf16 v[104:107], a[152:155], v[80:83], v[104:107]
  v_exp_f32 v90, v90
  v_mfma_f32_16x16x32_bf16 v[108:111], a[156:159], v[80:83], v[108:111]
  v_exp_f32 v91, v91
  v_mfma_f32_16x16x32_bf16 v[112:115], a[160:163], v[80:83], v[112:115]
  v_exp_f32 v92, v92
  v_mfma_f32_16x16x32_bf16 v[116:119], a[164:167], v[80:83], v[116:119]
  ds_read_b64_tr_b16 a[180:181], v65 offset:16384
  v_exp_f32 v93, v93
  v_mfma_f32_16x16x32_bf16 v[120:123], a[168:171], v[80:83], v[120:123]
  v_exp_f32 v94, v94
  v_mfma_f32_16x16x32_bf16 v[124:127], a[172:175], v[80:83], v[124:127]
  v_exp_f32 v95, v95
  v_mfma_f32_16x16x32_bf16 v[80:83], a[80:83], a[32:35], 0
  ds_read_b64_tr_b16 a[182:183], v65 offset:20480
  v_add_f32 v73, v73, v88
  v_mfma_f32_16x16x32_bf16 v[80:83], a[84:87], a[36:39], v[80:83]
  v_add_f32 v73, v73, v89
  v_add_f32 v73, v73, v90
  v_mfma_f32_16x16x32_bf16 v[80:83], a[88:91], a[40:43], v[80:83]
  ds_read_b64_tr_b16 a[184:185], v66 offset:16384
  v_add_f32 v73, v73, v91
  v_mfma_f32_16x16x32_bf16 v[80:83], a[92:95], a[44:47], v[80:83]
  v_cvt_pk_bf16_f32 v88, v88, v89
  v_cvt_pk_bf16_f32 v89, v90, v91
  v_mfma_f32_16x16x32_bf16 v[84:87], a[96:99], a[32:35], 0
  ds_read_b64_tr_b16 a[186:187], v66 offset:20480
  v_cvt_pk_bf16_f32 v90, v92, v93
  v_mfma_f32_16x16x32_bf16 v[84:87], a[100:103], a[36:39], v[84:87]
  v_cvt_pk_bf16_f32 v91, v94, v95
  v_add_f32 v73, v73, v92
  v_mfma_f32_16x16x32_bf16 v[84:87], a[104:107], a[40:43], v[84:87]
  ds_read_b64_tr_b16 a[188:189], v67 offset:16384
  v_add_f32 v73, v73, v93
  v_mfma_f32_16x16x32_bf16 v[84:87], a[108:111], a[44:47], v[84:87]
  v_add_f32 v73, v73, v94
  v_add_f32 v73, v73, v95
  v_mfma_f32_16x16x32_bf16 v[128:131], a[144:147], v[88:91], v[128:131]
  v_exp_f32 v80, v80
  v_mfma_f32_16x16x32_bf16 v[132:135], a[148:151], v[88:91], v[132:135]
  v_exp_f32 v81, v81
  v_mfma_f32_16x16x32_bf16 v[136:139], a[152:155], v[88:91], v[136:139]
  ds_read_b64_tr_b16 a[190:191], v67 offset:20480
  v_exp_f32 v82, v82
  v_mfma_f32_16x16x32_bf16 v[140:143], a[156:159], v[88:91], v[140:143]
  v_exp_f32 v83, v83
  v_mfma_f32_16x16x32_bf16 v[144:147], a[160:163], v[88:91], v[144:147]
  v_exp_f32 v84, v84
  v_mfma_f32_16x16x32_bf16 v[148:151], a[164:167], v[88:91], v[148:151]
  v_exp_f32 v85, v85
  v_mfma_f32_16x16x32_bf16 v[152:155], a[168:171], v[88:91], v[152:155]
  v_exp_f32 v86, v86
  v_mfma_f32_16x16x32_bf16 v[156:159], a[172:175], v[88:91], v[156:159]
  v_exp_f32 v87, v87
  v_mfma_f32_16x16x32_bf16 v[88:91], a[80:83], a[48:51], 0
  ds_read_b64_tr_b16 a[192:193], v68 offset:16384
  v_add_f32 v74, v74, v80
  v_mfma_f32_16x16x32_bf16 v[88:91], a[84:87], a[52:55], v[88:91]
  v_add_f32 v74, v74, v81
  v_add_f32 v74, v74, v82
  v_mfma_f32_16x16x32_bf16 v[88:91], a[88:91], a[56:59], v[88:91]
  ds_read_b64_tr_b16 a[194:195], v68 offset:20480
  v_add_f32 v74, v74, v83
  v_mfma_f32_16x16x32_bf16 v[88:91], a[92:95], a[60:63], v[88:91]
  v_cvt_pk_bf16_f32 v80, v80, v81
  v_cvt_pk_bf16_f32 v81, v82, v83
  v_mfma_f32_16x16x32_bf16 v[92:95], a[96:99], a[48:51], 0
  ds_read_b64_tr_b16 a[196:197], v69 offset:16384
  v_cvt_pk_bf16_f32 v82, v84, v85
  v_mfma_f32_16x16x32_bf16 v[92:95], a[100:103], a[52:55], v[92:95]
  ds_read_b64_tr_b16 a[198:199], v69 offset:20480
  v_cvt_pk_bf16_f32 v83, v86, v87
  v_add_f32 v74, v74, v84
  v_mfma_f32_16x16x32_bf16 v[92:95], a[104:107], a[56:59], v[92:95]
  ds_read_b64_tr_b16 a[200:201], v70 offset:16384
  v_add_f32 v74, v74, v85
  v_mfma_f32_16x16x32_bf16 v[92:95], a[108:111], a[60:63], v[92:95]
  v_add_f32 v74, v74, v86
  v_add_f32 v74, v74, v87
  v_mfma_f32_16x16x32_bf16 v[160:163], a[144:147], v[80:83], v[160:163]
  v_exp_f32 v88, v88
  v_mfma_f32_16x16x32_bf16 v[164:167], a[148:151], v[80:83], v[164:167]
  v_exp_f32 v89, v89
  v_mfma_f32_16x16x32_bf16 v[168:171], a[152:155], v[80:83], v[168:171]
  v_exp_f32 v90, v90
  v_mfma_f32_16x16x32_bf16 v[172:175], a[156:159], v[80:83], v[172:175]
  v_exp_f32 v91, v91
  v_mfma_f32_16x16x32_bf16 v[176:179], a[160:163], v[80:83], v[176:179]
  v_exp_f32 v92, v92
  v_mfma_f32_16x16x32_bf16 v[180:183], a[164:167], v[80:83], v[180:183]
  v_exp_f32 v93, v93
  v_mfma_f32_16x16x32_bf16 v[184:187], a[168:171], v[80:83], v[184:187]
  ds_read_b64_tr_b16 a[202:203], v70 offset:20480
  v_exp_f32 v94, v94
  v_mfma_f32_16x16x32_bf16 v[188:191], a[172:175], v[80:83], v[188:191]
  v_exp_f32 v95, v95
  v_mfma_f32_16x16x32_bf16 v[80:83], a[80:83], a[64:67], 0
  ds_read_b64_tr_b16 a[204:205], v71 offset:16384
  v_add_f32 v75, v75, v88
  v_mfma_f32_16x16x32_bf16 v[80:83], a[84:87], a[68:71], v[80:83]
  v_add_f32 v75, v75, v89
  v_add_f32 v75, v75, v90
  v_mfma_f32_16x16x32_bf16 v[80:83], a[88:91], a[72:75], v[80:83]
  ds_read_b64_tr_b16 a[206:207], v71 offset:20480
  v_add_f32 v75, v75, v91
  v_mfma_f32_16x16x32_bf16 v[80:83], a[92:95], a[76:79], v[80:83]
  v_cvt_pk_bf16_f32 v88, v88, v89
  v_cvt_pk_bf16_f32 v89, v90, v91
  v_mfma_f32_16x16x32_bf16 v[84:87], a[96:99], a[64:67], 0
  v_cvt_pk_bf16_f32 v90, v92, v93
  v_xor_b32 v60, 0x10000, v60
  v_mfma_f32_16x16x32_bf16 v[84:87], a[100:103], a[68:71], v[84:87]
  v_cvt_pk_bf16_f32 v91, v94, v95
  v_add_f32 v75, v75, v92
  v_xor_b32 v61, 0x10000, v61
  v_mfma_f32_16x16x32_bf16 v[84:87], a[104:107], a[72:75], v[84:87]
  v_add_f32 v75, v75, v93
  v_xor_b32 v62, 0x10000, v62
  v_mfma_f32_16x16x32_bf16 v[84:87], a[108:111], a[76:79], v[84:87]
  v_add_f32 v75, v75, v94
  v_add_f32 v75, v75, v95
  v_xor_b32 v63, 0x10000, v63
  v_mfma_f32_16x16x32_bf16 v[192:195], a[144:147], v[88:91], v[192:195]
  v_exp_f32 v80, v80
  v_xor_b32 v64, 0x10000, v64
  v_mfma_f32_16x16x32_bf16 v[196:199], a[148:151], v[88:91], v[196:199]
  v_exp_f32 v81, v81
  v_xor_b32 v65, 0x10000, v65
  v_mfma_f32_16x16x32_bf16 v[200:203], a[152:155], v[88:91], v[200:203]
  v_exp_f32 v82, v82
  v_xor_b32 v66, 0x10000, v66
  v_mfma_f32_16x16x32_bf16 v[204:207], a[156:159], v[88:91], v[204:207]
  v_exp_f32 v83, v83
  v_xor_b32 v67, 0x10000, v67
  v_mfma_f32_16x16x32_bf16 v[208:211], a[160:163], v[88:91], v[208:211]
  v_exp_f32 v84, v84
  v_xor_b32 v68, 0x10000, v68
  v_mfma_f32_16x16x32_bf16 v[212:215], a[164:167], v[88:91], v[212:215]
  v_exp_f32 v85, v85
  v_xor_b32 v69, 0x10000, v69
  v_mfma_f32_16x16x32_bf16 v[216:219], a[168:171], v[88:91], v[216:219]
  v_exp_f32 v86, v86
  v_xor_b32 v70, 0x10000, v70
  v_mfma_f32_16x16x32_bf16 v[220:223], a[172:175], v[88:91], v[220:223]
  v_exp_f32 v87, v87
  v_xor_b32 v71, 0x10000, v71
L_a1b:
  s_waitcnt lgkmcnt(0)
  s_barrier
  v_mfma_f32_16x16x32_bf16 v[88:91], a[112:115], a[0:3], 0
  ds_read_b128 a[80:83], v60 offset:0
  v_add_f32 v76, v76, v80
  v_mfma_f32_16x16x32_bf16 v[88:91], a[116:119], a[4:7], v[88:91]
  v_add_f32 v76, v76, v81
  v_add_f32 v76, v76, v82
  v_mfma_f32_16x16x32_bf16 v[88:91], a[120:123], a[8:11], v[88:91]
  ds_read_b128 a[84:87], v61 offset:0
  v_add_f32 v76, v76, v83
  v_mfma_f32_16x16x32_bf16 v[88:91], a[124:127], a[12:15], v[88:91]
  v_cvt_pk_bf16_f32 v80, v80, v81
  v_cvt_pk_bf16_f32 v81, v82, v83
  v_mfma_f32_16x16x32_bf16 v[92:95], a[128:131], a[0:3], 0
  ds_read_b128 a[88:91], v62 offset:0
  v_cvt_pk_bf16_f32 v82, v84, v85
  v_mfma_f32_16x16x32_bf16 v[92:95], a[132:135], a[4:7], v[92:95]
  v_cvt_pk_bf16_f32 v83, v86, v87
  v_add_f32 v76, v76, v84
  v_mfma_f32_16x16x32_bf16 v[92:95], a[136:139], a[8:11], v[92:95]
  ds_read_b128 a[92:95], v63 offset:0
  v_add_f32 v76, v76, v85
  v_mfma_f32_16x16x32_bf16 v[92:95], a[140:143], a[12:15], v[92:95]
  v_add_f32 v76, v76, v86
  v_add_f32 v76, v76, v87
  v_mfma_f32_16x16x32_bf16 v[224:227], a[144:147], v[80:83], v[224:227]
  v_exp_f32 v88, v88
  v_mfma_f32_16x16x32_bf16 v[228:231], a[148:151], v[80:83], v[228:231]
  ds_read_b128 a[96:99], v60 offset:4096
  v_exp_f32 v89, v89
  v_mfma_f32_16x16x32_bf16 v[232:235], a[152:155], v[80:83], v[232:235]
  v_exp_f32 v90, v90
  v_mfma_f32_16x16x32_bf16 v[236:239], a[156:159], v[80:83], v[236:239]
  v_exp_f32 v91, v91
  v_mfma_f32_16x16x32_bf16 v[240:243], a[160:163], v[80:83], v[240:243]
  v_exp_f32 v92, v92
  v_mfma_f32_16x16x32_bf16 v[244:247], a[164:167], v[80:83], v[244:247]
  v_exp_f32 v93, v93
  v_mfma_f32_16x16x32_bf16 v[248:251], a[168:171], v[80:83], v[248:251]
  v_exp_f32 v94, v94
  v_mfma_f32_16x16x32_bf16 v[252:255], a[172:175], v[80:83], v[252:255]
  v_exp_f32 v95, v95
  v_mfma_f32_16x16x32_bf16 v[80:83], a[112:115], a[16:19], 0
  ds_read_b128 a[100:103], v61 offset:4096
  v_add_f32 v72, v72, v88
  v_mfma_f32_16x16x32_bf16 v[80:83], a[116:119], a[20:23], v[80:83]
  v_add_f32 v72, v72, v89
  v_add_f32 v72, v72, v90
  v_mfma_f32_16x16x32_bf16 v[80:83], a[120:123], a[24:27], v[80:83]
  ds_read_b128 a[104:107], v62 offset:4096
  v_add_f32 v72, v72, v91
  v_mfma_f32_16x16x32_bf16 v[80:83], a[124:127], a[28:31], v[80:83]
  ds_read_b128 a[108:111], v63 offset:4096
  v_cvt_pk_bf16_f32 v88, v88, v89
  v_cvt_pk_bf16_f32 v89, v90, v91
  v_mfma_f32_16x16x32_bf16 v[84:87], a[128:131], a[16:19], 0
  ds_read_b64_tr_b16 a[144:145], v64 offset:0
  v_cvt_pk_bf16_f32 v90, v92, v93
  v_mfma_f32_16x16x32_bf16 v[84:87], a[132:135], a[20:23], v[84:87]
  v_cvt_pk_bf16_f32 v91, v94, v95
  v_add_f32 v72, v72, v92
  v_mfma_f32_16x16x32_bf16 v[84:87], a[136:139], a[24:27], v[84:87]
  ds_read_b64_tr_b16 a[146:147], v64 offset:4096
  v_add_f32 v72, v72, v93
  v_mfma_f32_16x16x32_bf16 v[84:87], a[140:143], a[28:31], v[84:87]
  v_add_f32 v72, v72, v94
  v_add_f32 v72, v72, v95
  v_mfma_f32_16x16x32_bf16 v[96:99], a[176:179], v[88:91], v[96:99]
  v_exp_f32 v80, v80
  v_mfma_f32_16x16x32_bf16 v[100:103], a[180:183], v[88:91], v[100:103]
  v_exp_f32 v81, v81
  v_mfma_f32_16x16x32_bf16 v[104:107], a[184:187], v[88:91], v[104:107]
  v_exp_f32 v82, v82
  v_mfma_f32_16x16x32_bf16 v[108:111], a[188:191], v[88:91], v[108:111]
  v_exp_f32 v83, v83
  v_mfma_f32_16x16x32_bf16 v[112:115], a[192:195], v[88:91], v[112:115]
  v_exp_f32 v84, v84
  v_mfma_f32_16x16x32_bf16 v[116:119], a[196:199], v[88:91], v[116:119]
  ds_read_b64_tr_b16 a[148:149], v65 offset:0
  v_exp_f32 v85, v85
  v_mfma_f32_16x16x32_bf16 v[120:123], a[200:203], v[88:91], v[120:123]
  v_exp_f32 v86, v86
  v_mfma_f32_16x16x32_bf16 v[124:127], a[204:207], v[88:91], v[124:127]
  v_exp_f32 v87, v87
  v_mfma_f32_16x16x32_bf16 v[88:91], a[112:115], a[32:35], 0
  ds_read_b64_tr_b16 a[150:151], v65 offset:4096
  v_add_f32 v73, v73, v80
  v_mfma_f32_16x16x32_bf16 v[88:91], a[116:119], a[36:39], v[88:91]
  v_add_f32 v73, v73, v81
  v_add_f32 v73, v73, v82
  v_mfma_f32_16x16x32_bf16 v[88:91], a[120:123], a[40:43], v[88:91]
  ds_read_b64_tr_b16 a[152:153], v66 offset:0
  v_add_f32 v73, v73, v83
  v_mfma_f32_16x16x32_bf16 v[88:91], a[124:127], a[44:47], v[88:91]
  v_cvt_pk_bf16_f32 v80, v80, v81
  v_cvt_pk_bf16_f32 v81, v82, v83
  v_mfma_f32_16x16x32_bf16 v[92:95], a[128:131], a[32:35], 0
  ds_read_b64_tr_b16 a[154:155], v66 offset:4096
  v_cvt_pk_bf16_f32 v82, v84, v85
  v_mfma_f32_16x16x32_bf16 v[92:95], a[132:135], a[36:39], v[92:95]
  v_cvt_pk_bf16_f32 v83, v86, v87
  v_add_f32 v73, v73, v84
  v_mfma_f32_16x16x32_bf16 v[92:95], a[136:139], a[40:43], v[92:95]
  ds_read_b64_tr_b16 a[156:157], v67 offset:0
  v_add_f32 v73, v73, v85
  v_mfma_f32_16x16x32_bf16 v[92:95], a[140:143], a[44:47], v[92:95]
  v_add_f32 v73, v73, v86
  v_add_f32 v73, v73, v87
  v_mfma_f32_16x16x32_bf16 v[128:131], a[176:179], v[80:83], v[128:131]
  v_exp_f32 v88, v88
  v_mfma_f32_16x16x32_bf16 v[132:135], a[180:183], v[80:83], v[132:135]
  v_exp_f32 v89, v89
  v_mfma_f32_16x16x32_bf16 v[136:139], a[184:187], v[80:83], v[136:139]
  ds_read_b64_tr_b16 a[158:159], v67 offset:4096
  v_exp_f32 v90, v90
  v_mfma_f32_16x16x32_bf16 v[140:143], a[188:191], v[80:83], v[140:143]
  v_exp_f32 v91, v91
  v_mfma_f32_16x16x32_bf16 v[144:147], a[192:195], v[80:83], v[144:147]
  v_exp_f32 v92, v92
  v_mfma_f32_16x16x32_bf16 v[148:151], a[196:199], v[80:83], v[148:151]
  v_exp_f32 v93, v93
  v_mfma_f32_16x16x32_bf16 v[152:155], a[200:203], v[80:83], v[152:155]
  v_exp_f32 v94, v94
  v_mfma_f32_16x16x32_bf16 v[156:159], a[204:207], v[80:83], v[156:159]
  v_exp_f32 v95, v95
  v_mfma_f32_16x16x32_bf16 v[80:83], a[112:115], a[48:51], 0
  ds_read_b64_tr_b16 a[160:161], v68 offset:0
  v_add_f32 v74, v74, v88
  v_mfma_f32_16x16x32_bf16 v[80:83], a[116:119], a[52:55], v[80:83]
  v_add_f32 v74, v74, v89
  v_add_f32 v74, v74, v90
  v_mfma_f32_16x16x32_bf16 v[80:83], a[120:123], a[56:59], v[80:83]
  ds_read_b64_tr_b16 a[162:163], v68 offset:4096
  v_add_f32 v74, v74, v91
  v_mfma_f32_16x16x32_bf16 v[80:83], a[124:127], a[60:63], v[80:83]
  v_cvt_pk_bf16_f32 v88, v88, v89
  v_cvt_pk_bf16_f32 v89, v90, v91
  v_mfma_f32_16x16x32_bf16 v[84:87], a[128:131], a[48:51], 0
  ds_read_b64_tr_b16 a[164:165], v69 offset:0
  v_cvt_pk_bf16_f32 v90, v92, v93
  v_mfma_f32_16x16x32_bf16 v[84:87], a[132:135], a[52:55], v[84:87]
  ds_read_b64_tr_b16 a[166:167], v69 offset:4096
  v_cvt_pk_bf16_f32 v91, v94, v95
  v_add_f32 v74, v74, v92
  v_mfma_f32_16x16x32_bf16 v[84:87], a[136:139], a[56:59], v[84:87]
  ds_read_b64_tr_b16 a[168:169], v70 offset:0
  v_add_f32 v74, v74, v93
  v_mfma_f32_16x16x32_bf16 v[84:87], a[140:143], a[60:63], v[84:87]
  v_add_f32 v74, v74, v94
  v_add_f32 v74, v74, v95
  v_mfma_f32_16x16x32_bf16 v[160:163], a[176:179], v[88:91], v[160:163]
  v_exp_f32 v80, v80
  v_mfma_f32_16x16x32_bf16 v[164:167], a[180:183], v[88:91], v[164:167]
  v_exp_f32 v81, v81
  v_mfma_f32_16x16x32_bf16 v[168:171], a[184:187], v[88:91], v[168:171]
  v_exp_f32 v82, v82
  v_mfma_f32_16x16x32_bf16 v[172:175], a[188:191], v[88:91], v[172:175]
  v_exp_f32 v83, v83
  v_mfma_f32_16x16x32_bf16 v[176:179], a[192:195], v[88:91], v[176:179]
  v_exp_f32 v84, v84
  v_mfma_f32_16x16x32_bf16 v[180:183], a[196:199], v[88:91], v[180:183]
  v_exp_f32 v85, v85
  v_mfma_f32_16x16x32_bf16 v[184:187], a[200:203], v[88:91], v[184:187]
  ds_read_b64_tr_b16 a[170:171], v70 offset:4096
  v_exp_f32 v86, v86
  v_mfma_f32_16x16x32_bf16 v[188:191], a[204:207], v[88:91], v[188:191]
  v_exp_f32 v87, v87
  v_mfma_f32_16x16x32_bf16 v[88:91], a[112:115], a[64:67], 0
  ds_read_b64_tr_b16 a[172:173], v71 offset:0
  v_add_f32 v75, v75, v80
  v_mfma_f32_16x16x32_bf16 v[88:91], a[116:119], a[68:71], v[88:91]
  v_add_f32 v75, v75, v81
  v_add_f32 v75, v75, v82
  v_mfma_f32_16x16x32_bf16 v[88:91], a[120:123], a[72:75], v[88:91]
  ds_read_b64_tr_b16 a[174:175], v71 offset:4096
  v_add_f32 v75, v75, v83
  v_mfma_f32_16x16x32_bf16 v[88:91], a[124:127], a[76:79], v[88:91]
  v_cvt_pk_bf16_f32 v80, v80, v81
  v_cvt_pk_bf16_f32 v81, v82, v83
  v_mfma_f32_16x16x32_bf16 v[92:95], a[128:131], a[64:67], 0
  v_cvt_pk_bf16_f32 v82, v84, v85
  v_mfma_f32_16x16x32_bf16 v[92:95], a[132:135], a[68:71], v[92:95]
  v_cvt_pk_bf16_f32 v83, v86, v87
  v_add_f32 v75, v75, v84
  v_mfma_f32_16x16x32_bf16 v[92:95], a[136:139], a[72:75], v[92:95]
  v_add_f32 v75, v75, v85
  v_mfma_f32_16x16x32_bf16 v[92:95], a[140:143], a[76:79], v[92:95]
  v_add_f32 v75, v75, v86
  v_add_f32 v75, v75, v87
  v_mfma_f32_16x16x32_bf16 v[192:195], a[176:179], v[80:83], v[192:195]
  v_exp_f32 v88, v88
  v_mfma_f32_16x16x32_bf16 v[196:199], a[180:183], v[80:83], v[196:199]
  v_exp_f32 v89, v89
  v_mfma_f32_16x16x32_bf16 v[200:203], a[184:187], v[80:83], v[200:203]
  v_exp_f32 v90, v90
  v_mfma_f32_16x16x32_bf16 v[204:207], a[188:191], v[80:83], v[204:207]
  v_exp_f32 v91, v91
  v_mfma_f32_16x16x32_bf16 v[208:211], a[192:195], v[80:83], v[208:211]
  v_exp_f32 v92, v92
  v_mfma_f32_16x16x32_bf16 v[212:215], a[196:199], v[80:83], v[212:215]
  v_exp_f32 v93, v93
  v_mfma_f32_16x16x32_bf16 v[216:219], a[200:203], v[80:83], v[216:219]
  v_exp_f32 v94, v94
  v_mfma_f32_16x16x32_bf16 v[220:223], a[204:207], v[80:83], v[220:223]
  v_exp_f32 v95, v95
  s_xor_b32 s45, s45, 0x10000
  s_add_u32 s40, s40, 2
  s_cmp_lt_u32 s40, 14
  s_cbranch_scc1 L_ab
  s_waitcnt lgkmcnt(0)
  s_add_u32 s38, s55, 0
  s_nop 0
  buffer_load_dword v50, v51, s[56:59], s38 offen
  s_add_u32 s38, s55, 8192
  s_nop 0
  buffer_load_dword v50, v51, s[56:59], s38 offen
  s_add_u32 s38, s55, 10240
  s_nop 0
  buffer_load_dword v50, v51, s[56:59], s38 offen
L_ntb14:
  v_mfma_f32_16x16x32_bf16 v[80:83], a[80:83], a[0:3], 0
  v_add_f32 v76, v76, v88
  v_mfma_f32_16x16x32_bf16 v[80:83], a[84:87], a[4:7], v[80:83]
  v_add_f32 v76, v76, v89
  v_add_f32 v76, v76, v90
  v_mfma_f32_16x16x32_bf16 v[80:83], a[88:91], a[8:11], v[80:83]
  v_add_f32 v76, v76, v91
  v_mfma_f32_16x16x32_bf16 v[80:83], a[92:95], a[12:15], v[80:83]
  v_cvt_pk_bf16_f32 v88, v88, v89
  v_cvt_pk_bf16_f32 v89, v90, v91
  v_mfma_f32_16x16x32_bf16 v[84:87], a[96:99], a[0:3], 0
  v_cvt_pk_bf16_f32 v90, v92, v93
  v_mfma_f32_16x16x32_bf16 v[84:87], a[100:103], a[4:7], v[84:87]
  v_cvt_pk_bf16_f32 v91, v94, v95
  v_add_f32 v76, v76, v92
  v_mfma_f32_16x16x32_bf16 v[84:87], a[104:107], a[8:11], v[84:87]
  v_add_f32 v76, v76, v93
  v_mfma_f32_16x16x32_bf16 v[84:87], a[108:111], a[12:15], v[84:87]
  v_add_f32 v76, v76, v94
  v_add_f32 v76, v76, v95
  v_mfma_f32_16x16x32_bf16 v[224:227], a[176:179], v[88:91], v[224:227]
  v_exp_f32 v80, v80
  v_mfma_f32_16x16x32_bf16 v[228:231], a[180:183], v[88:91], v[228:231]
  v_exp_f32 v81, v81
  v_mfma_f32_16x16x32_bf16 v[232:235], a[184:187], v[88:91], v[232:235]
  v_exp_f32 v82, v82
  v_mfma_f32_16x16x32_bf16 v[236:239], a[188:191], v[88:91], v[236:239]
  v_exp_f32 v83, v83
  v_mfma_f32_16x16x32_bf16 v[240:243], a[192:195], v[88:91], v[240:243]
  v_exp_f32 v84, v84
  v_mfma_f32_16x16x32_bf16 v[244:247], a[196:199], v[88:91], v[244:247]
  v_exp_f32 v85, v85
  v_mfma_f32_16x16x32_bf16 v[248:251], a[200:203], v[88:91], v[248:251]
  v_exp_f32 v86, v86
  v_mfma_f32_16x16x32_bf16 v[252:255], a[204:207], v[88:91], v[252:255]
  v_exp_f32 v87, v87
  v_mfma_f32_16x16x32_bf16 v[88:91], a[80:83], a[16:19], 0
  v_add_f32 v72, v72, v80
  v_mfma_f32_16x16x32_bf16 v[88:91], a[84:87], a[20:23], v[88:91]
  v_add_f32 v72, v72, v81
  v_add_f32 v72, v72, v82
  v_mfma_f32_16x16x32_bf16 v[88:91], a[88:91], a[24:27], v[88:91]
  v_add_f32 v72, v72, v83
  v_mfma_f32_16x16x32_bf16 v[88:91], a[92:95], a[28:31], v[88:91]
  v_cvt_pk_bf16_f32 v80, v80, v81
  v_cvt_pk_bf16_f32 v81, v82, v83
  v_mfma_f32_16x16x32_bf16 v[92:95], a[96:99], a[16:19], 0
  v_cvt_pk_bf16_f32 v82, v84, v85
  v_mfma_f32_16x16x32_bf16 v[92:95], a[100:103], a[20:23], v[92:95]
  v_cvt_pk_bf16_f32 v83, v86, v87
  v_add_f32 v72, v72, v84
  v_mfma_f32_16x16x32_bf16 v[92:95], a[104:107], a[24:27], v[92:95]
  v_add_f32 v72, v72, v85
  v_mfma_f32_16x16x32_bf16 v[92:95], a[108:111], a[28:31], v[92:95]
  v_add_f32 v72, v72, v86
  v_add_f32 v72, v72, v87
  v_mfma_f32_16x16x32_bf16 v[96:99], a[144:147], v[80:83], v[96:99]
  v_exp_f32 v88, v88
  v_mfma_f32_16x16x32_bf16 v[100:103], a[148:151], v[80:83], v[100:103]
  v_exp_f32 v89, v89
  v_mfma_f32_16x16x32_bf16 v[104:107], a[152:155], v[80:83], v[104:107]
  v_exp_f32 v90, v90
  v_mfma_f32_16x16x32_bf16 v[108:111], a[156:159], v[80:83], v[108:111]
  v_exp_f32 v91, v91
  v_mfma_f32_16x16x32_bf16 v[112:115], a[160:163], v[80:83], v[112:115]
  v_exp_f32 v92, v92
  v_mfma_f32_16x16x32_bf16 v[116:119], a[164:167], v[80:83], v[116:119]
  v_exp_f32 v93, v93
  v_mfma_f32_16x16x32_bf16 v[120:123], a[168:171], v[80:83], v[120:123]
  v_exp_f32 v94, v94
  v_mfma_f32_16x16x32_bf16 v[124:127], a[172:175], v[80:83], v[124:127]
  v_exp_f32 v95, v95
  v_mfma_f32_16x16x32_bf16 v[80:83], a[80:83], a[32:35], 0
  v_add_f32 v73, v73, v88
  v_mfma_f32_16x16x32_bf16 v[80:83], a[84:87], a[36:39], v[80:83]
  v_add_f32 v73, v73, v89
  v_add_f32 v73, v73, v90
  v_mfma_f32_16x16x32_bf16 v[80:83], a[88:91], a[40:43], v[80:83]
  v_add_f32 v73, v73, v91
  v_mfma_f32_16x16x32_bf16 v[80:83], a[92:95], a[44:47], v[80:83]
  v_cvt_pk_bf16_f32 v88, v88, v89
  v_cvt_pk_bf16_f32 v89, v90, v91
  v_mfma_f32_16x16x32_bf16 v[84:87], a[96:99], a[32:35], 0
  v_cvt_pk_bf16_f32 v90, v92, v93
  v_mfma_f32_16x16x32_bf16 v[84:87], a[100:103], a[36:39], v[84:87]
  v_cvt_pk_bf16_f32 v91, v94, v95
  v_add_f32 v73, v73, v92
  v_mfma_f32_16x16x32_bf16 v[84:87], a[104:107], a[40:43], v[84:87]
  v_add_f32 v73, v73, v93
  v_mfma_f32_16x16x32_bf16 v[84:87], a[108:111], a[44:47], v[84:87]
  v_add_f32 v73, v73, v94
  v_add_f32 v73, v73, v95
  v_mfma_f32_16x16x32_bf16 v[128:131], a[144:147], v[88:91], v[128:131]
  v_exp_f32 v80, v80
  v_mfma_f32_16x16x32_bf16 v[132:135], a[148:151], v[88:91], v[132:135]
  v_exp_f32 v81, v81
  v_mfma_f32_16x16x32_bf16 v[136:139], a[152:155], v[88:91], v[136:139]
  v_exp_f32 v82, v82
  v_mfma_f32_16x16x32_bf16 v[140:143], a[156:159], v[88:91], v[140:143]
  v_exp_f32 v83, v83
  v_mfma_f32_16x16x32_bf16 v[144:147], a[160:163], v[88:91], v[144:147]
  v_exp_f32 v84, v84
  v_mfma_f32_16x16x32_bf16 v[148:151], a[164:167], v[88:91], v[148:151]
  v_exp_f32 v85, v85
  v_mfma_f32_16x16x32_bf16 v[152:155], a[168:171], v[88:91], v[152:155]
  v_exp_f32 v86, v86
  v_mfma_f32_16x16x32_bf16 v[156:159], a[172:175], v[88:91], v[156:159]
  v_exp_f32 v87, v87
  s_barrier
  v_mfma_f32_16x16x32_bf16 v[88:91], a[80:83], a[48:51], 0
  ds_read_b128 a[112:115], v60 offset:16384
  v_add_f32 v74, v74, v80
  v_mfma_f32_16x16x32_bf16 v[88:91], a[84:87], a[52:55], v[88:91]
  ds_read_b128 a[116:119], v61 offset:16384
  v_add_f32 v74, v74, v81
  v_add_f32 v74, v74, v82
  v_mfma_f32_16x16x32_bf16 v[88:91], a[88:91], a[56:59], v[88:91]
  ds_read_b128 a[120:123], v62 offset:16384
  v_add_f32 v74, v74, v83
  v_mfma_f32_16x16x32_bf16 v[88:91], a[92:95], a[60:63], v[88:91]
  ds_read_b128 a[124:127], v63 offset:16384
  v_cvt_pk_bf16_f32 v80, v80, v81
  v_cvt_pk_bf16_f32 v81, v82, v83
  v_mfma_f32_16x16x32_bf16 v[92:95], a[96:99], a[48:51], 0
  ds_read_b128 a[128:131], v60 offset:20480
  v_cvt_pk_bf16_f32 v82, v84, v85
  v_mfma_f32_16x16x32_bf16 v[92:95], a[100:103], a[52:55], v[92:95]
  ds_read_b128 a[132:135], v61 offset:20480
  v_cvt_pk_bf16_f32 v83, v86, v87
  v_add_f32 v74, v74, v84
  v_mfma_f32_16x16x32_bf16 v[92:95], a[104:107], a[56:59], v[92:95]
  ds_read_b128 a[136:139], v62 offset:20480
  v_add_f32 v74, v74, v85
  v_mfma_f32_16x16x32_bf16 v[92:95], a[108:111], a[60:63], v[92:95]
  ds_read_b128 a[140:143], v63 offset:20480
  v_add_f32 v74, v74, v86
  v_add_f32 v74, v74, v87
  v_mfma_f32_16x16x32_bf16 v[160:163], a[144:147], v[80:83], v[160:163]
  ds_read_b64_tr_b16 a[176:177], v64 offset:16384
  v_exp_f32 v88, v88
  v_mfma_f32_16x16x32_bf16 v[164:167], a[148:151], v[80:83], v[164:167]
  ds_read_b64_tr_b16 a[178:179], v64 offset:20480
  v_exp_f32 v89, v89
  v_mfma_f32_16x16x32_bf16 v[168:171], a[152:155], v[80:83], v[168:171]
  ds_read_b64_tr_b16 a[180:181], v65 offset:16384
  v_exp_f32 v90, v90
  v_mfma_f32_16x16x32_bf16 v[172:175], a[156:159], v[80:83], v[172:175]
  ds_read_b64_tr_b16 a[182:183], v65 offset:20480
  v_exp_f32 v91, v91
  v_mfma_f32_16x16x32_bf16 v[176:179], a[160:163], v[80:83], v[176:179]
  ds_read_b64_tr_b16 a[184:185], v66 offset:16384
  v_exp_f32 v92, v92
  v_mfma_f32_16x16x32_bf16 v[180:183], a[164:167], v[80:83], v[180:183]
  ds_read_b64_tr_b16 a[186:187], v66 offset:20480
  v_exp_f32 v93, v93
  v_mfma_f32_16x16x32_bf16 v[184:187], a[168:171], v[80:83], v[184:187]
  ds_read_b64_tr_b16 a[188:189], v67 offset:16384
  v_exp_f32 v94, v94
  v_mfma_f32_16x16x32_bf16 v[188:191], a[172:175], v[80:83], v[188:191]
  ds_read_b64_tr_b16 a[190:191], v67 offset:20480
  v_exp_f32 v95, v95
  v_mfma_f32_16x16x32_bf16 v[80:83], a[80:83], a[64:67], 0
  ds_read_b64_tr_b16 a[192:193], v68 offset:16384
  v_add_f32 v75, v75, v88
  v_mfma_f32_16x16x32_bf16 v[80:83], a[84:87], a[68:71], v[80:83]
  ds_read_b64_tr_b16 a[194:195], v68 offset:20480
  v_add_f32 v75, v75, v89
  v_add_f32 v75, v75, v90
  v_mfma_f32_16x16x32_bf16 v[80:83], a[88:91], a[72:75], v[80:83]
  ds_read_b64_tr_b16 a[196:197], v69 offset:16384
  v_add_f32 v75, v75, v91
  v_mfma_f32_16x16x32_bf16 v[80:83], a[92:95], a[76:79], v[80:83]
  ds_read_b64_tr_b16 a[198:199], v69 offset:20480
  v_cvt_pk_bf16_f32 v88, v88, v89
  v_cvt_pk_bf16_f32 v89, v90, v91
  v_mfma_f32_16x16x32_bf16 v[84:87], a[96:99], a[64:67], 0
  ds_read_b64_tr_b16 a[200:201], v70 offset:16384
  v_cvt_pk_bf16_f32 v90, v92, v93
  v_mfma_f32_16x16x32_bf16 v[84:87], a[100:103], a[68:71], v[84:87]
  ds_read_b64_tr_b16 a[202:203], v70 offset:20480
  v_cvt_pk_bf16_f32 v91, v94, v95
  v_add_f32 v75, v75, v92
  v_mfma_f32_16x16x32_bf16 v[84:87], a[104:107], a[72:75], v[84:87]
  ds_read_b64_tr_b16 a[204:205], v71 offset:16384
  v_add_f32 v75, v75, v93
  v_mfma_f32_16x16x32_bf16 v[84:87], a[108:111], a[76:79], v[84:87]
  ds_read_b64_tr_b16 a[206:207], v71 offset:20480
  v_add_f32 v75, v75, v94
  v_add_f32 v75, v75, v95
  v_mfma_f32_16x16x32_bf16 v[192:195], a[144:147], v[88:91], v[192:195]
  v_exp_f32 v80, v80
  v_mfma_f32_16x16x32_bf16 v[196:199], a[148:151], v[88:91], v[196:199]
  v_exp_f32 v81, v81
  v_mfma_f32_16x16x32_bf16 v[200:203], a[152:155], v[88:91], v[200:203]
  v_exp_f32 v82, v82
  v_mfma_f32_16x16x32_bf16 v[204:207], a[156:159], v[88:91], v[204:207]
  v_exp_f32 v83, v83
  v_mfma_f32_16x16x32_bf16 v[208:211], a[160:163], v[88:91], v[208:211]
  v_exp_f32 v84, v84
  v_mfma_f32_16x16x32_bf16 v[212:215], a[164:167], v[88:91], v[212:215]
  v_exp_f32 v85, v85
  v_mfma_f32_16x16x32_bf16 v[216:219], a[168:171], v[88:91], v[216:219]
  v_exp_f32 v86, v86
  v_mfma_f32_16x16x32_bf16 v[220:223], a[172:175], v[88:91], v[220:223]
  v_exp_f32 v87, v87
  s_waitcnt lgkmcnt(0)
  s_barrier
  v_mfma_f32_16x16x32_bf16 v[88:91], a[112:115], a[0:3], 0
  v_add_f32 v76, v76, v80
  v_mfma_f32_16x16x32_bf16 v[88:91], a[116:119], a[4:7], v[88:91]
  v_add_f32 v76, v76, v81
  v_add_f32 v76, v76, v82
  v_mfma_f32_16x16x32_bf16 v[88:91], a[120:123], a[8:11], v[88:91]
  v_add_f32 v76, v76, v83
  v_mfma_f32_16x16x32_bf16 v[88:91], a[124:127], a[12:15], v[88:91]
  v_cvt_pk_bf16_f32 v80, v80, v81
  v_cvt_pk_bf16_f32 v81, v82, v83
  v_mfma_f32_16x16x32_bf16 v[92:95], a[128:131], a[0:3], 0
  v_cvt_pk_bf16_f32 v82, v84, v85
  v_mfma_f32_16x16x32_bf16 v[92:95], a[132:135], a[4:7], v[92:95]
  v_cvt_pk_bf16_f32 v83, v86, v87
  v_add_f32 v76, v76, v84
  v_mfma_f32_16x16x32_bf16 v[92:95], a[136:139], a[8:11], v[92:95]
  v_add_f32 v76, v76, v85
  v_mfma_f32_16x16x32_bf16 v[92:95], a[140:143], a[12:15], v[92:95]
  v_add_f32 v76, v76, v86
  v_add_f32 v76, v76, v87
  v_mfma_f32_16x16x32_bf16 v[224:227], a[144:147], v[80:83], v[224:227]
  v_exp_f32 v88, v88
  v_mfma_f32_16x16x32_bf16 v[228:231], a[148:151], v[80:83], v[228:231]
  v_exp_f32 v89, v89
  v_mfma_f32_16x16x32_bf16 v[232:235], a[152:155], v[80:83], v[232:235]
  v_exp_f32 v90, v90
  v_mfma_f32_16x16x32_bf16 v[236:239], a[156:159], v[80:83], v[236:239]
  v_exp_f32 v91, v91
  v_mfma_f32_16x16x32_bf16 v[240:243], a[160:163], v[80:83], v[240:243]
  v_exp_f32 v92, v92
  v_mfma_f32_16x16x32_bf16 v[244:247], a[164:167], v[80:83], v[244:247]
  v_exp_f32 v93, v93
  v_mfma_f32_16x16x32_bf16 v[248:251], a[168:171], v[80:83], v[248:251]
  v_exp_f32 v94, v94
  v_mfma_f32_16x16x32_bf16 v[252:255], a[172:175], v[80:83], v[252:255]
  v_exp_f32 v95, v95
  v_mfma_f32_16x16x32_bf16 v[80:83], a[112:115], a[16:19], 0
  v_add_f32 v72, v72, v88
  v_mfma_f32_16x16x32_bf16 v[80:83], a[116:119], a[20:23], v[80:83]
  v_add_f32 v72, v72, v89
  v_add_f32 v72, v72, v90
  v_mfma_f32_16x16x32_bf16 v[80:83], a[120:123], a[24:27], v[80:83]
  v_add_f32 v72, v72, v91
  v_mfma_f32_16x16x32_bf16 v[80:83], a[124:127], a[28:31], v[80:83]
  v_cvt_pk_bf16_f32 v88, v88, v89
  v_cvt_pk_bf16_f32 v89, v90, v91
  v_mfma_f32_16x16x32_bf16 v[84:87], a[128:131], a[16:19], 0
  v_cvt_pk_bf16_f32 v90, v92, v93
  v_mfma_f32_16x16x32_bf16 v[84:87], a[132:135], a[20:23], v[84:87]
  v_cvt_pk_bf16_f32 v91, v94, v95
  v_add_f32 v72, v72, v92
  v_mfma_f32_16x16x32_bf16 v[84:87], a[136:139], a[24:27], v[84:87]
  v_add_f32 v72, v72, v93
  v_mfma_f32_16x16x32_bf16 v[84:87], a[140:143], a[28:31], v[84:87]
  v_add_f32 v72, v72, v94
  v_add_f32 v72, v72, v95
  v_mfma_f32_16x16x32_bf16 v[96:99], a[176:179], v[88:91], v[96:99]
  v_exp_f32 v80, v80
  v_mfma_f32_16x16x32_bf16 v[100:103], a[180:183], v[88:91], v[100:103]
  v_exp_f32 v81, v81
  v_mfma_f32_16x16x32_bf16 v[104:107], a[184:187], v[88:91], v[104:107]
  v_exp_f32 v82, v82
  v_mfma_f32_16x16x32_bf16 v[108:111], a[188:191], v[88:91], v[108:111]
  v_exp_f32 v83, v83
  v_mfma_f32_16x16x32_bf16 v[112:115], a[192:195], v[88:91], v[112:115]
  v_exp_f32 v84, v84
  v_mfma_f32_16x16x32_bf16 v[116:119], a[196:199], v[88:91], v[116:119]
  v_exp_f32 v85, v85
  v_mfma_f32_16x16x32_bf16 v[120:123], a[200:203], v[88:91], v[120:123]
  v_exp_f32 v86, v86
  v_mfma_f32_16x16x32_bf16 v[124:127], a[204:207], v[88:91], v[124:127]
  v_exp_f32 v87, v87
  v_mfma_f32_16x16x32_bf16 v[88:91], a[112:115], a[32:35], 0
  v_add_f32 v73, v73, v80
  v_mfma_f32_16x16x32_bf16 v[88:91], a[116:119], a[36:39], v[88:91]
  v_add_f32 v73, v73, v81
  v_add_f32 v73, v73, v82
  v_mfma_f32_16x16x32_bf16 v[88:91], a[120:123], a[40:43], v[88:91]
  v_add_f32 v73, v73, v83
  v_mfma_f32_16x16x32_bf16 v[88:91], a[124:127], a[44:47], v[88:91]
  v_cvt_pk_bf16_f32 v80, v80, v81
  v_cvt_pk_bf16_f32 v81, v82, v83
  v_mfma_f32_16x16x32_bf16 v[92:95], a[128:131], a[32:35], 0
  v_cvt_pk_bf16_f32 v82, v84, v85
  v_mfma_f32_16x16x32_bf16 v[92:95], a[132:135], a[36:39], v[92:95]
  v_cvt_pk_bf16_f32 v83, v86, v87
  v_add_f32 v73, v73, v84
  v_mfma_f32_16x16x32_bf16 v[92:95], a[136:139], a[40:43], v[92:95]
  v_add_f32 v73, v73, v85
  v_mfma_f32_16x16x32_bf16 v[92:95], a[140:143], a[44:47], v[92:95]
  v_add_f32 v73, v73, v86
  v_add_f32 v73, v73, v87
  v_mfma_f32_16x16x32_bf16 v[128:131], a[176:179], v[80:83], v[128:131]
  v_exp_f32 v88, v88
  v_mfma_f32_16x16x32_bf16 v[132:135], a[180:183], v[80:83], v[132:135]
  v_exp_f32 v89, v89
  v_mfma_f32_16x16x32_bf16 v[136:139], a[184:187], v[80:83], v[136:139]
  v_exp_f32 v90, v90
  v_mfma_f32_16x16x32_bf16 v[140:143], a[188:191], v[80:83], v[140:143]
  v_exp_f32 v91, v91
  v_mfma_f32_16x16x32_bf16 v[144:147], a[192:195], v[80:83], v[144:147]
  v_exp_f32 v92, v92
  v_mfma_f32_16x16x32_bf16 v[148:151], a[196:199], v[80:83], v[148:151]
  v_exp_f32 v93, v93
  v_mfma_f32_16x16x32_bf16 v[152:155], a[200:203], v[80:83], v[152:155]
  v_exp_f32 v94, v94
  v_mfma_f32_16x16x32_bf16 v[156:159], a[204:207], v[80:83], v[156:159]
  v_exp_f32 v95, v95
  v_mfma_f32_16x16x32_bf16 v[80:83], a[112:115], a[48:51], 0
  v_add_f32 v74, v74, v88
  v_mfma_f32_16x16x32_bf16 v[80:83], a[116:119], a[52:55], v[80:83]
  v_add_f32 v74, v74, v89
  v_add_f32 v74, v74, v90
  v_mfma_f32_16x16x32_bf16 v[80:83], a[120:123], a[56:59], v[80:83]
  v_add_f32 v74, v74, v91
  v_mfma_f32_16x16x32_bf16 v[80:83], a[124:127], a[60:63], v[80:83]
  v_cvt_pk_bf16_f32 v88, v88, v89
  v_cvt_pk_bf16_f32 v89, v90, v91
  v_mfma_f32_16x16x32_bf16 v[84:87], a[128:131], a[48:51], 0
  v_cvt_pk_bf16_f32 v90, v92, v93
  v_mfma_f32_16x16x32_bf16 v[84:87], a[132:135], a[52:55], v[84:87]
  v_cvt_pk_bf16_f32 v91, v94, v95
  v_add_f32 v74, v74, v92
  v_mfma_f32_16x16x32_bf16 v[84:87], a[136:139], a[56:59], v[84:87]
  v_add_f32 v74, v74, v93
  v_mfma_f32_16x16x32_bf16 v[84:87], a[140:143], a[60:63], v[84:87]
  v_add_f32 v74, v74, v94
  v_add_f32 v74, v74, v95
  v_mfma_f32_16x16x32_bf16 v[160:163], a[176:179], v[88:91], v[160:163]
  v_exp_f32 v80, v80
  v_mfma_f32_16x16x32_bf16 v[164:167], a[180:183], v[88:91], v[164:167]
  v_exp_f32 v81, v81
  v_mfma_f32_16x16x32_bf16 v[168:171], a[184:187], v[88:91], v[168:171]
  v_exp_f32 v82, v82
  v_mfma_f32_16x16x32_bf16 v[172:175], a[188:191], v[88:91], v[172:175]
  v_exp_f32 v83, v83
  v_mfma_f32_16x16x32_bf16 v[176:179], a[192:195], v[88:91], v[176:179]
  v_exp_f32 v84, v84
  v_mfma_f32_16x16x32_bf16 v[180:183], a[196:199], v[88:91], v[180:183]
  v_exp_f32 v85, v85
  v_mfma_f32_16x16x32_bf16 v[184:187], a[200:203], v[88:91], v[184:187]
  v_exp_f32 v86, v86
  v_mfma_f32_16x16x32_bf16 v[188:191], a[204:207], v[88:91], v[188:191]
  v_exp_f32 v87, v87
  v_mfma_f32_16x16x32_bf16 v[88:91], a[112:115], a[64:67], 0
  v_add_f32 v75, v75, v80
  v_mfma_f32_16x16x32_bf16 v[88:91], a[116:119], a[68:71], v[88:91]
  v_add_f32 v75, v75, v81
  v_add_f32 v75, v75, v82
  v_mfma_f32_16x16x32_bf16 v[88:91], a[120:123], a[72:75], v[88:91]
  v_add_f32 v75, v75, v83
  v_mfma_f32_16x16x32_bf16 v[88:91], a[124:127], a[76:79], v[88:91]
  v_cvt_pk_bf16_f32 v80, v80, v81
  v_cvt_pk_bf16_f32 v81, v82, v83
  v_mfma_f32_16x16x32_bf16 v[92:95], a[128:131], a[64:67], 0
  v_cvt_pk_bf16_f32 v82, v84, v85
  v_mfma_f32_16x16x32_bf16 v[92:95], a[132:135], a[68:71], v[92:95]
  v_cvt_pk_bf16_f32 v83, v86, v87
  v_add_f32 v75, v75, v84
  v_mfma_f32_16x16x32_bf16 v[92:95], a[136:139], a[72:75], v[92:95]
  v_add_f32 v75, v75, v85
  v_mfma_f32_16x16x32_bf16 v[92:95], a[140:143], a[76:79], v[92:95]
  v_add_f32 v75, v75, v86
  v_add_f32 v75, v75, v87
  v_mfma_f32_16x16x32_bf16 v[192:195], a[176:179], v[80:83], v[192:195]
  v_exp_f32 v88, v88
  v_mfma_f32_16x16x32_bf16 v[196:199], a[180:183], v[80:83], v[196:199]
  v_exp_f32 v89, v89
  v_mfma_f32_16x16x32_bf16 v[200:203], a[184:187], v[80:83], v[200:203]
  v_exp_f32 v90, v90
  v_mfma_f32_16x16x32_bf16 v[204:207], a[188:191], v[80:83], v[204:207]
  v_exp_f32 v91, v91
  v_mfma_f32_16x16x32_bf16 v[208:211], a[192:195], v[80:83], v[208:211]
  v_exp_f32 v92, v92
  v_mfma_f32_16x16x32_bf16 v[212:215], a[196:199], v[80:83], v[212:215]
  v_exp_f32 v93, v93
  v_mfma_f32_16x16x32_bf16 v[216:219], a[200:203], v[80:83], v[216:219]
  v_exp_f32 v94, v94
  v_mfma_f32_16x16x32_bf16 v[220:223], a[204:207], v[80:83], v[220:223]
  v_exp_f32 v95, v95
  s_nop 0
  v_add_f32 v76, v76, v88
  v_add_f32 v76, v76, v89
  v_add_f32 v76, v76, v90
  v_add_f32 v76, v76, v91
  v_cvt_pk_bf16_f32 v88, v88, v89
  v_cvt_pk_bf16_f32 v89, v90, v91
  v_cvt_pk_bf16_f32 v90, v92, v93
  v_cvt_pk_bf16_f32 v91, v94, v95
  v_add_f32 v76, v76, v92
  v_add_f32 v76, v76, v93
  v_add_f32 v76, v76, v94
  v_add_f32 v76, v76, v95
  v_mfma_f32_16x16x32_bf16 v[224:227], a[176:179], v[88:91], v[224:227]
  v_mov_b32 v1, v72
  v_mov_b32 v2, v73
  v_mov_b32 v3, v74
  v_mov_b32 v4, v75
  v_mov_b32 v5, v76
  v_mfma_f32_16x16x32_bf16 v[228:231], a[180:183], v[88:91], v[228:231]
  s_nop 1
  v_permlane32_swap_b32 v1, v72
  v_permlane32_swap_b32 v2, v73
  v_permlane32_swap_b32 v3, v74
  v_permlane32_swap_b32 v4, v75
  v_mfma_f32_16x16x32_bf16 v[232:235], a[184:187], v[88:91], v[232:235]
  v_permlane32_swap_b32 v5, v76
  s_nop 1
  v_add_f32 v72, v72, v1
  v_add_f32 v73, v73, v2
  v_add_f32 v74, v74, v3
  v_mfma_f32_16x16x32_bf16 v[236:239], a[188:191], v[88:91], v[236:239]
  v_add_f32 v75, v75, v4
  v_add_f32 v76, v76, v5
  v_mov_b32 v1, v72
  v_mov_b32 v2, v73
  v_mov_b32 v3, v74
  v_mfma_f32_16x16x32_bf16 v[240:243], a[192:195], v[88:91], v[240:243]
  v_mov_b32 v4, v75
  v_mov_b32 v5, v76
  s_nop 1
  v_permlane16_swap_b32 v1, v72
  v_permlane16_swap_b32 v2, v73
  v_mfma_f32_16x16x32_bf16 v[244:247], a[196:199], v[88:91], v[244:247]
  v_permlane16_swap_b32 v3, v74
  v_permlane16_swap_b32 v4, v75
  v_permlane16_swap_b32 v5, v76
  s_nop 1
  v_add_f32 v72, v72, v1
  v_mfma_f32_16x16x32_bf16 v[248:251], a[200:203], v[88:91], v[248:251]
  v_add_f32 v73, v73, v2
  v_add_f32 v74, v74, v3
  v_add_f32 v75, v75, v4
  v_add_f32 v76, v76, v5
  v_mfma_f32_16x16x32_bf16 v[252:255], a[204:207], v[88:91], v[252:255]
L_eb:
  v_mov_b32 v6, v72
  v_mov_b32 v7, v72
  v_min_u32 v6, v6, v73
  v_max_u32 v7, v7, v73
  v_min_u32 v6, v6, v74
  v_max_u32 v7, v7, v74
  v_min_u32 v6, v6, v75
  v_max_u32 v7, v7, v75
  v_min_u32 v6, v6, v76
  v_max_u32 v7, v7, v76
  v_cmp_gt_u32 vcc, 0x35800000, v6
  v_cmp_lt_u32 s[80:81], s51, v7
  s_nop 1
  s_or_b64 vcc, vcc, s[80:81]
  s_cbranch_vccz L_okb
  v_mov_b32 v6, 163836
  v_mov_b32 v7, 1
  ds_write_b32 v6, v7
L_okb:
  v_rcp_f32 v72, v72
  v_rcp_f32 v73, v73
  v_rcp_f32 v74, v74
  v_rcp_f32 v75, v75
  v_rcp_f32 v76, v76
  s_nop 0
  v_pk_mul_f32 v[96:97], v[96:97], v[72:73] op_sel:[0,0] op_sel_hi:[1,0]
  v_pk_mul_f32 v[98:99], v[98:99], v[72:73] op_sel:[0,0] op_sel_hi:[1,0]
  v_pk_mul_f32 v[100:101], v[100:101], v[72:73] op_sel:[0,0] op_sel_hi:[1,0]
  v_pk_mul_f32 v[102:103], v[102:103], v[72:73] op_sel:[0,0] op_sel_hi:[1,0]
  v_cvt_pk_bf16_f32 v8, v96, v97
  v_cvt_pk_bf16_f32 v9, v98, v99
  v_cvt_pk_bf16_f32 v10, v100, v101
  v_cvt_pk_bf16_f32 v11, v102, v103
  ds_write_b128 v49, v[8:11] offset:0
  s_add_u32 s38, s50, 0
  s_nop 0
  buffer_store_dwordx4 v[8:11], v52, s[24:27], s38 offen offset:0 sc1
  v_pk_mov_b32 v[96:97], 0, 0
  v_pk_mov_b32 v[98:99], 0, 0
  v_pk_mov_b32 v[100:101], 0, 0
  v_pk_mov_b32 v[102:103], 0, 0
  v_pk_mul_f32 v[104:105], v[104:105], v[72:73] op_sel:[0,0] op_sel_hi:[1,0]
  v_pk_mul_f32 v[106:107], v[106:107], v[72:73] op_sel:[0,0] op_sel_hi:[1,0]
  v_pk_mul_f32 v[108:109], v[108:109], v[72:73] op_sel:[0,0] op_sel_hi:[1,0]
  v_pk_mul_f32 v[110:111], v[110:111], v[72:73] op_sel:[0,0] op_sel_hi:[1,0]
  v_cvt_pk_bf16_f32 v12, v104, v105
  v_cvt_pk_bf16_f32 v13, v106, v107
  v_cvt_pk_bf16_f32 v14, v108, v109
  v_cvt_pk_bf16_f32 v15, v110, v111
  ds_write_b128 v49, v[12:15] offset:9216
  s_add_u32 s38, s50, 9216
  s_nop 0
  buffer_store_dwordx4 v[12:15], v52, s[24:27], s38 offen offset:0 sc1
  v_pk_mov_b32 v[104:105], 0, 0
  v_pk_mov_b32 v[106:107], 0, 0
  v_pk_mov_b32 v[108:109], 0, 0
  v_pk_mov_b32 v[110:111], 0, 0
  v_pk_mul_f32 v[128:129], v[128:129], v[72:73] op_sel:[0,1] op_sel_hi:[1,1]
  v_pk_mul_f32 v[130:131], v[130:131], v[72:73] op_sel:[0,1] op_sel_hi:[1,1]
  v_pk_mul_f32 v[132:133], v[132:133], v[72:73] op_sel:[0,1] op_sel_hi:[1,1]
  v_pk_mul_f32 v[134:135], v[134:135], v[72:73] op_sel:[0,1] op_sel_hi:[1,1]
  v_cvt_pk_bf16_f32 v80, v128, v129
  v_cvt_pk_bf16_f32 v81, v130, v131
  v_cvt_pk_bf16_f32 v82, v132, v133
  v_cvt_pk_bf16_f32 v83, v134, v135
  ds_write_b128 v49, v[80:83] offset:1024
  s_add_u32 s38, s50, 0
  s_nop 0
  buffer_store_dwordx4 v[80:83], v52, s[24:27], s38 offen offset:1024 sc1
  v_pk_mov_b32 v[128:129], 0, 0
  v_pk_mov_b32 v[130:131], 0, 0
  v_pk_mov_b32 v[132:133], 0, 0
  v_pk_mov_b32 v[134:135], 0, 0
  v_pk_mul_f32 v[136:137], v[136:137], v[72:73] op_sel:[0,1] op_sel_hi:[1,1]
  v_pk_mul_f32 v[138:139], v[138:139], v[72:73] op_sel:[0,1] op_sel_hi:[1,1]
  v_pk_mul_f32 v[140:141], v[140:141], v[72:73] op_sel:[0,1] op_sel_hi:[1,1]
  v_pk_mul_f32 v[142:143], v[142:143], v[72:73] op_sel:[0,1] op_sel_hi:[1,1]
  v_cvt_pk_bf16_f32 v84, v136, v137
  v_cvt_pk_bf16_f32 v85, v138, v139
  v_cvt_pk_bf16_f32 v86, v140, v141
  v_cvt_pk_bf16_f32 v87, v142, v143
  ds_write_b128 v49, v[84:87] offset:10240
  s_add_u32 s38, s50, 9216
  s_nop 0
  buffer_store_dwordx4 v[84:87], v52, s[24:27], s38 offen offset:1024 sc1
  v_pk_mov_b32 v[136:137], 0, 0
  v_pk_mov_b32 v[138:139], 0, 0
  v_pk_mov_b32 v[140:141], 0, 0
  v_pk_mov_b32 v[142:143], 0, 0
  v_pk_mul_f32 v[160:161], v[160:161], v[74:75] op_sel:[0,0] op_sel_hi:[1,0]
  v_pk_mul_f32 v[162:163], v[162:163], v[74:75] op_sel:[0,0] op_sel_hi:[1,0]
  v_pk_mul_f32 v[164:165], v[164:165], v[74:75] op_sel:[0,0] op_sel_hi:[1,0]
  v_pk_mul_f32 v[166:167], v[166:167], v[74:75] op_sel:[0,0] op_sel_hi:[1,0]
  v_cvt_pk_bf16_f32 v8, v160, v161
  v_cvt_pk_bf16_f32 v9, v162, v163
  v_cvt_pk_bf16_f32 v10, v164, v165
  v_cvt_pk_bf16_f32 v11, v166, v167
  ds_write_b128 v49, v[8:11] offset:2048
  s_add_u32 s38, s50, 0
  s_nop 0
  buffer_store_dwordx4 v[8:11], v52, s[24:27], s38 offen offset:2048 sc1
  v_pk_mov_b32 v[160:161], 0, 0
  v_pk_mov_b32 v[162:163], 0, 0
  v_pk_mov_b32 v[164:165], 0, 0
  v_pk_mov_b32 v[166:167], 0, 0
  v_pk_mul_f32 v[168:169], v[168:169], v[74:75] op_sel:[0,0] op_sel_hi:[1,0]
  v_pk_mul_f32 v[170:171], v[170:171], v[74:75] op_sel:[0,0] op_sel_hi:[1,0]
  v_pk_mul_f32 v[172:173], v[172:173], v[74:75] op_sel:[0,0] op_sel_hi:[1,0]
  v_pk_mul_f32 v[174:175], v[174:175], v[74:75] op_sel:[0,0] op_sel_hi:[1,0]
  v_cvt_pk_bf16_f32 v12, v168, v169
  v_cvt_pk_bf16_f32 v13, v170, v171
  v_cvt_pk_bf16_f32 v14, v172, v173
  v_cvt_pk_bf16_f32 v15, v174, v175
  ds_write_b128 v49, v[12:15] offset:11264
  s_add_u32 s38, s50, 9216
  s_nop 0
  buffer_store_dwordx4 v[12:15], v52, s[24:27], s38 offen offset:2048 sc1
  v_pk_mov_b32 v[168:169], 0, 0
  v_pk_mov_b32 v[170:171], 0, 0
  v_pk_mov_b32 v[172:173], 0, 0
  v_pk_mov_b32 v[174:175], 0, 0
  v_pk_mul_f32 v[192:193], v[192:193], v[74:75] op_sel:[0,1] op_sel_hi:[1,1]
  v_pk_mul_f32 v[194:195], v[194:195], v[74:75] op_sel:[0,1] op_sel_hi:[1,1]
  v_pk_mul_f32 v[196:197], v[196:197], v[74:75] op_sel:[0,1] op_sel_hi:[1,1]
  v_pk_mul_f32 v[198:199], v[198:199], v[74:75] op_sel:[0,1] op_sel_hi:[1,1]
  v_cvt_pk_bf16_f32 v80, v192, v193
  v_cvt_pk_bf16_f32 v81, v194, v195
  v_cvt_pk_bf16_f32 v82, v196, v197
  v_cvt_pk_bf16_f32 v83, v198, v199
  ds_write_b128 v49, v[80:83] offset:3072
  s_add_u32 s38, s50, 0
  s_nop 0
  buffer_store_dwordx4 v[80:83], v52, s[24:27], s38 offen offset:3072 sc1
  v_pk_mul_f32 v[200:201], v[200:201], v[74:75] op_sel:[0,1] op_sel_hi:[1,1]
  v_pk_mul_f32 v[202:203], v[202:203], v[74:75] op_sel:[0,1] op_sel_hi:[1,1]
  v_pk_mul_f32 v[204:205], v[204:205], v[74:75] op_sel:[0,1] op_sel_hi:[1,1]
  v_pk_mul_f32 v[206:207], v[206:207], v[74:75] op_sel:[0,1] op_sel_hi:[1,1]
  v_cvt_pk_bf16_f32 v84, v200, v201
  v_cvt_pk_bf16_f32 v85, v202, v203
  v_cvt_pk_bf16_f32 v86, v204, v205
  v_cvt_pk_bf16_f32 v87, v206, v207
  ds_write_b128 v49, v[84:87] offset:12288
  s_add_u32 s38, s50, 9216
  s_nop 0
  buffer_store_dwordx4 v[84:87], v52, s[24:27], s38 offen offset:3072 sc1
  v_pk_mul_f32 v[224:225], v[224:225], v[76:77] op_sel:[0,0] op_sel_hi:[1,0]
  v_pk_mul_f32 v[226:227], v[226:227], v[76:77] op_sel:[0,0] op_sel_hi:[1,0]
  v_pk_mul_f32 v[228:229], v[228:229], v[76:77] op_sel:[0,0] op_sel_hi:[1,0]
  v_pk_mul_f32 v[230:231], v[230:231], v[76:77] op_sel:[0,0] op_sel_hi:[1,0]
  v_cvt_pk_bf16_f32 v8, v224, v225
  v_cvt_pk_bf16_f32 v9, v226, v227
  v_cvt_pk_bf16_f32 v10, v228, v229
  v_cvt_pk_bf16_f32 v11, v230, v231
  ds_write_b128 v49, v[8:11] offset:4096
  s_add_u32 s38, s50, 4096
  s_nop 0
  buffer_store_dwordx4 v[8:11], v52, s[24:27], s38 offen offset:0 sc1
  v_pk_mul_f32 v[232:233], v[232:233], v[76:77] op_sel:[0,0] op_sel_hi:[1,0]
  v_pk_mul_f32 v[234:235], v[234:235], v[76:77] op_sel:[0,0] op_sel_hi:[1,0]
  v_pk_mul_f32 v[236:237], v[236:237], v[76:77] op_sel:[0,0] op_sel_hi:[1,0]
  v_pk_mul_f32 v[238:239], v[238:239], v[76:77] op_sel:[0,0] op_sel_hi:[1,0]
  v_cvt_pk_bf16_f32 v12, v232, v233
  v_cvt_pk_bf16_f32 v13, v234, v235
  v_cvt_pk_bf16_f32 v14, v236, v237
  v_cvt_pk_bf16_f32 v15, v238, v239
  ds_write_b128 v49, v[12:15] offset:13312
  s_add_u32 s38, s50, 13312
  s_nop 0
  buffer_store_dwordx4 v[12:15], v52, s[24:27], s38 offen offset:0 sc1
  v_pk_mul_f32 v[112:113], v[112:113], v[72:73] op_sel:[0,0] op_sel_hi:[1,0]
  v_pk_mul_f32 v[114:115], v[114:115], v[72:73] op_sel:[0,0] op_sel_hi:[1,0]
  v_pk_mul_f32 v[116:117], v[116:117], v[72:73] op_sel:[0,0] op_sel_hi:[1,0]
  v_pk_mul_f32 v[118:119], v[118:119], v[72:73] op_sel:[0,0] op_sel_hi:[1,0]
  v_cvt_pk_bf16_f32 v80, v112, v113
  v_cvt_pk_bf16_f32 v81, v114, v115
  v_cvt_pk_bf16_f32 v82, v116, v117
  v_cvt_pk_bf16_f32 v83, v118, v119
  ds_write_b128 v49, v[80:83] offset:36864
  s_add_u32 s38, s50, 18432
  s_nop 0
  buffer_store_dwordx4 v[80:83], v52, s[24:27], s38 offen offset:0 sc1
  v_pk_mov_b32 v[112:113], 0, 0
  v_pk_mov_b32 v[114:115], 0, 0
  v_pk_mov_b32 v[116:117], 0, 0
  v_pk_mov_b32 v[118:119], 0, 0
  v_pk_mul_f32 v[120:121], v[120:121], v[72:73] op_sel:[0,0] op_sel_hi:[1,0]
  v_pk_mul_f32 v[122:123], v[122:123], v[72:73] op_sel:[0,0] op_sel_hi:[1,0]
  v_pk_mul_f32 v[124:125], v[124:125], v[72:73] op_sel:[0,0] op_sel_hi:[1,0]
  v_pk_mul_f32 v[126:127], v[126:127], v[72:73] op_sel:[0,0] op_sel_hi:[1,0]
  v_cvt_pk_bf16_f32 v84, v120, v121
  v_cvt_pk_bf16_f32 v85, v122, v123
  v_cvt_pk_bf16_f32 v86, v124, v125
  v_cvt_pk_bf16_f32 v87, v126, v127
  ds_write_b128 v49, v[84:87] offset:46080
  s_add_u32 s38, s50, 27648
  s_nop 0
  buffer_store_dwordx4 v[84:87], v52, s[24:27], s38 offen offset:0 sc1
  v_pk_mov_b32 v[120:121], 0, 0
  v_pk_mov_b32 v[122:123], 0, 0
  v_pk_mov_b32 v[124:125], 0, 0
  v_pk_mov_b32 v[126:127], 0, 0
  v_pk_mul_f32 v[144:145], v[144:145], v[72:73] op_sel:[0,1] op_sel_hi:[1,1]
  v_pk_mul_f32 v[146:147], v[146:147], v[72:73] op_sel:[0,1] op_sel_hi:[1,1]
  v_pk_mul_f32 v[148:149], v[148:149], v[72:73] op_sel:[0,1] op_sel_hi:[1,1]
  v_pk_mul_f32 v[150:151], v[150:151], v[72:73] op_sel:[0,1] op_sel_hi:[1,1]
  v_cvt_pk_bf16_f32 v8, v144, v145
  v_cvt_pk_bf16_f32 v9, v146, v147
  v_cvt_pk_bf16_f32 v10, v148, v149
  v_cvt_pk_bf16_f32 v11, v150, v151
  ds_write_b128 v49, v[8:11] offset:37888
  s_add_u32 s38, s50, 18432
  s_nop 0
  buffer_store_dwordx4 v[8:11], v52, s[24:27], s38 offen offset:1024 sc1
  v_pk_mov_b32 v[144:145], 0, 0
  v_pk_mov_b32 v[146:147], 0, 0
  v_pk_mov_b32 v[148:149], 0, 0
  v_pk_mov_b32 v[150:151], 0, 0
  v_pk_mul_f32 v[152:153], v[152:153], v[72:73] op_sel:[0,1] op_sel_hi:[1,1]
  v_pk_mul_f32 v[154:155], v[154:155], v[72:73] op_sel:[0,1] op_sel_hi:[1,1]
  v_pk_mul_f32 v[156:157], v[156:157], v[72:73] op_sel:[0,1] op_sel_hi:[1,1]
  v_pk_mul_f32 v[158:159], v[158:159], v[72:73] op_sel:[0,1] op_sel_hi:[1,1]
  v_cvt_pk_bf16_f32 v12, v152, v153
  v_cvt_pk_bf16_f32 v13, v154, v155
  v_cvt_pk_bf16_f32 v14, v156, v157
  v_cvt_pk_bf16_f32 v15, v158, v159
  ds_write_b128 v49, v[12:15] offset:47104
  s_add_u32 s38, s50, 27648
  s_nop 0
  buffer_store_dwordx4 v[12:15], v52, s[24:27], s38 offen offset:1024 sc1
  v_pk_mov_b32 v[152:153], 0, 0
  v_pk_mov_b32 v[154:155], 0, 0
  v_pk_mov_b32 v[156:157], 0, 0
  v_pk_mov_b32 v[158:159], 0, 0
  v_pk_mul_f32 v[176:177], v[176:177], v[74:75] op_sel:[0,0] op_sel_hi:[1,0]
  v_pk_mul_f32 v[178:179], v[178:179], v[74:75] op_sel:[0,0] op_sel_hi:[1,0]
  v_pk_mul_f32 v[180:181], v[180:181], v[74:75] op_sel:[0,0] op_sel_hi:[1,0]
  v_pk_mul_f32 v[182:183], v[182:183], v[74:75] op_sel:[0,0] op_sel_hi:[1,0]
  v_cvt_pk_bf16_f32 v80, v176, v177
  v_cvt_pk_bf16_f32 v81, v178, v179
  v_cvt_pk_bf16_f32 v82, v180, v181
  v_cvt_pk_bf16_f32 v83, v182, v183
  ds_write_b128 v49, v[80:83] offset:38912
  s_add_u32 s38, s50, 18432
  s_nop 0
  buffer_store_dwordx4 v[80:83], v52, s[24:27], s38 offen offset:2048 sc1
  v_pk_mov_b32 v[176:177], 0, 0
  v_pk_mov_b32 v[178:179], 0, 0
  v_pk_mul_f32 v[184:185], v[184:185], v[74:75] op_sel:[0,0] op_sel_hi:[1,0]
  v_pk_mul_f32 v[186:187], v[186:187], v[74:75] op_sel:[0,0] op_sel_hi:[1,0]
  v_pk_mul_f32 v[188:189], v[188:189], v[74:75] op_sel:[0,0] op_sel_hi:[1,0]
  v_pk_mul_f32 v[190:191], v[190:191], v[74:75] op_sel:[0,0] op_sel_hi:[1,0]
  v_cvt_pk_bf16_f32 v84, v184, v185
  v_cvt_pk_bf16_f32 v85, v186, v187
  v_cvt_pk_bf16_f32 v86, v188, v189
  v_cvt_pk_bf16_f32 v87, v190, v191
  ds_write_b128 v49, v[84:87] offset:48128
  s_add_u32 s38, s50, 27648
  s_nop 0
  buffer_store_dwordx4 v[84:87], v52, s[24:27], s38 offen offset:2048 sc1
  v_pk_mul_f32 v[208:209], v[208:209], v[74:75] op_sel:[0,1] op_sel_hi:[1,1]
  v_pk_mul_f32 v[210:211], v[210:211], v[74:75] op_sel:[0,1] op_sel_hi:[1,1]
  v_pk_mul_f32 v[212:213], v[212:213], v[74:75] op_sel:[0,1] op_sel_hi:[1,1]
  v_pk_mul_f32 v[214:215], v[214:215], v[74:75] op_sel:[0,1] op_sel_hi:[1,1]
  v_cvt_pk_bf16_f32 v8, v208, v209
  v_cvt_pk_bf16_f32 v9, v210, v211
  v_cvt_pk_bf16_f32 v10, v212, v213
  v_cvt_pk_bf16_f32 v11, v214, v215
  ds_write_b128 v49, v[8:11] offset:39936
  s_add_u32 s38, s50, 18432
  s_nop 0
  buffer_store_dwordx4 v[8:11], v52, s[24:27], s38 offen offset:3072 sc1
  v_pk_mul_f32 v[216:217], v[216:217], v[74:75] op_sel:[0,1] op_sel_hi:[1,1]
  v_pk_mul_f32 v[218:219], v[218:219], v[74:75] op_sel:[0,1] op_sel_hi:[1,1]
  v_pk_mul_f32 v[220:221], v[220:221], v[74:75] op_sel:[0,1] op_sel_hi:[1,1]
  v_pk_mul_f32 v[222:223], v[222:223], v[74:75] op_sel:[0,1] op_sel_hi:[1,1]
  v_cvt_pk_bf16_f32 v12, v216, v217
  v_cvt_pk_bf16_f32 v13, v218, v219
  v_cvt_pk_bf16_f32 v14, v220, v221
  v_cvt_pk_bf16_f32 v15, v222, v223
  ds_write_b128 v49, v[12:15] offset:49152
  s_add_u32 s38, s50, 27648
  s_nop 0
  buffer_store_dwordx4 v[12:15], v52, s[24:27], s38 offen offset:3072 sc1
  v_pk_mul_f32 v[240:241], v[240:241], v[76:77] op_sel:[0,0] op_sel_hi:[1,0]
  v_pk_mul_f32 v[242:243], v[242:243], v[76:77] op_sel:[0,0] op_sel_hi:[1,0]
  v_pk_mul_f32 v[244:245], v[244:245], v[76:77] op_sel:[0,0] op_sel_hi:[1,0]
  v_pk_mul_f32 v[246:247], v[246:247], v[76:77] op_sel:[0,0] op_sel_hi:[1,0]
  v_cvt_pk_bf16_f32 v80, v240, v241
  v_cvt_pk_bf16_f32 v81, v242, v243
  v_cvt_pk_bf16_f32 v82, v244, v245
  v_cvt_pk_bf16_f32 v83, v246, v247
  ds_write_b128 v49, v[80:83] offset:40960
  s_add_u32 s38, s50, 22528
  s_nop 0
  buffer_store_dwordx4 v[80:83], v52, s[24:27], s38 offen offset:0 sc1
  v_pk_mul_f32 v[248:249], v[248:249], v[76:77] op_sel:[0,0] op_sel_hi:[1,0]
  v_pk_mul_f32 v[250:251], v[250:251], v[76:77] op_sel:[0,0] op_sel_hi:[1,0]
  v_pk_mul_f32 v[252:253], v[252:253], v[76:77] op_sel:[0,0] op_sel_hi:[1,0]
  v_pk_mul_f32 v[254:255], v[254:255], v[76:77] op_sel:[0,0] op_sel_hi:[1,0]
  v_cvt_pk_bf16_f32 v84, v248, v249
  v_cvt_pk_bf16_f32 v85, v250, v251
  v_cvt_pk_bf16_f32 v86, v252, v253
  v_cvt_pk_bf16_f32 v87, v254, v255
  ds_write_b128 v49, v[84:87] offset:50176
  s_add_u32 s38, s50, 31744
  s_nop 0
  buffer_store_dwordx4 v[84:87], v52, s[24:27], s38 offen offset:0 sc1
  s_mov_b32 s63, 0
  s_mov_b32 s67, 0
  s_mov_b32 s72, 36864
  s_mov_b32 s73, -110592
  s_mov_b32 s74, 36864
  s_mov_b32 s75, 196608
  s_mov_b32 m0, 196608
  s_mov_b32 s76, 1073741824
  s_mov_b32 s62, s77
  v_mov_b32 v1, 163836
  s_lshr_b32 s38, s2, 5
  s_lshl_b32 s38, s38, 3
  s_add_u32 s38, s38, s3
  s_lshl_b32 s38, s38, 8
  s_add_u32 s38, s38, 50331648
  s_add_u32 s80, s82, s38
  s_addc_u32 s81, s83, 0
  s_lshl_b32 s38, s4, 2
  v_mov_b32 v47, s38
  v_mov_b32 v48, s31
  s_mov_b32 s33, 0
  s_mov_b32 s32, 975
  s_cmp_eq_u32 s28, 0
  s_cselect_b32 s53, 8, 0
  s_add_u32 s64, s50, 18432
  s_add_u32 s65, s50, 27648
  s_add_u32 s66, s50, 22528
  s_add_u32 s61, s50, 31744
  s_mov_b32 s35, 1007
  s_mov_b64 s[40:41], 0
  s_waitcnt lgkmcnt(0)
  s_waitcnt vmcnt(10)
  s_branch L_gemm
L_tagb:
  s_memrealtime s[80:81]
  v_mov_b32 v1, 0
  v_mov_b32 v3, 0
  s_waitcnt lgkmcnt(0)
  s_or_b32 s80, s80, 1
  v_mov_b32 v2, s80
  s_mov_b64 exec, 1
  global_atomic_cmpswap v4, v1, v[2:3], s[6:7] sc0 sc1
  s_waitcnt vmcnt(0)
  s_mov_b64 exec, -1
  v_readfirstlane_b32 s31, v4
  s_nop 1
  s_cmp_eq_u32 s31, 0
  s_cselect_b32 s31, s80, s31
  s_branch L_tagbb
L_redob:
  s_waitcnt vmcnt(0) lgkmcnt(0)
  s_barrier
  v_mov_b32 v6, 163836
  v_mov_b32 v7, 0
  ds_write_b32 v6, v7
  v_and_b32 v60, 0xffff, v60
  v_and_b32 v61, 0xffff, v61
  v_and_b32 v62, 0xffff, v62
  v_and_b32 v63, 0xffff, v63
  v_and_b32 v64, 0xffff, v64
  v_and_b32 v65, 0xffff, v65
  v_and_b32 v66, 0xffff, v66
  v_and_b32 v67, 0xffff, v67
  v_and_b32 v68, 0xffff, v68
  v_and_b32 v69, 0xffff, v69
  v_and_b32 v70, 0xffff, v70
  v_and_b32 v71, 0xffff, v71
  v_mov_b32 v72, 0xff800000
  v_mov_b32 v73, 0xff800000
  v_mov_b32 v74, 0xff800000
  v_mov_b32 v75, 0xff800000
  v_mov_b32 v76, 0xff800000
  s_mov_b32 s43, 0
L_r0b:
  s_waitcnt vmcnt(0)
  s_barrier
  ds_read_b128 a[80:83], v60 offset:0
  ds_read_b128 a[84:87], v61 offset:0
  ds_read_b128 a[88:91], v62 offset:0
  ds_read_b128 a[92:95], v63 offset:0
  ds_read_b128 a[96:99], v60 offset:4096
  ds_read_b128 a[100:103], v61 offset:4096
  ds_read_b128 a[104:107], v62 offset:4096
  ds_read_b128 a[108:111], v63 offset:4096
  s_waitcnt lgkmcnt(0)
  s_barrier
  v_mfma_f32_16x16x32_bf16 v[80:83], a[80:83], a[0:3], 0
  v_mfma_f32_16x16x32_bf16 v[80:83], a[84:87], a[4:7], v[80:83]
  v_mfma_f32_16x16x32_bf16 v[80:83], a[88:91], a[8:11], v[80:83]
  v_mfma_f32_16x16x32_bf16 v[80:83], a[92:95], a[12:15], v[80:83]
  v_mfma_f32_16x16x32_bf16 v[84:87], a[96:99], a[0:3], 0
  v_mfma_f32_16x16x32_bf16 v[84:87], a[100:103], a[4:7], v[84:87]
  v_mfma_f32_16x16x32_bf16 v[84:87], a[104:107], a[8:11], v[84:87]
  v_mfma_f32_16x16x32_bf16 v[84:87], a[108:111], a[12:15], v[84:87]
  s_nop 7
  v_max3_f32 v72, v72, v80, v81
  v_max3_f32 v72, v72, v82, v83
  v_max3_f32 v72, v72, v84, v85
  v_max3_f32 v72, v72, v86, v87
  v_mfma_f32_16x16x32_bf16 v[80:83], a[80:83], a[16:19], 0
  v_mfma_f32_16x16x32_bf16 v[80:83], a[84:87], a[20:23], v[80:83]
  v_mfma_f32_16x16x32_bf16 v[80:83], a[88:91], a[24:27], v[80:83]
  v_mfma_f32_16x16x32_bf16 v[80:83], a[92:95], a[28:31], v[80:83]
  v_mfma_f32_16x16x32_bf16 v[84:87], a[96:99], a[16:19], 0
  v_mfma_f32_16x16x32_bf16 v[84:87], a[100:103], a[20:23], v[84:87]
  v_mfma_f32_16x16x32_bf16 v[84:87], a[104:107], a[24:27], v[84:87]
  v_mfma_f32_16x16x32_bf16 v[84:87], a[108:111], a[28:31], v[84:87]
  s_nop 7
  v_max3_f32 v73, v73, v80, v81
  v_max3_f32 v73, v73, v82, v83
  v_max3_f32 v73, v73, v84, v85
  v_max3_f32 v73, v73, v86, v87
  v_mfma_f32_16x16x32_bf16 v[80:83], a[80:83], a[32:35], 0
  v_mfma_f32_16x16x32_bf16 v[80:83], a[84:87], a[36:39], v[80:83]
  v_mfma_f32_16x16x32_bf16 v[80:83], a[88:91], a[40:43], v[80:83]
  v_mfma_f32_16x16x32_bf16 v[80:83], a[92:95], a[44:47], v[80:83]
  v_mfma_f32_16x16x32_bf16 v[84:87], a[96:99], a[32:35], 0
  v_mfma_f32_16x16x32_bf16 v[84:87], a[100:103], a[36:39], v[84:87]
  v_mfma_f32_16x16x32_bf16 v[84:87], a[104:107], a[40:43], v[84:87]
  v_mfma_f32_16x16x32_bf16 v[84:87], a[108:111], a[44:47], v[84:87]
  s_nop 7
  v_max3_f32 v74, v74, v80, v81
  v_max3_f32 v74, v74, v82, v83
  v_max3_f32 v74, v74, v84, v85
  v_max3_f32 v74, v74, v86, v87
  v_mfma_f32_16x16x32_bf16 v[80:83], a[80:83], a[48:51], 0
  v_mfma_f32_16x16x32_bf16 v[80:83], a[84:87], a[52:55], v[80:83]
  v_mfma_f32_16x16x32_bf16 v[80:83], a[88:91], a[56:59], v[80:83]
  v_mfma_f32_16x16x32_bf16 v[80:83], a[92:95], a[60:63], v[80:83]
  v_mfma_f32_16x16x32_bf16 v[84:87], a[96:99], a[48:51], 0
  v_mfma_f32_16x16x32_bf16 v[84:87], a[100:103], a[52:55], v[84:87]
  v_mfma_f32_16x16x32_bf16 v[84:87], a[104:107], a[56:59], v[84:87]
  v_mfma_f32_16x16x32_bf16 v[84:87], a[108:111], a[60:63], v[84:87]
  s_nop 7
  v_max3_f32 v75, v75, v80, v81
  v_max3_f32 v75, v75, v82, v83
  v_max3_f32 v75, v75, v84, v85
  v_max3_f32 v75, v75, v86, v87
  v_mfma_f32_16x16x32_bf16 v[80:83], a[80:83], a[64:67], 0
  v_mfma_f32_16x16x32_bf16 v[80:83], a[84:87], a[68:71], v[80:83]
  v_mfma_f32_16x16x32_bf16 v[80:83], a[88:91], a[72:75], v[80:83]
  v_mfma_f32_16x16x32_bf16 v[80:83], a[92:95], a[76:79], v[80:83]
  v_mfma_f32_16x16x32_bf16 v[84:87], a[96:99], a[64:67], 0
  v_mfma_f32_16x16x32_bf16 v[84:87], a[100:103], a[68:71], v[84:87]
  v_mfma_f32_16x16x32_bf16 v[84:87], a[104:107], a[72:75], v[84:87]
  v_mfma_f32_16x16x32_bf16 v[84:87], a[108:111], a[76:79], v[84:87]
  s_nop 7
  v_max3_f32 v76, v76, v80, v81
  v_max3_f32 v76, v76, v82, v83
  v_max3_f32 v76, v76, v84, v85
  v_max3_f32 v76, v76, v86, v87
  s_add_u32 s43, s43, 8192
  s_cmp_lt_u32 s43, 131072
  s_cbranch_scc1 L_r0b
  v_mov_b32 v1, v72
  v_mov_b32 v2, v73
  v_mov_b32 v3, v74
  v_mov_b32 v4, v75
  v_mov_b32 v5, v76
  s_nop 1
  v_permlane32_swap_b32 v1, v72
  v_permlane32_swap_b32 v2, v73
  v_permlane32_swap_b32 v3, v74
  v_permlane32_swap_b32 v4, v75
  v_permlane32_swap_b32 v5, v76
  s_nop 1
  v_max_f32 v72, v72, v1
  v_max_f32 v73, v73, v2
  v_max_f32 v74, v74, v3
  v_max_f32 v75, v75, v4
  v_max_f32 v76, v76, v5
  v_mov_b32 v1, v72
  v_mov_b32 v2, v73
  v_mov_b32 v3, v74
  v_mov_b32 v4, v75
  v_mov_b32 v5, v76
  s_nop 1
  v_permlane16_swap_b32 v1, v72
  v_permlane16_swap_b32 v2, v73
  v_permlane16_swap_b32 v3, v74
  v_permlane16_swap_b32 v4, v75
  v_permlane16_swap_b32 v5, v76
  s_nop 1
  v_max_f32 v72, v72, v1
  v_max_f32 v73, v73, v2
  v_max_f32 v74, v74, v3
  v_max_f32 v75, v75, v4
  v_max_f32 v76, v76, v5
  v_sub_f32 v8, 0, v72
  v_sub_f32 v9, 0, v72
  v_sub_f32 v10, 0, v72
  v_sub_f32 v11, 0, v72
  v_mov_b32 v72, 0
  v_sub_f32 v12, 0, v73
  v_sub_f32 v13, 0, v73
  v_sub_f32 v14, 0, v73
  v_sub_f32 v15, 0, v73
  v_mov_b32 v73, 0
  v_sub_f32 v16, 0, v74
  v_sub_f32 v17, 0, v74
  v_sub_f32 v18, 0, v74
  v_sub_f32 v19, 0, v74
  v_mov_b32 v74, 0
  v_sub_f32 v20, 0, v75
  v_sub_f32 v21, 0, v75
  v_sub_f32 v22, 0, v75
  v_sub_f32 v23, 0, v75
  v_mov_b32 v75, 0
  v_sub_f32 v24, 0, v76
  v_sub_f32 v25, 0, v76
  v_sub_f32 v26, 0, v76
  v_sub_f32 v27, 0, v76
  v_mov_b32 v76, 0
  v_mov_b32 v96, 0
  v_mov_b32 v97, 0
  v_mov_b32 v98, 0
  v_mov_b32 v99, 0
  v_mov_b32 v100, 0
  v_mov_b32 v101, 0
  v_mov_b32 v102, 0
  v_mov_b32 v103, 0
  v_mov_b32 v104, 0
  v_mov_b32 v105, 0
  v_mov_b32 v106, 0
  v_mov_b32 v107, 0
  v_mov_b32 v108, 0
  v_mov_b32 v109, 0
  v_mov_b32 v110, 0
  v_mov_b32 v111, 0
  v_mov_b32 v112, 0
  v_mov_b32 v113, 0
  v_mov_b32 v114, 0
  v_mov_b32 v115, 0
  v_mov_b32 v116, 0
  v_mov_b32 v117, 0
  v_mov_b32 v118, 0
  v_mov_b32 v119, 0
  v_mov_b32 v120, 0
  v_mov_b32 v121, 0
  v_mov_b32 v122, 0
  v_mov_b32 v123, 0
  v_mov_b32 v124, 0
  v_mov_b32 v125, 0
  v_mov_b32 v126, 0
  v_mov_b32 v127, 0
  v_mov_b32 v128, 0
  v_mov_b32 v129, 0
  v_mov_b32 v130, 0
  v_mov_b32 v131, 0
  v_mov_b32 v132, 0
  v_mov_b32 v133, 0
  v_mov_b32 v134, 0
  v_mov_b32 v135, 0
  v_mov_b32 v136, 0
  v_mov_b32 v137, 0
  v_mov_b32 v138, 0
  v_mov_b32 v139, 0
  v_mov_b32 v140, 0
  v_mov_b32 v141, 0
  v_mov_b32 v142, 0
  v_mov_b32 v143, 0
  v_mov_b32 v144, 0
  v_mov_b32 v145, 0
  v_mov_b32 v146, 0
  v_mov_b32 v147, 0
  v_mov_b32 v148, 0
  v_mov_b32 v149, 0
  v_mov_b32 v150, 0
  v_mov_b32 v151, 0
  v_mov_b32 v152, 0
  v_mov_b32 v153, 0
  v_mov_b32 v154, 0
  v_mov_b32 v155, 0
  v_mov_b32 v156, 0
  v_mov_b32 v157, 0
  v_mov_b32 v158, 0
  v_mov_b32 v159, 0
  v_mov_b32 v160, 0
  v_mov_b32 v161, 0
  v_mov_b32 v162, 0
  v_mov_b32 v163, 0
  v_mov_b32 v164, 0
  v_mov_b32 v165, 0
  v_mov_b32 v166, 0
  v_mov_b32 v167, 0
  v_mov_b32 v168, 0
  v_mov_b32 v169, 0
  v_mov_b32 v170, 0
  v_mov_b32 v171, 0
  v_mov_b32 v172, 0
  v_mov_b32 v173, 0
  v_mov_b32 v174, 0
  v_mov_b32 v175, 0
  v_mov_b32 v176, 0
  v_mov_b32 v177, 0
  v_mov_b32 v178, 0
  v_mov_b32 v179, 0
  v_mov_b32 v180, 0
  v_mov_b32 v181, 0
  v_mov_b32 v182, 0
  v_mov_b32 v183, 0
  v_mov_b32 v184, 0
  v_mov_b32 v185, 0
  v_mov_b32 v186, 0
  v_mov_b32 v187, 0
  v_mov_b32 v188, 0
  v_mov_b32 v189, 0
  v_mov_b32 v190, 0
  v_mov_b32 v191, 0
  v_mov_b32 v192, 0
  v_mov_b32 v193, 0
  v_mov_b32 v194, 0
  v_mov_b32 v195, 0
  v_mov_b32 v196, 0
  v_mov_b32 v197, 0
  v_mov_b32 v198, 0
  v_mov_b32 v199, 0
  v_mov_b32 v200, 0
  v_mov_b32 v201, 0
  v_mov_b32 v202, 0
  v_mov_b32 v203, 0
  v_mov_b32 v204, 0
  v_mov_b32 v205, 0
  v_mov_b32 v206, 0
  v_mov_b32 v207, 0
  v_mov_b32 v208, 0
  v_mov_b32 v209, 0
  v_mov_b32 v210, 0
  v_mov_b32 v211, 0
  v_mov_b32 v212, 0
  v_mov_b32 v213, 0
  v_mov_b32 v214, 0
  v_mov_b32 v215, 0
  v_mov_b32 v216, 0
  v_mov_b32 v217, 0
  v_mov_b32 v218, 0
  v_mov_b32 v219, 0
  v_mov_b32 v220, 0
  v_mov_b32 v221, 0
  v_mov_b32 v222, 0
  v_mov_b32 v223, 0
  v_mov_b32 v224, 0
  v_mov_b32 v225, 0
  v_mov_b32 v226, 0
  v_mov_b32 v227, 0
  v_mov_b32 v228, 0
  v_mov_b32 v229, 0
  v_mov_b32 v230, 0
  v_mov_b32 v231, 0
  v_mov_b32 v232, 0
  v_mov_b32 v233, 0
  v_mov_b32 v234, 0
  v_mov_b32 v235, 0
  v_mov_b32 v236, 0
  v_mov_b32 v237, 0
  v_mov_b32 v238, 0
  v_mov_b32 v239, 0
  v_mov_b32 v240, 0
  v_mov_b32 v241, 0
  v_mov_b32 v242, 0
  v_mov_b32 v243, 0
  v_mov_b32 v244, 0
  v_mov_b32 v245, 0
  v_mov_b32 v246, 0
  v_mov_b32 v247, 0
  v_mov_b32 v248, 0
  v_mov_b32 v249, 0
  v_mov_b32 v250, 0
  v_mov_b32 v251, 0
  v_mov_b32 v252, 0
  v_mov_b32 v253, 0
  v_mov_b32 v254, 0
  v_mov_b32 v255, 0
  s_mov_b32 s43, 0
L_r1b:
  s_waitcnt vmcnt(0)
  s_barrier
  ds_read_b128 a[80:83], v60 offset:0
  ds_read_b128 a[84:87], v61 offset:0
  ds_read_b128 a[88:91], v62 offset:0
  ds_read_b128 a[92:95], v63 offset:0
  ds_read_b128 a[96:99], v60 offset:4096
  ds_read_b128 a[100:103], v61 offset:4096
  ds_read_b128 a[104:107], v62 offset:4096
  ds_read_b128 a[108:111], v63 offset:4096
  ds_read_b64_tr_b16 a[144:145], v64 offset:0
  ds_read_b64_tr_b16 a[146:147], v64 offset:4096
  ds_read_b64_tr_b16 a[148:149], v65 offset:0
  ds_read_b64_tr_b16 a[150:151], v65 offset:4096
  ds_read_b64_tr_b16 a[152:153], v66 offset:0
  ds_read_b64_tr_b16 a[154:155], v66 offset:4096
  ds_read_b64_tr_b16 a[156:157], v67 offset:0
  ds_read_b64_tr_b16 a[158:159], v67 offset:4096
  ds_read_b64_tr_b16 a[160:161], v68 offset:0
  ds_read_b64_tr_b16 a[162:163], v68 offset:4096
  ds_read_b64_tr_b16 a[164:165], v69 offset:0
  ds_read_b64_tr_b16 a[166:167], v69 offset:4096
  ds_read_b64_tr_b16 a[168:169], v70 offset:0
  ds_read_b64_tr_b16 a[170:171], v70 offset:4096
  ds_read_b64_tr_b16 a[172:173], v71 offset:0
  ds_read_b64_tr_b16 a[174:175], v71 offset:4096
  s_waitcnt lgkmcnt(0)
  s_barrier
  v_mfma_f32_16x16x32_bf16 v[80:83], a[80:83], a[0:3], v[8:11]
  v_mfma_f32_16x16x32_bf16 v[80:83], a[84:87], a[4:7], v[80:83]
  v_mfma_f32_16x16x32_bf16 v[80:83], a[88:91], a[8:11], v[80:83]
  v_mfma_f32_16x16x32_bf16 v[80:83], a[92:95], a[12:15], v[80:83]
  v_mfma_f32_16x16x32_bf16 v[84:87], a[96:99], a[0:3], v[8:11]
  v_mfma_f32_16x16x32_bf16 v[84:87], a[100:103], a[4:7], v[84:87]
  v_mfma_f32_16x16x32_bf16 v[84:87], a[104:107], a[8:11], v[84:87]
  v_mfma_f32_16x16x32_bf16 v[84:87], a[108:111], a[12:15], v[84:87]
  s_nop 7
  v_exp_f32 v80, v80
  v_exp_f32 v81, v81
  v_exp_f32 v82, v82
  v_exp_f32 v83, v83
  v_exp_f32 v84, v84
  v_exp_f32 v85, v85
  v_exp_f32 v86, v86
  v_exp_f32 v87, v87
  v_add_f32 v72, v72, v80
  v_add_f32 v72, v72, v81
  v_add_f32 v72, v72, v82
  v_add_f32 v72, v72, v83
  v_cvt_pk_bf16_f32 v80, v80, v81
  v_cvt_pk_bf16_f32 v81, v82, v83
  v_cvt_pk_bf16_f32 v82, v84, v85
  v_cvt_pk_bf16_f32 v83, v86, v87
  v_add_f32 v72, v72, v84
  v_add_f32 v72, v72, v85
  v_add_f32 v72, v72, v86
  v_add_f32 v72, v72, v87
  v_mfma_f32_16x16x32_bf16 v[96:99], a[144:147], v[80:83], v[96:99]
  v_mfma_f32_16x16x32_bf16 v[100:103], a[148:151], v[80:83], v[100:103]
  v_mfma_f32_16x16x32_bf16 v[104:107], a[152:155], v[80:83], v[104:107]
  v_mfma_f32_16x16x32_bf16 v[108:111], a[156:159], v[80:83], v[108:111]
  v_mfma_f32_16x16x32_bf16 v[112:115], a[160:163], v[80:83], v[112:115]
  v_mfma_f32_16x16x32_bf16 v[116:119], a[164:167], v[80:83], v[116:119]
  v_mfma_f32_16x16x32_bf16 v[120:123], a[168:171], v[80:83], v[120:123]
  v_mfma_f32_16x16x32_bf16 v[124:127], a[172:175], v[80:83], v[124:127]
  v_mfma_f32_16x16x32_bf16 v[80:83], a[80:83], a[16:19], v[12:15]
  v_mfma_f32_16x16x32_bf16 v[80:83], a[84:87], a[20:23], v[80:83]
  v_mfma_f32_16x16x32_bf16 v[80:83], a[88:91], a[24:27], v[80:83]
  v_mfma_f32_16x16x32_bf16 v[80:83], a[92:95], a[28:31], v[80:83]
  v_mfma_f32_16x16x32_bf16 v[84:87], a[96:99], a[16:19], v[12:15]
  v_mfma_f32_16x16x32_bf16 v[84:87], a[100:103], a[20:23], v[84:87]
  v_mfma_f32_16x16x32_bf16 v[84:87], a[104:107], a[24:27], v[84:87]
  v_mfma_f32_16x16x32_bf16 v[84:87], a[108:111], a[28:31], v[84:87]
  s_nop 7
  v_exp_f32 v80, v80
  v_exp_f32 v81, v81
  v_exp_f32 v82, v82
  v_exp_f32 v83, v83
  v_exp_f32 v84, v84
  v_exp_f32 v85, v85
  v_exp_f32 v86, v86
  v_exp_f32 v87, v87
  v_add_f32 v73, v73, v80
  v_add_f32 v73, v73, v81
  v_add_f32 v73, v73, v82
  v_add_f32 v73, v73, v83
  v_cvt_pk_bf16_f32 v80, v80, v81
  v_cvt_pk_bf16_f32 v81, v82, v83
  v_cvt_pk_bf16_f32 v82, v84, v85
  v_cvt_pk_bf16_f32 v83, v86, v87
  v_add_f32 v73, v73, v84
  v_add_f32 v73, v73, v85
  v_add_f32 v73, v73, v86
  v_add_f32 v73, v73, v87
  v_mfma_f32_16x16x32_bf16 v[128:131], a[144:147], v[80:83], v[128:131]
  v_mfma_f32_16x16x32_bf16 v[132:135], a[148:151], v[80:83], v[132:135]
  v_mfma_f32_16x16x32_bf16 v[136:139], a[152:155], v[80:83], v[136:139]
  v_mfma_f32_16x16x32_bf16 v[140:143], a[156:159], v[80:83], v[140:143]
  v_mfma_f32_16x16x32_bf16 v[144:147], a[160:163], v[80:83], v[144:147]
  v_mfma_f32_16x16x32_bf16 v[148:151], a[164:167], v[80:83], v[148:151]
  v_mfma_f32_16x16x32_bf16 v[152:155], a[168:171], v[80:83], v[152:155]
  v_mfma_f32_16x16x32_bf16 v[156:159], a[172:175], v[80:83], v[156:159]
  v_mfma_f32_16x16x32_bf16 v[80:83], a[80:83], a[32:35], v[16:19]
  v_mfma_f32_16x16x32_bf16 v[80:83], a[84:87], a[36:39], v[80:83]
  v_mfma_f32_16x16x32_bf16 v[80:83], a[88:91], a[40:43], v[80:83]
  v_mfma_f32_16x16x32_bf16 v[80:83], a[92:95], a[44:47], v[80:83]
  v_mfma_f32_16x16x32_bf16 v[84:87], a[96:99], a[32:35], v[16:19]
  v_mfma_f32_16x16x32_bf16 v[84:87], a[100:103], a[36:39], v[84:87]
  v_mfma_f32_16x16x32_bf16 v[84:87], a[104:107], a[40:43], v[84:87]
  v_mfma_f32_16x16x32_bf16 v[84:87], a[108:111], a[44:47], v[84:87]
  s_nop 7
  v_exp_f32 v80, v80
  v_exp_f32 v81, v81
  v_exp_f32 v82, v82
  v_exp_f32 v83, v83
  v_exp_f32 v84, v84
  v_exp_f32 v85, v85
  v_exp_f32 v86, v86
  v_exp_f32 v87, v87
  v_add_f32 v74, v74, v80
  v_add_f32 v74, v74, v81
  v_add_f32 v74, v74, v82
  v_add_f32 v74, v74, v83
  v_cvt_pk_bf16_f32 v80, v80, v81
  v_cvt_pk_bf16_f32 v81, v82, v83
  v_cvt_pk_bf16_f32 v82, v84, v85
  v_cvt_pk_bf16_f32 v83, v86, v87
  v_add_f32 v74, v74, v84
  v_add_f32 v74, v74, v85
  v_add_f32 v74, v74, v86
  v_add_f32 v74, v74, v87
  v_mfma_f32_16x16x32_bf16 v[160:163], a[144:147], v[80:83], v[160:163]
  v_mfma_f32_16x16x32_bf16 v[164:167], a[148:151], v[80:83], v[164:167]
  v_mfma_f32_16x16x32_bf16 v[168:171], a[152:155], v[80:83], v[168:171]
  v_mfma_f32_16x16x32_bf16 v[172:175], a[156:159], v[80:83], v[172:175]
  v_mfma_f32_16x16x32_bf16 v[176:179], a[160:163], v[80:83], v[176:179]
  v_mfma_f32_16x16x32_bf16 v[180:183], a[164:167], v[80:83], v[180:183]
  v_mfma_f32_16x16x32_bf16 v[184:187], a[168:171], v[80:83], v[184:187]
  v_mfma_f32_16x16x32_bf16 v[188:191], a[172:175], v[80:83], v[188:191]
  v_mfma_f32_16x16x32_bf16 v[80:83], a[80:83], a[48:51], v[20:23]
  v_mfma_f32_16x16x32_bf16 v[80:83], a[84:87], a[52:55], v[80:83]
  v_mfma_f32_16x16x32_bf16 v[80:83], a[88:91], a[56:59], v[80:83]
  v_mfma_f32_16x16x32_bf16 v[80:83], a[92:95], a[60:63], v[80:83]
  v_mfma_f32_16x16x32_bf16 v[84:87], a[96:99], a[48:51], v[20:23]
  v_mfma_f32_16x16x32_bf16 v[84:87], a[100:103], a[52:55], v[84:87]
  v_mfma_f32_16x16x32_bf16 v[84:87], a[104:107], a[56:59], v[84:87]
  v_mfma_f32_16x16x32_bf16 v[84:87], a[108:111], a[60:63], v[84:87]
  s_nop 7
  v_exp_f32 v80, v80
  v_exp_f32 v81, v81
  v_exp_f32 v82, v82
  v_exp_f32 v83, v83
  v_exp_f32 v84, v84
  v_exp_f32 v85, v85
  v_exp_f32 v86, v86
  v_exp_f32 v87, v87
  v_add_f32 v75, v75, v80
  v_add_f32 v75, v75, v81
  v_add_f32 v75, v75, v82
  v_add_f32 v75, v75, v83
  v_cvt_pk_bf16_f32 v80, v80, v81
  v_cvt_pk_bf16_f32 v81, v82, v83
  v_cvt_pk_bf16_f32 v82, v84, v85
  v_cvt_pk_bf16_f32 v83, v86, v87
  v_add_f32 v75, v75, v84
  v_add_f32 v75, v75, v85
  v_add_f32 v75, v75, v86
  v_add_f32 v75, v75, v87
  v_mfma_f32_16x16x32_bf16 v[192:195], a[144:147], v[80:83], v[192:195]
  v_mfma_f32_16x16x32_bf16 v[196:199], a[148:151], v[80:83], v[196:199]
  v_mfma_f32_16x16x32_bf16 v[200:203], a[152:155], v[80:83], v[200:203]
  v_mfma_f32_16x16x32_bf16 v[204:207], a[156:159], v[80:83], v[204:207]
  v_mfma_f32_16x16x32_bf16 v[208:211], a[160:163], v[80:83], v[208:211]
  v_mfma_f32_16x16x32_bf16 v[212:215], a[164:167], v[80:83], v[212:215]
  v_mfma_f32_16x16x32_bf16 v[216:219], a[168:171], v[80:83], v[216:219]
  v_mfma_f32_16x16x32_bf16 v[220:223], a[172:175], v[80:83], v[220:223]
  v_mfma_f32_16x16x32_bf16 v[80:83], a[80:83], a[64:67], v[24:27]
  v_mfma_f32_16x16x32_bf16 v[80:83], a[84:87], a[68:71], v[80:83]
  v_mfma_f32_16x16x32_bf16 v[80:83], a[88:91], a[72:75], v[80:83]
  v_mfma_f32_16x16x32_bf16 v[80:83], a[92:95], a[76:79], v[80:83]
  v_mfma_f32_16x16x32_bf16 v[84:87], a[96:99], a[64:67], v[24:27]
  v_mfma_f32_16x16x32_bf16 v[84:87], a[100:103], a[68:71], v[84:87]
  v_mfma_f32_16x16x32_bf16 v[84:87], a[104:107], a[72:75], v[84:87]
  v_mfma_f32_16x16x32_bf16 v[84:87], a[108:111], a[76:79], v[84:87]
  s_nop 7
  v_exp_f32 v80, v80
  v_exp_f32 v81, v81
  v_exp_f32 v82, v82
  v_exp_f32 v83, v83
  v_exp_f32 v84, v84
  v_exp_f32 v85, v85
  v_exp_f32 v86, v86
  v_exp_f32 v87, v87
  v_add_f32 v76, v76, v80
  v_add_f32 v76, v76, v81
  v_add_f32 v76, v76, v82
  v_add_f32 v76, v76, v83
  v_cvt_pk_bf16_f32 v80, v80, v81
  v_cvt_pk_bf16_f32 v81, v82, v83
  v_cvt_pk_bf16_f32 v82, v84, v85
  v_cvt_pk_bf16_f32 v83, v86, v87
  v_add_f32 v76, v76, v84
  v_add_f32 v76, v76, v85
  v_add_f32 v76, v76, v86
  v_add_f32 v76, v76, v87
  v_mfma_f32_16x16x32_bf16 v[224:227], a[144:147], v[80:83], v[224:227]
  v_mfma_f32_16x16x32_bf16 v[228:231], a[148:151], v[80:83], v[228:231]
  v_mfma_f32_16x16x32_bf16 v[232:235], a[152:155], v[80:83], v[232:235]
  v_mfma_f32_16x16x32_bf16 v[236:239], a[156:159], v[80:83], v[236:239]
  v_mfma_f32_16x16x32_bf16 v[240:243], a[160:163], v[80:83], v[240:243]
  v_mfma_f32_16x16x32_bf16 v[244:247], a[164:167], v[80:83], v[244:247]
  v_mfma_f32_16x16x32_bf16 v[248:251], a[168:171], v[80:83], v[248:251]
  v_mfma_f32_16x16x32_bf16 v[252:255], a[172:175], v[80:83], v[252:255]
  s_add_u32 s43, s43, 8192
  s_cmp_lt_u32 s43, 131072
  s_cbranch_scc1 L_r1b
  s_barrier
  v_mov_b32 v1, v72
  v_mov_b32 v2, v73
  v_mov_b32 v3, v74
  v_mov_b32 v4, v75
  v_mov_b32 v5, v76
  s_nop 1
  v_permlane32_swap_b32 v1, v72
  v_permlane32_swap_b32 v2, v73
  v_permlane32_swap_b32 v3, v74
  v_permlane32_swap_b32 v4, v75
  v_permlane32_swap_b32 v5, v76
  s_nop 1
  v_add_f32 v72, v72, v1
  v_add_f32 v73, v73, v2
  v_add_f32 v74, v74, v3
  v_add_f32 v75, v75, v4
  v_add_f32 v76, v76, v5
  v_mov_b32 v1, v72
  v_mov_b32 v2, v73
  v_mov_b32 v3, v74
  v_mov_b32 v4, v75
  v_mov_b32 v5, v76
  s_nop 1
  v_permlane16_swap_b32 v1, v72
  v_permlane16_swap_b32 v2, v73
  v_permlane16_swap_b32 v3, v74
  v_permlane16_swap_b32 v4, v75
  v_permlane16_swap_b32 v5, v76
  s_nop 1
  v_add_f32 v72, v72, v1
  v_add_f32 v73, v73, v2
  v_add_f32 v74, v74, v3
  v_add_f32 v75, v75, v4
  v_add_f32 v76, v76, v5
  s_mov_b32 s34, 1
  s_branch L_eb
L_small:
  s_waitcnt vmcnt(4)
  s_waitcnt lgkmcnt(0)
  s_barrier
  ds_read_b128 a[208:211], v58 offset:0
  ds_read_b128 a[212:215], v58 offset:2048
  ds_read_b128 a[216:219], v58 offset:4096
  ds_read_b128 a[220:223], v58 offset:6144
  ds_read_b128 a[224:227], v58 offset:8192
  ds_read_b64_tr_b16 a[0:1], v64
  ds_read_b64_tr_b16 a[2:3], v64 offset:2048
  ds_read_b64_tr_b16 a[4:5], v65
  ds_read_b64_tr_b16 a[6:7], v65 offset:2048
  ds_read_b64_tr_b16 a[8:9], v66
  ds_read_b64_tr_b16 a[10:11], v66 offset:2048
  ds_read_b64_tr_b16 a[12:13], v67
  ds_read_b64_tr_b16 a[14:15], v67 offset:2048
  ds_read_b64_tr_b16 a[16:17], v68
  ds_read_b64_tr_b16 a[18:19], v68 offset:2048
  ds_read_b64_tr_b16 a[20:21], v69
  ds_read_b64_tr_b16 a[22:23], v69 offset:2048
  ds_read_b64_tr_b16 a[24:25], v70
  ds_read_b64_tr_b16 a[26:27], v70 offset:2048
  ds_read_b64_tr_b16 a[28:29], v71
  ds_read_b64_tr_b16 a[30:31], v71 offset:2048
  s_ashr_i32 s41, s40, 1
  s_sub_u32 s41, s41, s53
  s_mul_i32 s41, s41, 2
  s_lshr_b32 s38, s41, 1
  s_add_u32 s43, s38, s30
  s_and_b32 s43, s43, 31
  s_lshl_b32 s43, s43, 12
  s_and_b32 s38, s41, 1
  s_lshl_b32 s38, s38, 11
  s_add_u32 s43, s43, s38
  s_bfe_u32 s42, s41, 0x10002
  s_lshl_b32 s42, s42, 14
  s_and_b32 s38, s41, 3
  s_lshl_b32 s38, s38, 11
  s_add_u32 s42, s42, s38
  s_add_u32 s42, s42, s39
  s_cmp_ge_u32 s41, 16
  s_cselect_b32 s42, 196608, s42
  s_cselect_b32 s43, 1073741824, s43
  s_mov_b32 m0, s42
  s_nop 0
  buffer_load_dwordx4 v56, s[68:71], s43 offen offset:0 nt lds
  buffer_load_dwordx4 v57, s[68:71], s43 offen offset:1024 nt lds
  buffer_load_dwordx4 v56, s[68:71], s43 offen offset:2048 nt lds
  buffer_load_dwordx4 v57, s[68:71], s43 offen offset:3072 nt lds
  s_add_u32 s34, s52, 1
  s_sub_u32 s35, s34, 9
  s_cselect_b32 s34, s34, s35
  s_lshl_b32 s34, s34, 7
  s_add_u32 s35, s74, 18432
  s_add_u32 s34, s75, s34
  s_mov_b32 m0, s35
  s_nop 0
  buffer_load_dwordx4 v53, s[8:11], s34 offen offset:0  lds
  s_add_u32 s34, s34, 16384
  s_nop 0
  buffer_load_dwordx4 v53, s[8:11], s34 offen offset:2048  lds
  s_add_u32 s34, s34, 20480
  s_add_u32 m0, m0, 4096
  s_nop 0
  buffer_load_dwordx4 v53, s[8:11], s34 offen offset:0  lds
  s_add_u32 s34, s34, 16384
  s_nop 0
  buffer_load_dwordx4 v53, s[8:11], s34 offen offset:2048  lds
  s_nop 0
  s_add_u32 s33, s77, 16384
  s_mov_b32 s63, s32
  s_add_u32 s64, s32, 30720
  s_mov_b32 m0, s33
  s_nop 0
  buffer_load_dwordx4 v54, s[12:15], s63 offen offset:0  lds
  buffer_load_dwordx4 v55, s[12:15], s63 offen offset:1024  lds
  buffer_load_dwordx4 v54, s[12:15], s64 offen offset:2048  lds
  buffer_load_dwordx4 v55, s[12:15], s64 offen offset:3072  lds
  s_add_u32 s32, s32, 262144
  s_cmp_ge_u32 s32, s54
  s_cselect_b32 s32, s78, s32
  s_mov_b32 s40, 0
  s_ashr_i32 s41, s40, 1
  s_sub_u32 s41, s41, s53
  s_mul_i32 s41, s41, 2
  s_lshr_b32 s38, s41, 1
  s_add_u32 s43, s38, s30
  s_and_b32 s43, s43, 31
  s_lshl_b32 s43, s43, 12
  s_and_b32 s38, s41, 1
  s_lshl_b32 s38, s38, 11
  s_add_u32 s43, s43, s38
  s_bfe_u32 s42, s41, 0x10002
  s_lshl_b32 s42, s42, 14
  s_and_b32 s38, s41, 3
  s_lshl_b32 s38, s38, 11
  s_add_u32 s42, s42, s38
  s_add_u32 s42, s42, s39
  s_cmp_ge_u32 s41, 16
  s_cselect_b32 s42, 196608, s42
  s_cselect_b32 s43, 1073741824, s43
  s_mov_b32 s33, s77
  s_add_u32 s72, s32, 30720
  v_add_u32 v64, s36, v64
  v_add_u32 v65, s36, v65
  v_add_u32 v66, s36, v66
  v_add_u32 v67, s36, v67
  v_add_u32 v68, s36, v68
  v_add_u32 v69, s36, v69
  v_add_u32 v70, s36, v70
  v_add_u32 v71, s36, v71
L_qs:
  s_waitcnt lgkmcnt(0)
  s_waitcnt vmcnt(12)
  s_barrier
  v_mfma_f32_16x16x32_bf16 v[96:99], a[0:3], a[212:215], v[96:99]
  s_mov_b32 m0, s33
  ds_read_b128 a[228:231], v59 offset:0
  s_add_u32 s40, s40, 1
  v_mfma_f32_16x16x32_bf16 v[128:131], a[0:3], a[216:219], v[128:131]
  buffer_load_dwordx4 v54, s[12:15], s32 offen offset:0  lds
  v_mfma_f32_16x16x32_bf16 v[160:163], a[0:3], a[220:223], v[160:163]
  s_add_u32 s38, s40, 3
  ds_read_b128 a[232:235], v59 offset:2048
  s_lshr_b32 s38, s38, 1
  v_mfma_f32_16x16x32_bf16 v[192:195], a[0:3], a[224:227], v[192:195]
  buffer_load_dwordx4 v55, s[12:15], s32 offen offset:1024  lds
  v_mfma_f32_16x16x32_bf16 v[100:103], a[4:7], a[212:215], v[100:103]
  s_add_u32 s34, s38, s52
  ds_read_b128 a[236:239], v59 offset:4096
  s_sub_u32 s35, s34, 9
  v_mfma_f32_16x16x32_bf16 v[132:135], a[4:7], a[216:219], v[132:135]
  buffer_load_dwordx4 v54, s[12:15], s72 offen offset:2048  lds
  v_mfma_f32_16x16x32_bf16 v[164:167], a[4:7], a[220:223], v[164:167]
  s_cmp_lt_u32 s34, 9
  ds_read_b128 a[240:243], v59 offset:6144
  v_add_u32 v58, s37, v58
  v_mfma_f32_16x16x32_bf16 v[196:199], a[4:7], a[224:227], v[196:199]
  buffer_load_dwordx4 v55, s[12:15], s72 offen offset:3072  lds
  v_mfma_f32_16x16x32_bf16 v[104:107], a[8:11], a[212:215], v[104:107]
  s_mov_b32 m0, s42
  ds_read_b128 a[244:247], v59 offset:8192
  v_add_u32 v59, s37, v59
  v_mfma_f32_16x16x32_bf16 v[136:139], a[8:11], a[216:219], v[136:139]
  buffer_load_dwordx4 v56, s[68:71], s43 offen offset:0 nt lds
  v_mfma_f32_16x16x32_bf16 v[168:171], a[8:11], a[220:223], v[168:171]
  s_cselect_b32 s34, s34, s35
  ds_read_b64_tr_b16 a[32:33], v64
  s_lshl_b32 s34, s34, 7
  v_mfma_f32_16x16x32_bf16 v[200:203], a[8:11], a[224:227], v[200:203]
  buffer_load_dwordx4 v57, s[68:71], s43 offen offset:1024 nt lds
  v_mfma_f32_16x16x32_bf16 v[108:111], a[12:15], a[212:215], v[108:111]
  s_add_u32 s34, s34, s75
  ds_read_b64_tr_b16 a[34:35], v64 offset:2048
  v_add_u32 v64, s36, v64
  v_mfma_f32_16x16x32_bf16 v[140:143], a[12:15], a[216:219], v[140:143]
  buffer_load_dwordx4 v56, s[68:71], s43 offen offset:2048 nt lds
  v_mfma_f32_16x16x32_bf16 v[172:175], a[12:15], a[220:223], v[172:175]
  s_and_b32 s38, s38, 1
  ds_read_b64_tr_b16 a[36:37], v65
  s_mul_i32 s38, s38, 18432
  v_mfma_f32_16x16x32_bf16 v[204:207], a[12:15], a[224:227], v[204:207]
  buffer_load_dwordx4 v57, s[68:71], s43 offen offset:3072 nt lds
  v_mfma_f32_16x16x32_bf16 v[240:243], a[16:19], a[208:211], v[240:243]
  s_add_u32 s35, s74, s38
  ds_read_b64_tr_b16 a[38:39], v65 offset:2048
  v_add_u32 v65, s36, v65
  v_mfma_f32_16x16x32_bf16 v[112:115], a[16:19], a[212:215], v[112:115]
  s_cmp_ge_u32 s40, 15
  ds_read_b64_tr_b16 a[40:41], v66
  s_cselect_b32 s35, 196608, s35
  v_mfma_f32_16x16x32_bf16 v[144:147], a[16:19], a[216:219], v[144:147]
  s_cselect_b32 s34, 1073741824, s34
  ds_read_b64_tr_b16 a[42:43], v66 offset:2048
  v_add_u32 v66, s36, v66
  v_mfma_f32_16x16x32_bf16 v[176:179], a[16:19], a[220:223], v[176:179]
  s_add_u32 s46, s46, 8192
  ds_read_b64_tr_b16 a[44:45], v67
  s_cmp_eq_u32 s46, 24576
  v_mfma_f32_16x16x32_bf16 v[208:211], a[16:19], a[224:227], v[208:211]
  s_cselect_b32 s46, 0, s46
  ds_read_b64_tr_b16 a[46:47], v67 offset:2048
  v_add_u32 v67, s36, v67
  v_mfma_f32_16x16x32_bf16 v[244:247], a[20:23], a[208:211], v[244:247]
  s_cmp_eq_u32 s46, 8192
  ds_read_b64_tr_b16 a[48:49], v68
  s_cselect_b32 s62, s51, s48
  v_mfma_f32_16x16x32_bf16 v[116:119], a[20:23], a[212:215], v[116:119]
  s_add_u32 s63, s32, 262144
  ds_read_b64_tr_b16 a[50:51], v68 offset:2048
  v_add_u32 v68, s36, v68
  v_mfma_f32_16x16x32_bf16 v[148:151], a[20:23], a[216:219], v[148:151]
  s_cmp_ge_u32 s63, s54
  ds_read_b64_tr_b16 a[52:53], v69
  s_cselect_b32 s63, s78, s63
  v_mfma_f32_16x16x32_bf16 v[180:183], a[20:23], a[220:223], v[180:183]
  s_add_u32 s65, s46, s47
  ds_read_b64_tr_b16 a[54:55], v69 offset:2048
  v_add_u32 v69, s36, v69
  v_mfma_f32_16x16x32_bf16 v[212:215], a[20:23], a[224:227], v[212:215]
  s_cmp_ge_u32 s40, 15
  ds_read_b64_tr_b16 a[56:57], v70
  s_cselect_b32 s65, 196608, s65
  v_mfma_f32_16x16x32_bf16 v[248:251], a[24:27], a[208:211], v[248:251]
  s_cselect_b32 s63, 1073741824, s63
  ds_read_b64_tr_b16 a[58:59], v70 offset:2048
  v_add_u32 v70, s36, v70
  v_mfma_f32_16x16x32_bf16 v[120:123], a[24:27], a[212:215], v[120:123]
  s_add_u32 s64, s63, 30720
  ds_read_b64_tr_b16 a[60:61], v71
  s_mov_b32 s33, s65
  v_mfma_f32_16x16x32_bf16 v[152:155], a[24:27], a[216:219], v[152:155]
  s_sub_u32 s37, 0, s37
  ds_read_b64_tr_b16 a[62:63], v71 offset:2048
  v_add_u32 v71, s36, v71
  v_mfma_f32_16x16x32_bf16 v[184:187], a[24:27], a[220:223], v[184:187]
  v_mfma_f32_16x16x32_bf16 v[216:219], a[24:27], a[224:227], v[216:219]
  v_mfma_f32_16x16x32_bf16 v[252:255], a[28:31], a[208:211], v[252:255]
  v_mfma_f32_16x16x32_bf16 v[124:127], a[28:31], a[212:215], v[124:127]
  v_mfma_f32_16x16x32_bf16 v[156:159], a[28:31], a[216:219], v[156:159]
  v_mfma_f32_16x16x32_bf16 v[188:191], a[28:31], a[220:223], v[188:191]
  v_mfma_f32_16x16x32_bf16 v[220:223], a[28:31], a[224:227], v[220:223]
  s_waitcnt lgkmcnt(0)
  s_waitcnt vmcnt(8)
  s_barrier
  v_mfma_f32_16x16x32_bf16 v[96:99], a[32:35], a[232:235], v[96:99]
  s_mov_b32 m0, s35
  ds_read_b128 a[208:211], v58 offset:0
  v_mfma_f32_16x16x32_bf16 v[128:131], a[32:35], a[236:239], v[128:131]
  buffer_load_dwordx4 v53, s[8:11], s34 offen offset:0  lds
  v_mfma_f32_16x16x32_bf16 v[160:163], a[32:35], a[240:243], v[160:163]
  s_add_u32 s34, s34, 16384
  ds_read_b128 a[212:215], v58 offset:2048
  v_mfma_f32_16x16x32_bf16 v[192:195], a[32:35], a[244:247], v[192:195]
  buffer_load_dwordx4 v53, s[8:11], s34 offen offset:2048  lds
  v_mfma_f32_16x16x32_bf16 v[100:103], a[36:39], a[232:235], v[100:103]
  s_add_u32 s34, s34, 20480
  ds_read_b128 a[216:219], v58 offset:4096
  s_add_u32 m0, m0, 4096
  v_mfma_f32_16x16x32_bf16 v[132:135], a[36:39], a[236:239], v[132:135]
  buffer_load_dwordx4 v53, s[8:11], s34 offen offset:0  lds
  v_mfma_f32_16x16x32_bf16 v[164:167], a[36:39], a[240:243], v[164:167]
  s_add_u32 s34, s34, 16384
  ds_read_b128 a[220:223], v58 offset:6144
  s_add_u32 s40, s40, 1
  v_mfma_f32_16x16x32_bf16 v[196:199], a[36:39], a[244:247], v[196:199]
  buffer_load_dwordx4 v53, s[8:11], s34 offen offset:2048  lds
  v_mfma_f32_16x16x32_bf16 v[104:107], a[40:43], a[232:235], v[104:107]
  s_mov_b32 m0, s33
  ds_read_b128 a[224:227], v58 offset:8192
  s_ashr_i32 s41, s40, 1
  v_mfma_f32_16x16x32_bf16 v[136:139], a[40:43], a[236:239], v[136:139]
  s_sub_u32 s41, s41, s53
  ds_read_b64_tr_b16 a[0:1], v64
  s_mul_i32 s41, s41, 2
  v_mfma_f32_16x16x32_bf16 v[168:171], a[40:43], a[240:243], v[168:171]
  s_lshr_b32 s38, s41, 1
  ds_read_b64_tr_b16 a[2:3], v64 offset:2048
  v_add_u32 v64, s62, v64
  v_mfma_f32_16x16x32_bf16 v[200:203], a[40:43], a[244:247], v[200:203]
  buffer_load_dwordx4 v54, s[12:15], s63 offen offset:0  lds
  v_mfma_f32_16x16x32_bf16 v[108:111], a[44:47], a[232:235], v[108:111]
  s_add_u32 s43, s38, s30
  ds_read_b64_tr_b16 a[4:5], v65
  s_and_b32 s43, s43, 31
  v_mfma_f32_16x16x32_bf16 v[140:143], a[44:47], a[236:239], v[140:143]
  s_lshl_b32 s43, s43, 12
  ds_read_b64_tr_b16 a[6:7], v65 offset:2048
  v_add_u32 v65, s62, v65
  v_mfma_f32_16x16x32_bf16 v[172:175], a[44:47], a[240:243], v[172:175]
  s_and_b32 s38, s41, 1
  ds_read_b64_tr_b16 a[8:9], v66
  s_lshl_b32 s38, s38, 11
  v_mfma_f32_16x16x32_bf16 v[204:207], a[44:47], a[244:247], v[204:207]
  s_add_u32 s43, s43, s38
  ds_read_b64_tr_b16 a[10:11], v66 offset:2048
  v_add_u32 v66, s62, v66
  v_mfma_f32_16x16x32_bf16 v[240:243], a[48:51], a[228:231], v[240:243]
  buffer_load_dwordx4 v55, s[12:15], s63 offen offset:1024  lds
  v_mfma_f32_16x16x32_bf16 v[112:115], a[48:51], a[232:235], v[112:115]
  s_bfe_u32 s42, s41, 0x10002
  ds_read_b64_tr_b16 a[12:13], v67
  s_lshl_b32 s42, s42, 14
  v_mfma_f32_16x16x32_bf16 v[144:147], a[48:51], a[236:239], v[144:147]
  s_and_b32 s38, s41, 3
  ds_read_b64_tr_b16 a[14:15], v67 offset:2048
  v_add_u32 v67, s62, v67
  v_mfma_f32_16x16x32_bf16 v[176:179], a[48:51], a[240:243], v[176:179]
  s_lshl_b32 s38, s38, 11
  ds_read_b64_tr_b16 a[16:17], v68
  s_add_u32 s42, s42, s38
  v_mfma_f32_16x16x32_bf16 v[208:211], a[48:51], a[244:247], v[208:211]
  s_add_u32 s42, s42, s39
  ds_read_b64_tr_b16 a[18:19], v68 offset:2048
  v_add_u32 v68, s62, v68
  v_mfma_f32_16x16x32_bf16 v[244:247], a[52:55], a[228:231], v[244:247]
  buffer_load_dwordx4 v54, s[12:15], s64 offen offset:2048  lds
  v_mfma_f32_16x16x32_bf16 v[116:119], a[52:55], a[232:235], v[116:119]
  s_cmp_ge_u32 s41, 16
  ds_read_b64_tr_b16 a[20:21], v69
  s_cselect_b32 s42, 196608, s42
  v_mfma_f32_16x16x32_bf16 v[148:151], a[52:55], a[236:239], v[148:151]
  s_cselect_b32 s43, 1073741824, s43
  ds_read_b64_tr_b16 a[22:23], v69 offset:2048
  v_add_u32 v69, s62, v69
  v_mfma_f32_16x16x32_bf16 v[180:183], a[52:55], a[240:243], v[180:183]
  s_add_u32 s46, s46, 8192
  ds_read_b64_tr_b16 a[24:25], v70
  s_cmp_eq_u32 s46, 24576
  v_mfma_f32_16x16x32_bf16 v[212:215], a[52:55], a[244:247], v[212:215]
  s_cselect_b32 s46, 0, s46
  ds_read_b64_tr_b16 a[26:27], v70 offset:2048
  v_add_u32 v70, s62, v70
  v_mfma_f32_16x16x32_bf16 v[248:251], a[56:59], a[228:231], v[248:251]
  buffer_load_dwordx4 v55, s[12:15], s64 offen offset:3072  lds
  v_mfma_f32_16x16x32_bf16 v[120:123], a[56:59], a[232:235], v[120:123]
  s_cmp_eq_u32 s46, 8192
  ds_read_b64_tr_b16 a[28:29], v71
  s_cselect_b32 s36, s51, s48
  v_mfma_f32_16x16x32_bf16 v[152:155], a[56:59], a[236:239], v[152:155]
  s_add_u32 s32, s63, 262144
  ds_read_b64_tr_b16 a[30:31], v71 offset:2048
  v_add_u32 v71, s62, v71
  v_mfma_f32_16x16x32_bf16 v[184:187], a[56:59], a[240:243], v[184:187]
  s_cmp_ge_u32 s32, s54
  s_cselect_b32 s32, s78, s32
  s_add_u32 s65, s46, s47
  v_mfma_f32_16x16x32_bf16 v[216:219], a[56:59], a[244:247], v[216:219]
  s_cmp_ge_u32 s40, 15
  s_cselect_b32 s65, 196608, s65
  s_cselect_b32 s32, 1073741824, s32
  v_mfma_f32_16x16x32_bf16 v[252:255], a[60:63], a[228:231], v[252:255]
  s_add_u32 s72, s32, 30720
  s_mov_b32 s33, s65
  v_mfma_f32_16x16x32_bf16 v[124:127], a[60:63], a[232:235], v[124:127]
  v_mfma_f32_16x16x32_bf16 v[156:159], a[60:63], a[236:239], v[156:159]
  v_mfma_f32_16x16x32_bf16 v[188:191], a[60:63], a[240:243], v[188:191]
  v_mfma_f32_16x16x32_bf16 v[220:223], a[60:63], a[244:247], v[220:223]
  s_cmp_eq_u32 s40, 18
  s_cbranch_scc1 L_qes
  s_cmp_eq_u32 s40, 6
  s_cbranch_scc0 L_qs
  s_waitcnt lgkmcnt(0)
  s_waitcnt vmcnt(12)
  s_barrier
  v_mfma_f32_16x16x32_bf16 v[96:99], a[0:3], a[212:215], v[96:99]
  s_mov_b32 m0, s33
  ds_read_b128 a[228:231], v59 offset:0
  s_add_u32 s40, s40, 1
  v_mfma_f32_16x16x32_bf16 v[128:131], a[0:3], a[216:219], v[128:131]
  buffer_load_dwordx4 v54, s[12:15], s32 offen offset:0  lds
  v_mfma_f32_16x16x32_bf16 v[160:163], a[0:3], a[220:223], v[160:163]
  s_add_u32 s38, s40, 3
  ds_read_b128 a[232:235], v59 offset:2048
  s_lshr_b32 s38, s38, 1
  v_mfma_f32_16x16x32_bf16 v[192:195], a[0:3], a[224:227], v[192:195]
  buffer_load_dwordx4 v55, s[12:15], s32 offen offset:1024  lds
  v_mfma_f32_16x16x32_bf16 v[100:103], a[4:7], a[212:215], v[100:103]
  s_add_u32 s34, s38, s52
  ds_read_b128 a[236:239], v59 offset:4096
  s_sub_u32 s35, s34, 9
  v_mfma_f32_16x16x32_bf16 v[132:135], a[4:7], a[216:219], v[132:135]
  buffer_load_dwordx4 v54, s[12:15], s72 offen offset:2048  lds
  v_mfma_f32_16x16x32_bf16 v[164:167], a[4:7], a[220:223], v[164:167]
  s_cmp_lt_u32 s34, 9
  ds_read_b128 a[240:243], v59 offset:6144
  v_add_u32 v58, s37, v58
  v_mfma_f32_16x16x32_bf16 v[196:199], a[4:7], a[224:227], v[196:199]
  buffer_load_dwordx4 v55, s[12:15], s72 offen offset:3072  lds
  v_mfma_f32_16x16x32_bf16 v[104:107], a[8:11], a[212:215], v[104:107]
  s_mov_b32 m0, s42
  ds_read_b128 a[244:247], v59 offset:8192
  v_add_u32 v59, s37, v59
  v_mfma_f32_16x16x32_bf16 v[136:139], a[8:11], a[216:219], v[136:139]
  buffer_load_dwordx4 v56, s[68:71], s43 offen offset:0 nt lds
  v_mfma_f32_16x16x32_bf16 v[168:171], a[8:11], a[220:223], v[168:171]
  s_cselect_b32 s34, s34, s35
  ds_read_b64_tr_b16 a[32:33], v64
  s_lshl_b32 s34, s34, 7
  v_mfma_f32_16x16x32_bf16 v[200:203], a[8:11], a[224:227], v[200:203]
  buffer_load_dwordx4 v57, s[68:71], s43 offen offset:1024 nt lds
  v_mfma_f32_16x16x32_bf16 v[108:111], a[12:15], a[212:215], v[108:111]
  s_add_u32 s34, s34, s75
  ds_read_b64_tr_b16 a[34:35], v64 offset:2048
  v_add_u32 v64, s36, v64
  v_mfma_f32_16x16x32_bf16 v[140:143], a[12:15], a[216:219], v[140:143]
  buffer_load_dwordx4 v56, s[68:71], s43 offen offset:2048 nt lds
  v_mfma_f32_16x16x32_bf16 v[172:175], a[12:15], a[220:223], v[172:175]
  s_and_b32 s38, s38, 1
  ds_read_b64_tr_b16 a[36:37], v65
  s_mul_i32 s38, s38, 18432
  v_mfma_f32_16x16x32_bf16 v[204:207], a[12:15], a[224:227], v[204:207]
  buffer_load_dwordx4 v57, s[68:71], s43 offen offset:3072 nt lds
  v_mfma_f32_16x16x32_bf16 v[240:243], a[16:19], a[208:211], v[240:243]
  s_add_u32 s35, s74, s38
  ds_read_b64_tr_b16 a[38:39], v65 offset:2048
  v_add_u32 v65, s36, v65
  v_mfma_f32_16x16x32_bf16 v[112:115], a[16:19], a[212:215], v[112:115]
  s_cmp_ge_u32 s40, 15
  ds_read_b64_tr_b16 a[40:41], v66
  s_cselect_b32 s35, 196608, s35
  v_mfma_f32_16x16x32_bf16 v[144:147], a[16:19], a[216:219], v[144:147]
  s_cselect_b32 s34, 1073741824, s34
  ds_read_b64_tr_b16 a[42:43], v66 offset:2048
  v_add_u32 v66, s36, v66
  v_mfma_f32_16x16x32_bf16 v[176:179], a[16:19], a[220:223], v[176:179]
  s_add_u32 s46, s46, 8192
  ds_read_b64_tr_b16 a[44:45], v67
  s_cmp_eq_u32 s46, 24576
  v_mfma_f32_16x16x32_bf16 v[208:211], a[16:19], a[224:227], v[208:211]
  s_cselect_b32 s46, 0, s46
  ds_read_b64_tr_b16 a[46:47], v67 offset:2048
  v_add_u32 v67, s36, v67
  v_mfma_f32_16x16x32_bf16 v[244:247], a[20:23], a[208:211], v[244:247]
  s_cmp_eq_u32 s46, 8192
  ds_read_b64_tr_b16 a[48:49], v68
  s_cselect_b32 s62, s51, s48
  v_mfma_f32_16x16x32_bf16 v[116:119], a[20:23], a[212:215], v[116:119]
  s_add_u32 s63, s32, 262144
  ds_read_b64_tr_b16 a[50:51], v68 offset:2048
  v_add_u32 v68, s36, v68
  v_mfma_f32_16x16x32_bf16 v[148:151], a[20:23], a[216:219], v[148:151]
  s_cmp_ge_u32 s63, s54
  ds_read_b64_tr_b16 a[52:53], v69
  s_cselect_b32 s63, s78, s63
  v_mfma_f32_16x16x32_bf16 v[180:183], a[20:23], a[220:223], v[180:183]
  s_add_u32 s65, s46, s47
  ds_read_b64_tr_b16 a[54:55], v69 offset:2048
  v_add_u32 v69, s36, v69
  v_mfma_f32_16x16x32_bf16 v[212:215], a[20:23], a[224:227], v[212:215]
  s_cmp_ge_u32 s40, 15
  ds_read_b64_tr_b16 a[56:57], v70
  s_cselect_b32 s65, 196608, s65
  v_mfma_f32_16x16x32_bf16 v[248:251], a[24:27], a[208:211], v[248:251]
  s_cselect_b32 s63, 1073741824, s63
  ds_read_b64_tr_b16 a[58:59], v70 offset:2048
  v_add_u32 v70, s36, v70
  v_mfma_f32_16x16x32_bf16 v[120:123], a[24:27], a[212:215], v[120:123]
  s_add_u32 s64, s63, 30720
  ds_read_b64_tr_b16 a[60:61], v71
  s_mov_b32 s33, s65
  v_mfma_f32_16x16x32_bf16 v[152:155], a[24:27], a[216:219], v[152:155]
  s_sub_u32 s37, 0, s37
  ds_read_b64_tr_b16 a[62:63], v71 offset:2048
  v_add_u32 v71, s36, v71
  v_mfma_f32_16x16x32_bf16 v[184:187], a[24:27], a[220:223], v[184:187]
  v_mfma_f32_16x16x32_bf16 v[216:219], a[24:27], a[224:227], v[216:219]
  v_mfma_f32_16x16x32_bf16 v[252:255], a[28:31], a[208:211], v[252:255]
  v_mfma_f32_16x16x32_bf16 v[124:127], a[28:31], a[212:215], v[124:127]
  v_mfma_f32_16x16x32_bf16 v[156:159], a[28:31], a[216:219], v[156:159]
  v_mfma_f32_16x16x32_bf16 v[188:191], a[28:31], a[220:223], v[188:191]
  v_mfma_f32_16x16x32_bf16 v[220:223], a[28:31], a[224:227], v[220:223]
  s_waitcnt lgkmcnt(0)
  s_waitcnt vmcnt(8)
  s_barrier
  v_mfma_f32_16x16x32_bf16 v[96:99], a[32:35], a[232:235], v[96:99]
  s_mov_b32 m0, s35
  ds_read_b128 a[208:211], v58 offset:0
  ds_read_b128 a[212:215], v58 offset:2048
  v_mfma_f32_16x16x32_bf16 v[128:131], a[32:35], a[236:239], v[128:131]
  buffer_load_dwordx4 v53, s[8:11], s34 offen offset:0  lds
  v_mfma_f32_16x16x32_bf16 v[160:163], a[32:35], a[240:243], v[160:163]
  s_add_u32 s34, s34, 16384
  ds_read_b128 a[216:219], v58 offset:4096
  ds_read_b128 a[220:223], v58 offset:6144
  v_mfma_f32_16x16x32_bf16 v[192:195], a[32:35], a[244:247], v[192:195]
  buffer_load_dwordx4 v53, s[8:11], s34 offen offset:2048  lds
  v_mfma_f32_16x16x32_bf16 v[100:103], a[36:39], a[232:235], v[100:103]
  s_add_u32 s34, s34, 20480
  ds_read_b128 a[224:227], v58 offset:8192
  s_add_u32 m0, m0, 4096
  v_mfma_f32_16x16x32_bf16 v[132:135], a[36:39], a[236:239], v[132:135]
  buffer_load_dwordx4 v53, s[8:11], s34 offen offset:0  lds
  ds_read_b64_tr_b16 a[0:1], v64
  v_mfma_f32_16x16x32_bf16 v[164:167], a[36:39], a[240:243], v[164:167]
  s_add_u32 s34, s34, 16384
  ds_read_b64_tr_b16 a[2:3], v64 offset:2048
  ds_read_b64_tr_b16 a[4:5], v65
  v_mfma_f32_16x16x32_bf16 v[196:199], a[36:39], a[244:247], v[196:199]
  buffer_load_dwordx4 v53, s[8:11], s34 offen offset:2048  lds
  v_mfma_f32_16x16x32_bf16 v[104:107], a[40:43], a[232:235], v[104:107]
  s_mov_b32 m0, s33
  ds_read_b64_tr_b16 a[6:7], v65 offset:2048
  ds_read_b64_tr_b16 a[8:9], v66
  v_mfma_f32_16x16x32_bf16 v[136:139], a[40:43], a[236:239], v[136:139]
  s_nop 0
  ds_read_b64_tr_b16 a[10:11], v66 offset:2048
  ds_read_b64_tr_b16 a[12:13], v67
  v_mfma_f32_16x16x32_bf16 v[168:171], a[40:43], a[240:243], v[168:171]
  s_nop 0
  ds_read_b64_tr_b16 a[14:15], v67 offset:2048
  ds_read_b64_tr_b16 a[16:17], v68
  v_mfma_f32_16x16x32_bf16 v[200:203], a[40:43], a[244:247], v[200:203]
  buffer_load_dwordx4 v54, s[12:15], s63 offen offset:0  lds
  v_mfma_f32_16x16x32_bf16 v[108:111], a[44:47], a[232:235], v[108:111]
  s_nop 0
  ds_read_b64_tr_b16 a[18:19], v68 offset:2048
  ds_read_b64_tr_b16 a[20:21], v69
  v_mfma_f32_16x16x32_bf16 v[140:143], a[44:47], a[236:239], v[140:143]
  s_nop 0
  ds_read_b64_tr_b16 a[22:23], v69 offset:2048
  ds_read_b64_tr_b16 a[24:25], v70
  v_mfma_f32_16x16x32_bf16 v[172:175], a[44:47], a[240:243], v[172:175]
  s_nop 0
  ds_read_b64_tr_b16 a[26:27], v70 offset:2048
  ds_read_b64_tr_b16 a[28:29], v71
  v_mfma_f32_16x16x32_bf16 v[204:207], a[44:47], a[244:247], v[204:207]
  s_nop 0
  ds_read_b64_tr_b16 a[30:31], v71 offset:2048
  ds_read_b128 a[80:83], v60 offset:0
  v_mfma_f32_16x16x32_bf16 v[240:243], a[48:51], a[228:231], v[240:243]
  buffer_load_dwordx4 v55, s[12:15], s63 offen offset:1024  lds
  v_mfma_f32_16x16x32_bf16 v[112:115], a[48:51], a[232:235], v[112:115]
  s_add_u32 s40, s40, 1
  ds_read_b128 a[84:87], v61 offset:0
  v_add_u32 v64, s62, v64
  v_mfma_f32_16x16x32_bf16 v[144:147], a[48:51], a[236:239], v[144:147]
  s_ashr_i32 s41, s40, 1
  ds_read_b128 a[88:91], v62 offset:0
  v_add_u32 v65, s62, v65
  v_mfma_f32_16x16x32_bf16 v[176:179], a[48:51], a[240:243], v[176:179]
  s_sub_u32 s41, s41, s53
  ds_read_b128 a[92:95], v63 offset:0
  v_add_u32 v66, s62, v66
  v_mfma_f32_16x16x32_bf16 v[208:211], a[48:51], a[244:247], v[208:211]
  s_mul_i32 s41, s41, 2
  ds_read_b128 a[96:99], v60 offset:4096
  v_add_u32 v67, s62, v67
  v_mfma_f32_16x16x32_bf16 v[244:247], a[52:55], a[228:231], v[244:247]
  buffer_load_dwordx4 v54, s[12:15], s64 offen offset:2048  lds
  v_mfma_f32_16x16x32_bf16 v[116:119], a[52:55], a[232:235], v[116:119]
  s_lshr_b32 s38, s41, 1
  ds_read_b128 a[100:103], v61 offset:4096
  v_add_u32 v68, s62, v68
  v_mfma_f32_16x16x32_bf16 v[148:151], a[52:55], a[236:239], v[148:151]
  s_add_u32 s43, s38, s30
  ds_read_b128 a[104:107], v62 offset:4096
  v_add_u32 v69, s62, v69
  v_mfma_f32_16x16x32_bf16 v[180:183], a[52:55], a[240:243], v[180:183]
  s_and_b32 s43, s43, 31
  ds_read_b128 a[108:111], v63 offset:4096
  v_add_u32 v70, s62, v70
  v_mfma_f32_16x16x32_bf16 v[212:215], a[52:55], a[244:247], v[212:215]
  s_lshl_b32 s43, s43, 12
  ds_read_b64_tr_b16 a[144:145], v8 offset:0
  v_add_u32 v71, s62, v71
  v_mfma_f32_16x16x32_bf16 v[248:251], a[56:59], a[228:231], v[248:251]
  buffer_load_dwordx4 v55, s[12:15], s64 offen offset:3072  lds
  v_mfma_f32_16x16x32_bf16 v[120:123], a[56:59], a[232:235], v[120:123]
  s_and_b32 s38, s41, 1
  ds_read_b64_tr_b16 a[146:147], v8 offset:4096
  s_lshl_b32 s38, s38, 11
  v_mfma_f32_16x16x32_bf16 v[152:155], a[56:59], a[236:239], v[152:155]
  s_add_u32 s43, s43, s38
  ds_read_b64_tr_b16 a[148:149], v9 offset:0
  s_bfe_u32 s42, s41, 0x10002
  v_mfma_f32_16x16x32_bf16 v[184:187], a[56:59], a[240:243], v[184:187]
  s_lshl_b32 s42, s42, 14
  ds_read_b64_tr_b16 a[150:151], v9 offset:4096
  s_and_b32 s38, s41, 3
  v_mfma_f32_16x16x32_bf16 v[216:219], a[56:59], a[244:247], v[216:219]
  s_lshl_b32 s38, s38, 11
  s_add_u32 s42, s42, s38
  s_add_u32 s42, s42, s39
  v_mfma_f32_16x16x32_bf16 v[252:255], a[60:63], a[228:231], v[252:255]
  s_cmp_ge_u32 s41, 16
  s_cselect_b32 s42, 196608, s42
  s_cselect_b32 s43, 1073741824, s43
  v_mfma_f32_16x16x32_bf16 v[124:127], a[60:63], a[232:235], v[124:127]
  s_add_u32 s46, s46, 8192
  s_cmp_eq_u32 s46, 24576
  s_cselect_b32 s46, 0, s46
  v_mfma_f32_16x16x32_bf16 v[156:159], a[60:63], a[236:239], v[156:159]
  s_cmp_eq_u32 s46, 8192
  s_cselect_b32 s36, s51, s48
  s_add_u32 s32, s63, 262144
  v_mfma_f32_16x16x32_bf16 v[188:191], a[60:63], a[240:243], v[188:191]
  s_cmp_ge_u32 s32, s54
  s_cselect_b32 s32, s78, s32
  s_add_u32 s65, s46, s47
  v_mfma_f32_16x16x32_bf16 v[220:223], a[60:63], a[244:247], v[220:223]
  s_cmp_ge_u32 s40, 15
  s_cselect_b32 s65, 196608, s65
  s_cselect_b32 s32, 1073741824, s32
  s_add_u32 s72, s32, 30720
  s_mov_b32 s33, s65
  s_waitcnt lgkmcnt(0)
  s_waitcnt vmcnt(12)
  s_barrier
  v_mfma_f32_16x16x32_bf16 v[96:99], a[0:3], a[212:215], v[96:99]
  s_mov_b32 m0, s33
  ds_read_b128 a[228:231], v59 offset:0
  ds_read_b128 a[232:235], v59 offset:2048
  v_mfma_f32_16x16x32_bf16 v[128:131], a[0:3], a[216:219], v[128:131]
  buffer_load_dwordx4 v54, s[12:15], s32 offen offset:0  lds
  v_mfma_f32_16x16x32_bf16 v[160:163], a[0:3], a[220:223], v[160:163]
  s_nop 0
  ds_read_b128 a[236:239], v59 offset:4096
  ds_read_b128 a[240:243], v59 offset:6144
  v_mfma_f32_16x16x32_bf16 v[192:195], a[0:3], a[224:227], v[192:195]
  buffer_load_dwordx4 v55, s[12:15], s32 offen offset:1024  lds
  v_mfma_f32_16x16x32_bf16 v[100:103], a[4:7], a[212:215], v[100:103]
  s_nop 0
  ds_read_b128 a[244:247], v59 offset:8192
  ds_read_b64_tr_b16 a[32:33], v64
  v_mfma_f32_16x16x32_bf16 v[132:135], a[4:7], a[216:219], v[132:135]
  buffer_load_dwordx4 v54, s[12:15], s72 offen offset:2048  lds
  v_mfma_f32_16x16x32_bf16 v[164:167], a[4:7], a[220:223], v[164:167]
  s_nop 0
  ds_read_b64_tr_b16 a[34:35], v64 offset:2048
  ds_read_b64_tr_b16 a[36:37], v65
  v_mfma_f32_16x16x32_bf16 v[196:199], a[4:7], a[224:227], v[196:199]
  buffer_load_dwordx4 v55, s[12:15], s72 offen offset:3072  lds
  v_mfma_f32_16x16x32_bf16 v[104:107], a[8:11], a[212:215], v[104:107]
  s_mov_b32 m0, s42
  ds_read_b64_tr_b16 a[38:39], v65 offset:2048
  ds_read_b64_tr_b16 a[40:41], v66
  v_mfma_f32_16x16x32_bf16 v[136:139], a[8:11], a[216:219], v[136:139]
  buffer_load_dwordx4 v56, s[68:71], s43 offen offset:0 nt lds
  v_mfma_f32_16x16x32_bf16 v[168:171], a[8:11], a[220:223], v[168:171]
  s_nop 0
  ds_read_b64_tr_b16 a[42:43], v66 offset:2048
  ds_read_b64_tr_b16 a[44:45], v67
  v_mfma_f32_16x16x32_bf16 v[200:203], a[8:11], a[224:227], v[200:203]
  buffer_load_dwordx4 v57, s[68:71], s43 offen offset:1024 nt lds
  v_mfma_f32_16x16x32_bf16 v[108:111], a[12:15], a[212:215], v[108:111]
  s_nop 0
  ds_read_b64_tr_b16 a[46:47], v67 offset:2048
  ds_read_b64_tr_b16 a[48:49], v68
  v_mfma_f32_16x16x32_bf16 v[140:143], a[12:15], a[216:219], v[140:143]
  buffer_load_dwordx4 v56, s[68:71], s43 offen offset:2048 nt lds
  v_mfma_f32_16x16x32_bf16 v[172:175], a[12:15], a[220:223], v[172:175]
  s_nop 0
  ds_read_b64_tr_b16 a[50:51], v68 offset:2048
  ds_read_b64_tr_b16 a[52:53], v69
  v_mfma_f32_16x16x32_bf16 v[204:207], a[12:15], a[224:227], v[204:207]
  buffer_load_dwordx4 v57, s[68:71], s43 offen offset:3072 nt lds
  v_mfma_f32_16x16x32_bf16 v[240:243], a[16:19], a[208:211], v[240:243]
  s_nop 0
  ds_read_b64_tr_b16 a[54:55], v69 offset:2048
  ds_read_b64_tr_b16 a[56:57], v70
  v_mfma_f32_16x16x32_bf16 v[112:115], a[16:19], a[212:215], v[112:115]
  s_nop 0
  ds_read_b64_tr_b16 a[58:59], v70 offset:2048
  ds_read_b64_tr_b16 a[60:61], v71
  v_mfma_f32_16x16x32_bf16 v[144:147], a[16:19], a[216:219], v[144:147]
  s_nop 0
  ds_read_b64_tr_b16 a[62:63], v71 offset:2048
  ds_read_b64_tr_b16 a[152:153], v10 offset:0
  v_mfma_f32_16x16x32_bf16 v[176:179], a[16:19], a[220:223], v[176:179]
  s_add_u32 s40, s40, 1
  ds_read_b64_tr_b16 a[154:155], v10 offset:4096
  v_add_u32 v58, s37, v58
  v_mfma_f32_16x16x32_bf16 v[208:211], a[16:19], a[224:227], v[208:211]
  s_add_u32 s38, s40, 3
  ds_read_b64_tr_b16 a[156:157], v11 offset:0
  v_add_u32 v59, s37, v59
  v_mfma_f32_16x16x32_bf16 v[244:247], a[20:23], a[208:211], v[244:247]
  s_lshr_b32 s38, s38, 1
  ds_read_b64_tr_b16 a[158:159], v11 offset:4096
  v_add_u32 v64, s36, v64
  v_mfma_f32_16x16x32_bf16 v[116:119], a[20:23], a[212:215], v[116:119]
  s_add_u32 s34, s38, s52
  ds_read_b64_tr_b16 a[160:161], v12 offset:0
  v_add_u32 v65, s36, v65
  v_mfma_f32_16x16x32_bf16 v[148:151], a[20:23], a[216:219], v[148:151]
  s_sub_u32 s35, s34, 9
  ds_read_b64_tr_b16 a[162:163], v12 offset:4096
  v_add_u32 v66, s36, v66
  v_mfma_f32_16x16x32_bf16 v[180:183], a[20:23], a[220:223], v[180:183]
  s_cmp_lt_u32 s34, 9
  ds_read_b64_tr_b16 a[164:165], v13 offset:0
  v_add_u32 v67, s36, v67
  v_mfma_f32_16x16x32_bf16 v[212:215], a[20:23], a[224:227], v[212:215]
  s_cselect_b32 s34, s34, s35
  ds_read_b64_tr_b16 a[166:167], v13 offset:4096
  v_add_u32 v68, s36, v68
  v_mfma_f32_16x16x32_bf16 v[248:251], a[24:27], a[208:211], v[248:251]
  s_lshl_b32 s34, s34, 7
  ds_read_b64_tr_b16 a[168:169], v14 offset:0
  v_add_u32 v69, s36, v69
  v_mfma_f32_16x16x32_bf16 v[120:123], a[24:27], a[212:215], v[120:123]
  s_add_u32 s34, s34, s75
  ds_read_b64_tr_b16 a[170:171], v14 offset:4096
  v_add_u32 v70, s36, v70
  v_mfma_f32_16x16x32_bf16 v[152:155], a[24:27], a[216:219], v[152:155]
  s_and_b32 s38, s38, 1
  ds_read_b64_tr_b16 a[172:173], v15 offset:0
  v_add_u32 v71, s36, v71
  v_mfma_f32_16x16x32_bf16 v[184:187], a[24:27], a[220:223], v[184:187]
  s_mul_i32 s38, s38, 18432
  ds_read_b64_tr_b16 a[174:175], v15 offset:4096
  s_add_u32 s35, s74, s38
  v_mfma_f32_16x16x32_bf16 v[216:219], a[24:27], a[224:227], v[216:219]
  s_cmp_ge_u32 s40, 15
  s_cselect_b32 s35, 196608, s35
  s_cselect_b32 s34, 1073741824, s34
  v_mfma_f32_16x16x32_bf16 v[252:255], a[28:31], a[208:211], v[252:255]
  s_add_u32 s46, s46, 8192
  s_cmp_eq_u32 s46, 24576
  s_cselect_b32 s46, 0, s46
  v_mfma_f32_16x16x32_bf16 v[124:127], a[28:31], a[212:215], v[124:127]
  s_cmp_eq_u32 s46, 8192
  s_cselect_b32 s62, s51, s48
  s_add_u32 s63, s32, 262144
  v_mfma_f32_16x16x32_bf16 v[156:159], a[28:31], a[216:219], v[156:159]
  s_cmp_ge_u32 s63, s54
  s_cselect_b32 s63, s78, s63
  s_add_u32 s65, s46, s47
  v_mfma_f32_16x16x32_bf16 v[188:191], a[28:31], a[220:223], v[188:191]
  s_cmp_ge_u32 s40, 15
  s_cselect_b32 s65, 196608, s65
  s_cselect_b32 s63, 1073741824, s63
  v_mfma_f32_16x16x32_bf16 v[220:223], a[28:31], a[224:227], v[220:223]
  s_add_u32 s64, s63, 30720
  s_mov_b32 s33, s65
  s_sub_u32 s37, 0, s37
  s_waitcnt lgkmcnt(0)
  s_waitcnt vmcnt(8)
  s_barrier
  v_mfma_f32_16x16x32_bf16 v[96:99], a[32:35], a[232:235], v[96:99]
  s_mov_b32 m0, s35
  ds_read_b128 a[208:211], v58 offset:0
  v_mfma_f32_16x16x32_bf16 v[128:131], a[32:35], a[236:239], v[128:131]
  buffer_load_dwordx4 v53, s[8:11], s34 offen offset:0  lds
  v_mfma_f32_16x16x32_bf16 v[160:163], a[32:35], a[240:243], v[160:163]
  s_add_u32 s34, s34, 16384
  ds_read_b128 a[212:215], v58 offset:2048
  v_mfma_f32_16x16x32_bf16 v[192:195], a[32:35], a[244:247], v[192:195]
  buffer_load_dwordx4 v53, s[8:11], s34 offen offset:2048  lds
  v_mfma_f32_16x16x32_bf16 v[100:103], a[36:39], a[232:235], v[100:103]
  s_add_u32 s34, s34, 20480
  ds_read_b128 a[216:219], v58 offset:4096
  s_add_u32 m0, m0, 4096
  v_mfma_f32_16x16x32_bf16 v[132:135], a[36:39], a[236:239], v[132:135]
  buffer_load_dwordx4 v53, s[8:11], s34 offen offset:0  lds
  v_mfma_f32_16x16x32_bf16 v[164:167], a[36:39], a[240:243], v[164:167]
  s_add_u32 s34, s34, 16384
  ds_read_b128 a[220:223], v58 offset:6144
  s_add_u32 s40, s40, 1
  v_mfma_f32_16x16x32_bf16 v[196:199], a[36:39], a[244:247], v[196:199]
  buffer_load_dwordx4 v53, s[8:11], s34 offen offset:2048  lds
  v_mfma_f32_16x16x32_bf16 v[104:107], a[40:43], a[232:235], v[104:107]
  s_mov_b32 m0, s33
  ds_read_b128 a[224:227], v58 offset:8192
  s_ashr_i32 s41, s40, 1
  v_mfma_f32_16x16x32_bf16 v[136:139], a[40:43], a[236:239], v[136:139]
  s_sub_u32 s41, s41, s53
  ds_read_b64_tr_b16 a[0:1], v64
  s_mul_i32 s41, s41, 2
  v_mfma_f32_16x16x32_bf16 v[168:171], a[40:43], a[240:243], v[168:171]
  s_lshr_b32 s38, s41, 1
  ds_read_b64_tr_b16 a[2:3], v64 offset:2048
  v_add_u32 v64, s62, v64
  v_mfma_f32_16x16x32_bf16 v[200:203], a[40:43], a[244:247], v[200:203]
  buffer_load_dwordx4 v54, s[12:15], s63 offen offset:0  lds
  v_mfma_f32_16x16x32_bf16 v[108:111], a[44:47], a[232:235], v[108:111]
  s_add_u32 s43, s38, s30
  ds_read_b64_tr_b16 a[4:5], v65
  s_and_b32 s43, s43, 31
  v_mfma_f32_16x16x32_bf16 v[140:143], a[44:47], a[236:239], v[140:143]
  s_lshl_b32 s43, s43, 12
  ds_read_b64_tr_b16 a[6:7], v65 offset:2048
  v_add_u32 v65, s62, v65
  v_mfma_f32_16x16x32_bf16 v[172:175], a[44:47], a[240:243], v[172:175]
  s_and_b32 s38, s41, 1
  ds_read_b64_tr_b16 a[8:9], v66
  s_lshl_b32 s38, s38, 11
  v_mfma_f32_16x16x32_bf16 v[204:207], a[44:47], a[244:247], v[204:207]
  s_add_u32 s43, s43, s38
  ds_read_b64_tr_b16 a[10:11], v66 offset:2048
  v_add_u32 v66, s62, v66
  v_mfma_f32_16x16x32_bf16 v[240:243], a[48:51], a[228:231], v[240:243]
  buffer_load_dwordx4 v55, s[12:15], s63 offen offset:1024  lds
  v_mfma_f32_16x16x32_bf16 v[112:115], a[48:51], a[232:235], v[112:115]
  s_bfe_u32 s42, s41, 0x10002
  ds_read_b64_tr_b16 a[12:13], v67
  s_lshl_b32 s42, s42, 14
  v_mfma_f32_16x16x32_bf16 v[144:147], a[48:51], a[236:239], v[144:147]
  s_and_b32 s38, s41, 3
  ds_read_b64_tr_b16 a[14:15], v67 offset:2048
  v_add_u32 v67, s62, v67
  v_mfma_f32_16x16x32_bf16 v[176:179], a[48:51], a[240:243], v[176:179]
  s_lshl_b32 s38, s38, 11
  ds_read_b64_tr_b16 a[16:17], v68
  s_add_u32 s42, s42, s38
  v_mfma_f32_16x16x32_bf16 v[208:211], a[48:51], a[244:247], v[208:211]
  s_add_u32 s42, s42, s39
  ds_read_b64_tr_b16 a[18:19], v68 offset:2048
  v_add_u32 v68, s62, v68
  v_mfma_f32_16x16x32_bf16 v[244:247], a[52:55], a[228:231], v[244:247]
  buffer_load_dwordx4 v54, s[12:15], s64 offen offset:2048  lds
  v_mfma_f32_16x16x32_bf16 v[116:119], a[52:55], a[232:235], v[116:119]
  s_cmp_ge_u32 s41, 16
  ds_read_b64_tr_b16 a[20:21], v69
  s_cselect_b32 s42, 196608, s42
  v_mfma_f32_16x16x32_bf16 v[148:151], a[52:55], a[236:239], v[148:151]
  s_cselect_b32 s43, 1073741824, s43
  ds_read_b64_tr_b16 a[22:23], v69 offset:2048
  v_add_u32 v69, s62, v69
  v_mfma_f32_16x16x32_bf16 v[180:183], a[52:55], a[240:243], v[180:183]
  s_add_u32 s46, s46, 8192
  ds_read_b64_tr_b16 a[24:25], v70
  s_cmp_eq_u32 s46, 24576
  v_mfma_f32_16x16x32_bf16 v[212:215], a[52:55], a[244:247], v[212:215]
  s_cselect_b32 s46, 0, s46
  ds_read_b64_tr_b16 a[26:27], v70 offset:2048
  v_add_u32 v70, s62, v70
  v_mfma_f32_16x16x32_bf16 v[248:251], a[56:59], a[228:231], v[248:251]
  buffer_load_dwordx4 v55, s[12:15], s64 offen offset:3072  lds
  v_mfma_f32_16x16x32_bf16 v[120:123], a[56:59], a[232:235], v[120:123]
  s_cmp_eq_u32 s46, 8192
  ds_read_b64_tr_b16 a[28:29], v71
  s_cselect_b32 s36, s51, s48
  v_mfma_f32_16x16x32_bf16 v[152:155], a[56:59], a[236:239], v[152:155]
  s_add_u32 s32, s63, 262144
  ds_read_b64_tr_b16 a[30:31], v71 offset:2048
  v_add_u32 v71, s62, v71
  v_mfma_f32_16x16x32_bf16 v[184:187], a[56:59], a[240:243], v[184:187]
  s_cmp_ge_u32 s32, s54
  s_cselect_b32 s32, s78, s32
  s_add_u32 s65, s46, s47
  v_mfma_f32_16x16x32_bf16 v[216:219], a[56:59], a[244:247], v[216:219]
  s_cmp_ge_u32 s40, 15
  s_cselect_b32 s65, 196608, s65
  s_cselect_b32 s32, 1073741824, s32
  v_mfma_f32_16x16x32_bf16 v[252:255], a[60:63], a[228:231], v[252:255]
  s_add_u32 s72, s32, 30720
  s_mov_b32 s33, s65
  v_mfma_f32_16x16x32_bf16 v[124:127], a[60:63], a[232:235], v[124:127]
  v_mfma_f32_16x16x32_bf16 v[156:159], a[60:63], a[236:239], v[156:159]
  v_mfma_f32_16x16x32_bf16 v[188:191], a[60:63], a[240:243], v[188:191]
  v_mfma_f32_16x16x32_bf16 v[220:223], a[60:63], a[244:247], v[220:223]
  s_waitcnt lgkmcnt(0)
  s_waitcnt vmcnt(12)
  s_barrier
  v_mfma_f32_16x16x32_bf16 v[96:99], a[0:3], a[212:215], v[96:99]
  s_mov_b32 m0, s33
  ds_read_b128 a[228:231], v59 offset:0
  s_add_u32 s40, s40, 1
  v_mfma_f32_16x16x32_bf16 v[128:131], a[0:3], a[216:219], v[128:131]
  buffer_load_dwordx4 v54, s[12:15], s32 offen offset:0  lds
  v_mfma_f32_16x16x32_bf16 v[160:163], a[0:3], a[220:223], v[160:163]
  s_add_u32 s38, s40, 3
  ds_read_b128 a[232:235], v59 offset:2048
  s_lshr_b32 s38, s38, 1
  v_mfma_f32_16x16x32_bf16 v[192:195], a[0:3], a[224:227], v[192:195]
  buffer_load_dwordx4 v55, s[12:15], s32 offen offset:1024  lds
  v_mfma_f32_16x16x32_bf16 v[100:103], a[4:7], a[212:215], v[100:103]
  s_add_u32 s34, s38, s52
  ds_read_b128 a[236:239], v59 offset:4096
  s_sub_u32 s35, s34, 9
  v_mfma_f32_16x16x32_bf16 v[132:135], a[4:7], a[216:219], v[132:135]
  buffer_load_dwordx4 v54, s[12:15], s72 offen offset:2048  lds
  v_mfma_f32_16x16x32_bf16 v[164:167], a[4:7], a[220:223], v[164:167]
  s_cmp_lt_u32 s34, 9
  ds_read_b128 a[240:243], v59 offset:6144
  v_add_u32 v58, s37, v58
  v_mfma_f32_16x16x32_bf16 v[196:199], a[4:7], a[224:227], v[196:199]
  buffer_load_dwordx4 v55, s[12:15], s72 offen offset:3072  lds
  v_mfma_f32_16x16x32_bf16 v[104:107], a[8:11], a[212:215], v[104:107]
  s_mov_b32 m0, s42
  ds_read_b128 a[244:247], v59 offset:8192
  v_add_u32 v59, s37, v59
  v_mfma_f32_16x16x32_bf16 v[136:139], a[8:11], a[216:219], v[136:139]
  buffer_load_dwordx4 v56, s[68:71], s43 offen offset:0 nt lds
  v_mfma_f32_16x16x32_bf16 v[168:171], a[8:11], a[220:223], v[168:171]
  s_cselect_b32 s34, s34, s35
  ds_read_b64_tr_b16 a[32:33], v64
  s_lshl_b32 s34, s34, 7
  v_mfma_f32_16x16x32_bf16 v[200:203], a[8:11], a[224:227], v[200:203]
  buffer_load_dwordx4 v57, s[68:71], s43 offen offset:1024 nt lds
  v_mfma_f32_16x16x32_bf16 v[108:111], a[12:15], a[212:215], v[108:111]
  s_add_u32 s34, s34, s75
  ds_read_b64_tr_b16 a[34:35], v64 offset:2048
  v_add_u32 v64, s36, v64
  v_mfma_f32_16x16x32_bf16 v[140:143], a[12:15], a[216:219], v[140:143]
  buffer_load_dwordx4 v56, s[68:71], s43 offen offset:2048 nt lds
  v_mfma_f32_16x16x32_bf16 v[172:175], a[12:15], a[220:223], v[172:175]
  s_and_b32 s38, s38, 1
  ds_read_b64_tr_b16 a[36:37], v65
  s_mul_i32 s38, s38, 18432
  v_mfma_f32_16x16x32_bf16 v[204:207], a[12:15], a[224:227], v[204:207]
  buffer_load_dwordx4 v57, s[68:71], s43 offen offset:3072 nt lds
  v_mfma_f32_16x16x32_bf16 v[240:243], a[16:19], a[208:211], v[240:243]
  s_add_u32 s35, s74, s38
  ds_read_b64_tr_b16 a[38:39], v65 offset:2048
  v_add_u32 v65, s36, v65
  v_mfma_f32_16x16x32_bf16 v[112:115], a[16:19], a[212:215], v[112:115]
  s_cmp_ge_u32 s40, 15
  ds_read_b64_tr_b16 a[40:41], v66
  s_cselect_b32 s35, 196608, s35
  v_mfma_f32_16x16x32_bf16 v[144:147], a[16:19], a[216:219], v[144:147]
  s_cselect_b32 s34, 1073741824, s34
  ds_read_b64_tr_b16 a[42:43], v66 offset:2048
  v_add_u32 v66, s36, v66
  v_mfma_f32_16x16x32_bf16 v[176:179], a[16:19], a[220:223], v[176:179]
  s_add_u32 s46, s46, 8192
  ds_read_b64_tr_b16 a[44:45], v67
  s_cmp_eq_u32 s46, 24576
  v_mfma_f32_16x16x32_bf16 v[208:211], a[16:19], a[224:227], v[208:211]
  s_cselect_b32 s46, 0, s46
  ds_read_b64_tr_b16 a[46:47], v67 offset:2048
  v_add_u32 v67, s36, v67
  v_mfma_f32_16x16x32_bf16 v[244:247], a[20:23], a[208:211], v[244:247]
  s_cmp_eq_u32 s46, 8192
  ds_read_b64_tr_b16 a[48:49], v68
  s_cselect_b32 s62, s51, s48
  v_mfma_f32_16x16x32_bf16 v[116:119], a[20:23], a[212:215], v[116:119]
  s_add_u32 s63, s32, 262144
  ds_read_b64_tr_b16 a[50:51], v68 offset:2048
  v_add_u32 v68, s36, v68
  v_mfma_f32_16x16x32_bf16 v[148:151], a[20:23], a[216:219], v[148:151]
  s_cmp_ge_u32 s63, s54
  ds_read_b64_tr_b16 a[52:53], v69
  s_cselect_b32 s63, s78, s63
  v_mfma_f32_16x16x32_bf16 v[180:183], a[20:23], a[220:223], v[180:183]
  s_add_u32 s65, s46, s47
  ds_read_b64_tr_b16 a[54:55], v69 offset:2048
  v_add_u32 v69, s36, v69
  v_mfma_f32_16x16x32_bf16 v[212:215], a[20:23], a[224:227], v[212:215]
  s_cmp_ge_u32 s40, 15
  ds_read_b64_tr_b16 a[56:57], v70
  s_cselect_b32 s65, 196608, s65
  v_mfma_f32_16x16x32_bf16 v[248:251], a[24:27], a[208:211], v[248:251]
  s_cselect_b32 s63, 1073741824, s63
  ds_read_b64_tr_b16 a[58:59], v70 offset:2048
  v_add_u32 v70, s36, v70
  v_mfma_f32_16x16x32_bf16 v[120:123], a[24:27], a[212:215], v[120:123]
  s_add_u32 s64, s63, 30720
  ds_read_b64_tr_b16 a[60:61], v71
  s_mov_b32 s33, s65
  v_mfma_f32_16x16x32_bf16 v[152:155], a[24:27], a[216:219], v[152:155]
  s_sub_u32 s37, 0, s37
  ds_read_b64_tr_b16 a[62:63], v71 offset:2048
  v_add_u32 v71, s36, v71
  v_mfma_f32_16x16x32_bf16 v[184:187], a[24:27], a[220:223], v[184:187]
  v_mfma_f32_16x16x32_bf16 v[216:219], a[24:27], a[224:227], v[216:219]
  v_mfma_f32_16x16x32_bf16 v[252:255], a[28:31], a[208:211], v[252:255]
  v_mfma_f32_16x16x32_bf16 v[124:127], a[28:31], a[212:215], v[124:127]
  v_mfma_f32_16x16x32_bf16 v[156:159], a[28:31], a[216:219], v[156:159]
  v_mfma_f32_16x16x32_bf16 v[188:191], a[28:31], a[220:223], v[188:191]
  v_mfma_f32_16x16x32_bf16 v[220:223], a[28:31], a[224:227], v[220:223]
  s_waitcnt lgkmcnt(0)
  s_waitcnt vmcnt(8)
  s_barrier
  v_mfma_f32_16x16x32_bf16 v[96:99], a[32:35], a[232:235], v[96:99]
  s_mov_b32 m0, s35
  ds_read_b128 a[208:211], v58 offset:0
  ds_read_b128 a[212:215], v58 offset:2048
  v_mfma_f32_16x16x32_bf16 v[128:131], a[32:35], a[236:239], v[128:131]
  buffer_load_dwordx4 v53, s[8:11], s34 offen offset:0  lds
  v_mfma_f32_16x16x32_bf16 v[160:163], a[32:35], a[240:243], v[160:163]
  s_add_u32 s34, s34, 16384
  ds_read_b128 a[216:219], v58 offset:4096
  ds_read_b128 a[220:223], v58 offset:6144
  v_mfma_f32_16x16x32_bf16 v[192:195], a[32:35], a[244:247], v[192:195]
  buffer_load_dwordx4 v53, s[8:11], s34 offen offset:2048  lds
  v_mfma_f32_16x16x32_bf16 v[100:103], a[36:39], a[232:235], v[100:103]
  s_add_u32 s34, s34, 20480
  ds_read_b128 a[224:227], v58 offset:8192
  s_add_u32 m0, m0, 4096
  v_mfma_f32_16x16x32_bf16 v[132:135], a[36:39], a[236:239], v[132:135]
  buffer_load_dwordx4 v53, s[8:11], s34 offen offset:0  lds
  ds_read_b64_tr_b16 a[0:1], v64
  v_mfma_f32_16x16x32_bf16 v[164:167], a[36:39], a[240:243], v[164:167]
  s_add_u32 s34, s34, 16384
  ds_read_b64_tr_b16 a[2:3], v64 offset:2048
  ds_read_b64_tr_b16 a[4:5], v65
  v_mfma_f32_16x16x32_bf16 v[196:199], a[36:39], a[244:247], v[196:199]
  buffer_load_dwordx4 v53, s[8:11], s34 offen offset:2048  lds
  v_mfma_f32_16x16x32_bf16 v[104:107], a[40:43], a[232:235], v[104:107]
  s_mov_b32 m0, s33
  ds_read_b64_tr_b16 a[6:7], v65 offset:2048
  ds_read_b64_tr_b16 a[8:9], v66
  v_mfma_f32_16x16x32_bf16 v[136:139], a[40:43], a[236:239], v[136:139]
  s_nop 0
  ds_read_b64_tr_b16 a[10:11], v66 offset:2048
  ds_read_b64_tr_b16 a[12:13], v67
  v_mfma_f32_16x16x32_bf16 v[168:171], a[40:43], a[240:243], v[168:171]
  s_nop 0
  ds_read_b64_tr_b16 a[14:15], v67 offset:2048
  ds_read_b64_tr_b16 a[16:17], v68
  v_mfma_f32_16x16x32_bf16 v[200:203], a[40:43], a[244:247], v[200:203]
  buffer_load_dwordx4 v54, s[12:15], s63 offen offset:0  lds
  v_mfma_f32_16x16x32_bf16 v[108:111], a[44:47], a[232:235], v[108:111]
  s_nop 0
  ds_read_b64_tr_b16 a[18:19], v68 offset:2048
  ds_read_b64_tr_b16 a[20:21], v69
  v_mfma_f32_16x16x32_bf16 v[140:143], a[44:47], a[236:239], v[140:143]
  s_nop 0
  ds_read_b64_tr_b16 a[22:23], v69 offset:2048
  ds_read_b64_tr_b16 a[24:25], v70
  v_mfma_f32_16x16x32_bf16 v[172:175], a[44:47], a[240:243], v[172:175]
  s_nop 0
  ds_read_b64_tr_b16 a[26:27], v70 offset:2048
  ds_read_b64_tr_b16 a[28:29], v71
  v_mfma_f32_16x16x32_bf16 v[204:207], a[44:47], a[244:247], v[204:207]
  s_nop 0
  ds_read_b64_tr_b16 a[30:31], v71 offset:2048
  ds_read_b128 a[112:115], v60 offset:16384
  v_mfma_f32_16x16x32_bf16 v[240:243], a[48:51], a[228:231], v[240:243]
  buffer_load_dwordx4 v55, s[12:15], s63 offen offset:1024  lds
  v_mfma_f32_16x16x32_bf16 v[112:115], a[48:51], a[232:235], v[112:115]
  s_add_u32 s40, s40, 1
  ds_read_b128 a[116:119], v61 offset:16384
  v_add_u32 v64, s62, v64
  v_mfma_f32_16x16x32_bf16 v[144:147], a[48:51], a[236:239], v[144:147]
  s_ashr_i32 s41, s40, 1
  ds_read_b128 a[120:123], v62 offset:16384
  v_add_u32 v65, s62, v65
  v_mfma_f32_16x16x32_bf16 v[176:179], a[48:51], a[240:243], v[176:179]
  s_sub_u32 s41, s41, s53
  ds_read_b128 a[124:127], v63 offset:16384
  v_add_u32 v66, s62, v66
  v_mfma_f32_16x16x32_bf16 v[208:211], a[48:51], a[244:247], v[208:211]
  s_mul_i32 s41, s41, 2
  ds_read_b128 a[128:131], v60 offset:20480
  v_add_u32 v67, s62, v67
  v_mfma_f32_16x16x32_bf16 v[244:247], a[52:55], a[228:231], v[244:247]
  buffer_load_dwordx4 v54, s[12:15], s64 offen offset:2048  lds
  v_mfma_f32_16x16x32_bf16 v[116:119], a[52:55], a[232:235], v[116:119]
  s_lshr_b32 s38, s41, 1
  ds_read_b128 a[132:135], v61 offset:20480
  v_add_u32 v68, s62, v68
  v_mfma_f32_16x16x32_bf16 v[148:151], a[52:55], a[236:239], v[148:151]
  s_add_u32 s43, s38, s30
  ds_read_b128 a[136:139], v62 offset:20480
  v_add_u32 v69, s62, v69
  v_mfma_f32_16x16x32_bf16 v[180:183], a[52:55], a[240:243], v[180:183]
  s_and_b32 s43, s43, 31
  ds_read_b128 a[140:143], v63 offset:20480
  v_add_u32 v70, s62, v70
  v_mfma_f32_16x16x32_bf16 v[212:215], a[52:55], a[244:247], v[212:215]
  s_lshl_b32 s43, s43, 12
  ds_read_b64_tr_b16 a[176:177], v8 offset:16384
  v_add_u32 v71, s62, v71
  v_mfma_f32_16x16x32_bf16 v[248:251], a[56:59], a[228:231], v[248:251]
  buffer_load_dwordx4 v55, s[12:15], s64 offen offset:3072  lds
  v_mfma_f32_16x16x32_bf16 v[120:123], a[56:59], a[232:235], v[120:123]
  s_and_b32 s38, s41, 1
  ds_read_b64_tr_b16 a[178:179], v8 offset:20480
  s_lshl_b32 s38, s38, 11
  v_mfma_f32_16x16x32_bf16 v[152:155], a[56:59], a[236:239], v[152:155]
  s_add_u32 s43, s43, s38
  ds_read_b64_tr_b16 a[180:181], v9 offset:16384
  s_bfe_u32 s42, s41, 0x10002
  v_mfma_f32_16x16x32_bf16 v[184:187], a[56:59], a[240:243], v[184:187]
  s_lshl_b32 s42, s42, 14
  ds_read_b64_tr_b16 a[182:183], v9 offset:20480
  s_and_b32 s38, s41, 3
  v_mfma_f32_16x16x32_bf16 v[216:219], a[56:59], a[244:247], v[216:219]
  s_lshl_b32 s38, s38, 11
  s_add_u32 s42, s42, s38
  s_add_u32 s42, s42, s39
  v_mfma_f32_16x16x32_bf16 v[252:255], a[60:63], a[228:231], v[252:255]
  s_cmp_ge_u32 s41, 16
  s_cselect_b32 s42, 196608, s42
  s_cselect_b32 s43, 1073741824, s43
  v_mfma_f32_16x16x32_bf16 v[124:127], a[60:63], a[232:235], v[124:127]
  s_add_u32 s46, s46, 8192
  s_cmp_eq_u32 s46, 24576
  s_cselect_b32 s46, 0, s46
  v_mfma_f32_16x16x32_bf16 v[156:159], a[60:63], a[236:239], v[156:159]
  s_cmp_eq_u32 s46, 8192
  s_cselect_b32 s36, s51, s48
  s_add_u32 s32, s63, 262144
  v_mfma_f32_16x16x32_bf16 v[188:191], a[60:63], a[240:243], v[188:191]
  s_cmp_ge_u32 s32, s54
  s_cselect_b32 s32, s78, s32
  s_add_u32 s65, s46, s47
  v_mfma_f32_16x16x32_bf16 v[220:223], a[60:63], a[244:247], v[220:223]
  s_cmp_ge_u32 s40, 15
  s_cselect_b32 s65, 196608, s65
  s_cselect_b32 s32, 1073741824, s32
  s_add_u32 s72, s32, 30720
  s_mov_b32 s33, s65
  s_waitcnt lgkmcnt(0)
  s_waitcnt vmcnt(12)
  s_barrier
  v_mfma_f32_16x16x32_bf16 v[96:99], a[0:3], a[212:215], v[96:99]
  s_mov_b32 m0, s33
  ds_read_b128 a[228:231], v59 offset:0
  ds_read_b128 a[232:235], v59 offset:2048
  v_mfma_f32_16x16x32_bf16 v[128:131], a[0:3], a[216:219], v[128:131]
  buffer_load_dwordx4 v54, s[12:15], s32 offen offset:0  lds
  v_mfma_f32_16x16x32_bf16 v[160:163], a[0:3], a[220:223], v[160:163]
  s_nop 0
  ds_read_b128 a[236:239], v59 offset:4096
  ds_read_b128 a[240:243], v59 offset:6144
  v_mfma_f32_16x16x32_bf16 v[192:195], a[0:3], a[224:227], v[192:195]
  buffer_load_dwordx4 v55, s[12:15], s32 offen offset:1024  lds
  v_mfma_f32_16x16x32_bf16 v[100:103], a[4:7], a[212:215], v[100:103]
  s_nop 0
  ds_read_b128 a[244:247], v59 offset:8192
  ds_read_b64_tr_b16 a[32:33], v64
  v_mfma_f32_16x16x32_bf16 v[132:135], a[4:7], a[216:219], v[132:135]
  buffer_load_dwordx4 v54, s[12:15], s72 offen offset:2048  lds
  v_mfma_f32_16x16x32_bf16 v[164:167], a[4:7], a[220:223], v[164:167]
  s_nop 0
  ds_read_b64_tr_b16 a[34:35], v64 offset:2048
  ds_read_b64_tr_b16 a[36:37], v65
  v_mfma_f32_16x16x32_bf16 v[196:199], a[4:7], a[224:227], v[196:199]
  buffer_load_dwordx4 v55, s[12:15], s72 offen offset:3072  lds
  v_mfma_f32_16x16x32_bf16 v[104:107], a[8:11], a[212:215], v[104:107]
  s_mov_b32 m0, s42
  ds_read_b64_tr_b16 a[38:39], v65 offset:2048
  ds_read_b64_tr_b16 a[40:41], v66
  v_mfma_f32_16x16x32_bf16 v[136:139], a[8:11], a[216:219], v[136:139]
  buffer_load_dwordx4 v56, s[68:71], s43 offen offset:0 nt lds
  v_mfma_f32_16x16x32_bf16 v[168:171], a[8:11], a[220:223], v[168:171]
  s_nop 0
  ds_read_b64_tr_b16 a[42:43], v66 offset:2048
  ds_read_b64_tr_b16 a[44:45], v67
  v_mfma_f32_16x16x32_bf16 v[200:203], a[8:11], a[224:227], v[200:203]
  buffer_load_dwordx4 v57, s[68:71], s43 offen offset:1024 nt lds
  v_mfma_f32_16x16x32_bf16 v[108:111], a[12:15], a[212:215], v[108:111]
  s_nop 0
  ds_read_b64_tr_b16 a[46:47], v67 offset:2048
  ds_read_b64_tr_b16 a[48:49], v68
  v_mfma_f32_16x16x32_bf16 v[140:143], a[12:15], a[216:219], v[140:143]
  buffer_load_dwordx4 v56, s[68:71], s43 offen offset:2048 nt lds
  v_mfma_f32_16x16x32_bf16 v[172:175], a[12:15], a[220:223], v[172:175]
  s_nop 0
  ds_read_b64_tr_b16 a[50:51], v68 offset:2048
  ds_read_b64_tr_b16 a[52:53], v69
  v_mfma_f32_16x16x32_bf16 v[204:207], a[12:15], a[224:227], v[204:207]
  buffer_load_dwordx4 v57, s[68:71], s43 offen offset:3072 nt lds
  v_mfma_f32_16x16x32_bf16 v[240:243], a[16:19], a[208:211], v[240:243]
  s_nop 0
  ds_read_b64_tr_b16 a[54:55], v69 offset:2048
  ds_read_b64_tr_b16 a[56:57], v70
  v_mfma_f32_16x16x32_bf16 v[112:115], a[16:19], a[212:215], v[112:115]
  s_nop 0
  ds_read_b64_tr_b16 a[58:59], v70 offset:2048
  ds_read_b64_tr_b16 a[60:61], v71
  v_mfma_f32_16x16x32_bf16 v[144:147], a[16:19], a[216:219], v[144:147]
  s_nop 0
  ds_read_b64_tr_b16 a[62:63], v71 offset:2048
  ds_read_b64_tr_b16 a[184:185], v10 offset:16384
  v_mfma_f32_16x16x32_bf16 v[176:179], a[16:19], a[220:223], v[176:179]
  s_add_u32 s40, s40, 1
  ds_read_b64_tr_b16 a[186:187], v10 offset:20480
  v_add_u32 v58, s37, v58
  v_mfma_f32_16x16x32_bf16 v[208:211], a[16:19], a[224:227], v[208:211]
  s_add_u32 s38, s40, 3
  ds_read_b64_tr_b16 a[188:189], v11 offset:16384
  v_add_u32 v59, s37, v59
  v_mfma_f32_16x16x32_bf16 v[244:247], a[20:23], a[208:211], v[244:247]
  s_lshr_b32 s38, s38, 1
  ds_read_b64_tr_b16 a[190:191], v11 offset:20480
  v_add_u32 v64, s36, v64
  v_mfma_f32_16x16x32_bf16 v[116:119], a[20:23], a[212:215], v[116:119]
  s_add_u32 s34, s38, s52
  ds_read_b64_tr_b16 a[192:193], v12 offset:16384
  v_add_u32 v65, s36, v65
  v_mfma_f32_16x16x32_bf16 v[148:151], a[20:23], a[216:219], v[148:151]
  s_sub_u32 s35, s34, 9
  ds_read_b64_tr_b16 a[194:195], v12 offset:20480
  v_add_u32 v66, s36, v66
  v_mfma_f32_16x16x32_bf16 v[180:183], a[20:23], a[220:223], v[180:183]
  s_cmp_lt_u32 s34, 9
  ds_read_b64_tr_b16 a[196:197], v13 offset:16384
  v_add_u32 v67, s36, v67
  v_mfma_f32_16x16x32_bf16 v[212:215], a[20:23], a[224:227], v[212:215]
  s_cselect_b32 s34, s34, s35
  ds_read_b64_tr_b16 a[198:199], v13 offset:20480
  v_add_u32 v68, s36, v68
  v_mfma_f32_16x16x32_bf16 v[248:251], a[24:27], a[208:211], v[248:251]
  s_lshl_b32 s34, s34, 7
  ds_read_b64_tr_b16 a[200:201], v14 offset:16384
  v_add_u32 v69, s36, v69
  v_mfma_f32_16x16x32_bf16 v[120:123], a[24:27], a[212:215], v[120:123]
  s_add_u32 s34, s34, s75
  ds_read_b64_tr_b16 a[202:203], v14 offset:20480
  v_add_u32 v70, s36, v70
  v_mfma_f32_16x16x32_bf16 v[152:155], a[24:27], a[216:219], v[152:155]
  s_and_b32 s38, s38, 1
  ds_read_b64_tr_b16 a[204:205], v15 offset:16384
  v_add_u32 v71, s36, v71
  v_mfma_f32_16x16x32_bf16 v[184:187], a[24:27], a[220:223], v[184:187]
  s_mul_i32 s38, s38, 18432
  ds_read_b64_tr_b16 a[206:207], v15 offset:20480
  s_add_u32 s35, s74, s38
  v_mfma_f32_16x16x32_bf16 v[216:219], a[24:27], a[224:227], v[216:219]
  s_cmp_ge_u32 s40, 15
  s_cselect_b32 s35, 196608, s35
  s_cselect_b32 s34, 1073741824, s34
  v_mfma_f32_16x16x32_bf16 v[252:255], a[28:31], a[208:211], v[252:255]
  s_add_u32 s46, s46, 8192
  s_cmp_eq_u32 s46, 24576
  s_cselect_b32 s46, 0, s46
  v_mfma_f32_16x16x32_bf16 v[124:127], a[28:31], a[212:215], v[124:127]
  s_cmp_eq_u32 s46, 8192
  s_cselect_b32 s62, s51, s48
  s_add_u32 s63, s32, 262144
  v_mfma_f32_16x16x32_bf16 v[156:159], a[28:31], a[216:219], v[156:159]
  s_cmp_ge_u32 s63, s54
  s_cselect_b32 s63, s78, s63
  s_add_u32 s65, s46, s47
  v_mfma_f32_16x16x32_bf16 v[188:191], a[28:31], a[220:223], v[188:191]
  s_cmp_ge_u32 s40, 15
  s_cselect_b32 s65, 196608, s65
  s_cselect_b32 s63, 1073741824, s63
  v_mfma_f32_16x16x32_bf16 v[220:223], a[28:31], a[224:227], v[220:223]
  s_add_u32 s64, s63, 30720
  s_mov_b32 s33, s65
  s_sub_u32 s37, 0, s37
  s_waitcnt lgkmcnt(0)
  s_waitcnt vmcnt(8)
  s_barrier
  v_mfma_f32_16x16x32_bf16 v[96:99], a[32:35], a[232:235], v[96:99]
  s_mov_b32 m0, s35
  ds_read_b128 a[208:211], v58 offset:0
  v_mfma_f32_16x16x32_bf16 v[128:131], a[32:35], a[236:239], v[128:131]
  buffer_load_dwordx4 v53, s[8:11], s34 offen offset:0  lds
  v_mfma_f32_16x16x32_bf16 v[160:163], a[32:35], a[240:243], v[160:163]
  s_add_u32 s34, s34, 16384
  ds_read_b128 a[212:215], v58 offset:2048
  v_mfma_f32_16x16x32_bf16 v[192:195], a[32:35], a[244:247], v[192:195]
  buffer_load_dwordx4 v53, s[8:11], s34 offen offset:2048  lds
  v_mfma_f32_16x16x32_bf16 v[100:103], a[36:39], a[232:235], v[100:103]
  s_add_u32 s34, s34, 20480
  ds_read_b128 a[216:219], v58 offset:4096
  s_add_u32 m0, m0, 4096
  v_mfma_f32_16x16x32_bf16 v[132:135], a[36:39], a[236:239], v[132:135]
  buffer_load_dwordx4 v53, s[8:11], s34 offen offset:0  lds
  v_mfma_f32_16x16x32_bf16 v[164:167], a[36:39], a[240:243], v[164:167]
  s_add_u32 s34, s34, 16384
  ds_read_b128 a[220:223], v58 offset:6144
  s_add_u32 s40, s40, 1
  v_mfma_f32_16x16x32_bf16 v[196:199], a[36:39], a[244:247], v[196:199]
  buffer_load_dwordx4 v53, s[8:11], s34 offen offset:2048  lds
  v_mfma_f32_16x16x32_bf16 v[104:107], a[40:43], a[232:235], v[104:107]
  s_mov_b32 m0, s33
  ds_read_b128 a[224:227], v58 offset:8192
  s_ashr_i32 s41, s40, 1
  v_mfma_f32_16x16x32_bf16 v[136:139], a[40:43], a[236:239], v[136:139]
  s_sub_u32 s41, s41, s53
  ds_read_b64_tr_b16 a[0:1], v64
  s_mul_i32 s41, s41, 2
  v_mfma_f32_16x16x32_bf16 v[168:171], a[40:43], a[240:243], v[168:171]
  s_lshr_b32 s38, s41, 1
  ds_read_b64_tr_b16 a[2:3], v64 offset:2048
  v_add_u32 v64, s62, v64
  v_mfma_f32_16x16x32_bf16 v[200:203], a[40:43], a[244:247], v[200:203]
  buffer_load_dwordx4 v54, s[12:15], s63 offen offset:0  lds
  v_mfma_f32_16x16x32_bf16 v[108:111], a[44:47], a[232:235], v[108:111]
  s_add_u32 s43, s38, s30
  ds_read_b64_tr_b16 a[4:5], v65
  s_and_b32 s43, s43, 31
  v_mfma_f32_16x16x32_bf16 v[140:143], a[44:47], a[236:239], v[140:143]
  s_lshl_b32 s43, s43, 12
  ds_read_b64_tr_b16 a[6:7], v65 offset:2048
  v_add_u32 v65, s62, v65
  v_mfma_f32_16x16x32_bf16 v[172:175], a[44:47], a[240:243], v[172:175]
  s_and_b32 s38, s41, 1
  ds_read_b64_tr_b16 a[8:9], v66
  s_lshl_b32 s38, s38, 11
  v_mfma_f32_16x16x32_bf16 v[204:207], a[44:47], a[244:247], v[204:207]
  s_add_u32 s43, s43, s38
  ds_read_b64_tr_b16 a[10:11], v66 offset:2048
  v_add_u32 v66, s62, v66
  v_mfma_f32_16x16x32_bf16 v[240:243], a[48:51], a[228:231], v[240:243]
  buffer_load_dwordx4 v55, s[12:15], s63 offen offset:1024  lds
  v_mfma_f32_16x16x32_bf16 v[112:115], a[48:51], a[232:235], v[112:115]
  s_bfe_u32 s42, s41, 0x10002
  ds_read_b64_tr_b16 a[12:13], v67
  s_lshl_b32 s42, s42, 14
  v_mfma_f32_16x16x32_bf16 v[144:147], a[48:51], a[236:239], v[144:147]
  s_and_b32 s38, s41, 3
  ds_read_b64_tr_b16 a[14:15], v67 offset:2048
  v_add_u32 v67, s62, v67
  v_mfma_f32_16x16x32_bf16 v[176:179], a[48:51], a[240:243], v[176:179]
  s_lshl_b32 s38, s38, 11
  ds_read_b64_tr_b16 a[16:17], v68
  s_add_u32 s42, s42, s38
  v_mfma_f32_16x16x32_bf16 v[208:211], a[48:51], a[244:247], v[208:211]
  s_add_u32 s42, s42, s39
  ds_read_b64_tr_b16 a[18:19], v68 offset:2048
  v_add_u32 v68, s62, v68
  v_mfma_f32_16x16x32_bf16 v[244:247], a[52:55], a[228:231], v[244:247]
  buffer_load_dwordx4 v54, s[12:15], s64 offen offset:2048  lds
  v_mfma_f32_16x16x32_bf16 v[116:119], a[52:55], a[232:235], v[116:119]
  s_cmp_ge_u32 s41, 16
  ds_read_b64_tr_b16 a[20:21], v69
  s_cselect_b32 s42, 196608, s42
  v_mfma_f32_16x16x32_bf16 v[148:151], a[52:55], a[236:239], v[148:151]
  s_cselect_b32 s43, 1073741824, s43
  ds_read_b64_tr_b16 a[22:23], v69 offset:2048
  v_add_u32 v69, s62, v69
  v_mfma_f32_16x16x32_bf16 v[180:183], a[52:55], a[240:243], v[180:183]
  s_add_u32 s46, s46, 8192
  ds_read_b64_tr_b16 a[24:25], v70
  s_cmp_eq_u32 s46, 24576
  v_mfma_f32_16x16x32_bf16 v[212:215], a[52:55], a[244:247], v[212:215]
  s_cselect_b32 s46, 0, s46
  ds_read_b64_tr_b16 a[26:27], v70 offset:2048
  v_add_u32 v70, s62, v70
  v_mfma_f32_16x16x32_bf16 v[248:251], a[56:59], a[228:231], v[248:251]
  buffer_load_dwordx4 v55, s[12:15], s64 offen offset:3072  lds
  v_mfma_f32_16x16x32_bf16 v[120:123], a[56:59], a[232:235], v[120:123]
  s_cmp_eq_u32 s46, 8192
  ds_read_b64_tr_b16 a[28:29], v71
  s_cselect_b32 s36, s51, s48
  v_mfma_f32_16x16x32_bf16 v[152:155], a[56:59], a[236:239], v[152:155]
  s_add_u32 s32, s63, 262144
  ds_read_b64_tr_b16 a[30:31], v71 offset:2048
  v_add_u32 v71, s62, v71
  v_mfma_f32_16x16x32_bf16 v[184:187], a[56:59], a[240:243], v[184:187]
  s_cmp_ge_u32 s32, s54
  s_cselect_b32 s32, s78, s32
  s_add_u32 s65, s46, s47
  v_mfma_f32_16x16x32_bf16 v[216:219], a[56:59], a[244:247], v[216:219]
  s_cmp_ge_u32 s40, 15
  s_cselect_b32 s65, 196608, s65
  s_cselect_b32 s32, 1073741824, s32
  v_mfma_f32_16x16x32_bf16 v[252:255], a[60:63], a[228:231], v[252:255]
  s_add_u32 s72, s32, 30720
  s_mov_b32 s33, s65
  v_mfma_f32_16x16x32_bf16 v[124:127], a[60:63], a[232:235], v[124:127]
  v_mfma_f32_16x16x32_bf16 v[156:159], a[60:63], a[236:239], v[156:159]
  v_mfma_f32_16x16x32_bf16 v[188:191], a[60:63], a[240:243], v[188:191]
  v_mfma_f32_16x16x32_bf16 v[220:223], a[60:63], a[244:247], v[220:223]
  s_branch L_qs
L_qes:
  s_waitcnt lgkmcnt(0)
  v_mov_b32 v64, v8
  v_mov_b32 v65, v9
  v_mov_b32 v66, v10
  v_mov_b32 v67, v11
  v_mov_b32 v68, v12
  v_mov_b32 v69, v13
  v_mov_b32 v70, v14
  v_mov_b32 v71, v15
  s_bitcmp1_b32 s2, 3
  s_cselect_b32 s68, s20, s16
  s_cselect_b32 s69, s21, s17
  s_cselect_b32 s12, s16, s20
  s_cselect_b32 s13, s17, s21
  s_cselect_b32 s47, 8192, 0
  s_mov_b32 s14, 131072
  s_add_u32 s47, s47, s44
  s_load_dword s31, s[6:7], 0
  v_and_b32 v1, 63, v0
  s_lshl_b32 s38, s29, 11
  s_add_u32 s38, s38, 155648
  v_lshl_add_u32 v1, v1, 4, s38
  s_add_u32 s43, s30, 8
  s_and_b32 s43, s43, 31
  s_lshl_b32 s43, s43, 12
  s_add_u32 s42, s47, 65536
  s_xor_b32 m0, s42, 0
  s_add_u32 s38, s43, 4096
  s_bitset0_b32 s38, 17
  buffer_load_dwordx4 v56, s[68:71], s43 offen offset:0 nt lds
  buffer_load_dwordx4 v57, s[68:71], s43 offen offset:1024 nt lds
  buffer_load_dwordx4 v56, s[68:71], s43 offen offset:2048 nt lds
  v_pk_mul_f32 v[240:241], v[240:241], s[48:49] op_sel:[0,1] op_sel_hi:[1,1]
  v_pk_mul_f32 v[242:243], v[242:243], s[48:49] op_sel:[0,1] op_sel_hi:[1,1]
  v_pk_mul_f32 v[244:245], v[244:245], s[48:49] op_sel:[0,1] op_sel_hi:[1,1]
  v_pk_mul_f32 v[246:247], v[246:247], s[48:49] op_sel:[0,1] op_sel_hi:[1,1]
  v_cvt_pk_bf16_f32 v4, v240, v241
  v_cvt_pk_bf16_f32 v5, v242, v243
  v_cvt_pk_bf16_f32 v6, v244, v245
  v_cvt_pk_bf16_f32 v7, v246, v247
  v_pk_mul_f32 v[248:249], v[248:249], s[48:49] op_sel:[0,1] op_sel_hi:[1,1]
  v_pk_mul_f32 v[250:251], v[250:251], s[48:49] op_sel:[0,1] op_sel_hi:[1,1]
  v_permlane32_swap_b32 v4, v6
  v_permlane32_swap_b32 v5, v7
  v_pk_mul_f32 v[252:253], v[252:253], s[48:49] op_sel:[0,1] op_sel_hi:[1,1]
  v_pk_mul_f32 v[254:255], v[254:255], s[48:49] op_sel:[0,1] op_sel_hi:[1,1]
  v_permlane16_swap_b32 v4, v6
  v_permlane16_swap_b32 v5, v7
  v_cvt_pk_bf16_f32 v20, v248, v249
  ds_write_b128 v1, v[4:7] offset:0
  v_cvt_pk_bf16_f32 v21, v250, v251
  v_cvt_pk_bf16_f32 v22, v252, v253
  v_cvt_pk_bf16_f32 v23, v254, v255
  buffer_load_dwordx4 v57, s[68:71], s43 offen offset:3072 nt lds
  s_xor_b32 m0, s42, 4096
  s_nop 0
  buffer_load_dwordx4 v56, s[68:71], s38 offen offset:0 nt lds
  buffer_load_dwordx4 v57, s[68:71], s38 offen offset:1024 nt lds
  buffer_load_dwordx4 v56, s[68:71], s38 offen offset:2048 nt lds
  v_pk_mul_f32 v[96:97], v[96:97], s[48:49] op_sel:[0,1] op_sel_hi:[1,1]
  v_pk_mul_f32 v[98:99], v[98:99], s[48:49] op_sel:[0,1] op_sel_hi:[1,1]
  v_permlane32_swap_b32 v20, v22
  v_permlane32_swap_b32 v21, v23
  v_pk_mul_f32 v[100:101], v[100:101], s[48:49] op_sel:[0,1] op_sel_hi:[1,1]
  v_pk_mul_f32 v[102:103], v[102:103], s[48:49] op_sel:[0,1] op_sel_hi:[1,1]
  v_permlane16_swap_b32 v20, v22
  v_permlane16_swap_b32 v21, v23
  v_cvt_pk_bf16_f32 v4, v96, v97
  ds_write_b128 v1, v[20:23] offset:1024
  v_cvt_pk_bf16_f32 v5, v98, v99
  v_cvt_pk_bf16_f32 v6, v100, v101
  v_cvt_pk_bf16_f32 v7, v102, v103
  buffer_load_dwordx4 v57, s[68:71], s38 offen offset:3072 nt lds
  s_xor_b32 m0, s42, 8192
  s_nop 0
  buffer_load_dwordx4 v56, s[12:15], s43 offen offset:0 nt lds
  buffer_load_dwordx4 v57, s[12:15], s43 offen offset:1024 nt lds
  buffer_load_dwordx4 v56, s[12:15], s43 offen offset:2048 nt lds
  v_pk_mul_f32 v[104:105], v[104:105], s[48:49] op_sel:[0,1] op_sel_hi:[1,1]
  v_pk_mul_f32 v[106:107], v[106:107], s[48:49] op_sel:[0,1] op_sel_hi:[1,1]
  v_permlane32_swap_b32 v4, v6
  v_permlane32_swap_b32 v5, v7
  v_pk_mul_f32 v[108:109], v[108:109], s[48:49] op_sel:[0,1] op_sel_hi:[1,1]
  v_pk_mul_f32 v[110:111], v[110:111], s[48:49] op_sel:[0,1] op_sel_hi:[1,1]
  v_permlane16_swap_b32 v4, v6
  v_permlane16_swap_b32 v5, v7
  v_cvt_pk_bf16_f32 v20, v104, v105
  v_accvgpr_write_b32 a0, v4
  v_accvgpr_write_b32 a2, v6
  v_accvgpr_write_b32 a1, v5
  v_accvgpr_write_b32 a3, v7
  v_cvt_pk_bf16_f32 v21, v106, v107
  v_cvt_pk_bf16_f32 v22, v108, v109
  v_cvt_pk_bf16_f32 v23, v110, v111
  buffer_load_dwordx4 v57, s[12:15], s43 offen offset:3072 nt lds
  s_xor_b32 m0, s42, 12288
  s_nop 0
  buffer_load_dwordx4 v56, s[12:15], s38 offen offset:0 nt lds
  buffer_load_dwordx4 v57, s[12:15], s38 offen offset:1024 nt lds
  buffer_load_dwordx4 v56, s[12:15], s38 offen offset:2048 nt lds
  v_pk_mul_f32 v[112:113], v[112:113], s[48:49] op_sel:[0,1] op_sel_hi:[1,1]
  v_pk_mul_f32 v[114:115], v[114:115], s[48:49] op_sel:[0,1] op_sel_hi:[1,1]
  v_permlane32_swap_b32 v20, v22
  v_permlane32_swap_b32 v21, v23
  v_pk_mul_f32 v[116:117], v[116:117], s[48:49] op_sel:[0,1] op_sel_hi:[1,1]
  v_pk_mul_f32 v[118:119], v[118:119], s[48:49] op_sel:[0,1] op_sel_hi:[1,1]
  v_permlane16_swap_b32 v20, v22
  v_permlane16_swap_b32 v21, v23
  v_cvt_pk_bf16_f32 v4, v112, v113
  v_accvgpr_write_b32 a4, v20
  v_accvgpr_write_b32 a6, v22
  v_accvgpr_write_b32 a5, v21
  v_accvgpr_write_b32 a7, v23
  v_cvt_pk_bf16_f32 v5, v114, v115
  v_cvt_pk_bf16_f32 v6, v116, v117
  v_cvt_pk_bf16_f32 v7, v118, v119
  buffer_load_dwordx4 v57, s[12:15], s38 offen offset:3072 nt lds
  v_pk_mul_f32 v[120:121], v[120:121], s[48:49] op_sel:[0,1] op_sel_hi:[1,1]
  v_pk_mul_f32 v[122:123], v[122:123], s[48:49] op_sel:[0,1] op_sel_hi:[1,1]
  v_permlane32_swap_b32 v4, v6
  v_permlane32_swap_b32 v5, v7
  v_pk_mul_f32 v[124:125], v[124:125], s[48:49] op_sel:[0,1] op_sel_hi:[1,1]
  v_pk_mul_f32 v[126:127], v[126:127], s[48:49] op_sel:[0,1] op_sel_hi:[1,1]
  v_permlane16_swap_b32 v4, v6
  v_permlane16_swap_b32 v5, v7
  v_cvt_pk_bf16_f32 v20, v120, v121
  v_accvgpr_write_b32 a8, v4
  v_accvgpr_write_b32 a10, v6
  v_accvgpr_write_b32 a9, v5
  v_accvgpr_write_b32 a11, v7
  v_cvt_pk_bf16_f32 v21, v122, v123
  v_cvt_pk_bf16_f32 v22, v124, v125
  v_cvt_pk_bf16_f32 v23, v126, v127
  v_pk_mul_f32 v[128:129], v[128:129], s[48:49] op_sel:[0,1] op_sel_hi:[1,1]
  v_pk_mul_f32 v[130:131], v[130:131], s[48:49] op_sel:[0,1] op_sel_hi:[1,1]
  v_permlane32_swap_b32 v20, v22
  v_permlane32_swap_b32 v21, v23
  v_pk_mul_f32 v[132:133], v[132:133], s[48:49] op_sel:[0,1] op_sel_hi:[1,1]
  v_pk_mul_f32 v[134:135], v[134:135], s[48:49] op_sel:[0,1] op_sel_hi:[1,1]
  v_permlane16_swap_b32 v20, v22
  v_permlane16_swap_b32 v21, v23
  v_cvt_pk_bf16_f32 v4, v128, v129
  v_accvgpr_write_b32 a12, v20
  v_accvgpr_write_b32 a14, v22
  v_accvgpr_write_b32 a13, v21
  v_accvgpr_write_b32 a15, v23
  v_cvt_pk_bf16_f32 v5, v130, v131
  v_cvt_pk_bf16_f32 v6, v132, v133
  v_cvt_pk_bf16_f32 v7, v134, v135
  v_pk_mul_f32 v[136:137], v[136:137], s[48:49] op_sel:[0,1] op_sel_hi:[1,1]
  v_pk_mul_f32 v[138:139], v[138:139], s[48:49] op_sel:[0,1] op_sel_hi:[1,1]
  v_permlane32_swap_b32 v4, v6
  v_permlane32_swap_b32 v5, v7
  v_pk_mul_f32 v[140:141], v[140:141], s[48:49] op_sel:[0,1] op_sel_hi:[1,1]
  v_pk_mul_f32 v[142:143], v[142:143], s[48:49] op_sel:[0,1] op_sel_hi:[1,1]
  v_permlane16_swap_b32 v4, v6
  v_permlane16_swap_b32 v5, v7
  v_cvt_pk_bf16_f32 v20, v136, v137
  v_accvgpr_write_b32 a16, v4
  v_accvgpr_write_b32 a18, v6
  v_accvgpr_write_b32 a17, v5
  v_accvgpr_write_b32 a19, v7
  v_cvt_pk_bf16_f32 v21, v138, v139
  v_cvt_pk_bf16_f32 v22, v140, v141
  v_cvt_pk_bf16_f32 v23, v142, v143
  v_pk_mul_f32 v[144:145], v[144:145], s[48:49] op_sel:[0,1] op_sel_hi:[1,1]
  v_pk_mul_f32 v[146:147], v[146:147], s[48:49] op_sel:[0,1] op_sel_hi:[1,1]
  v_permlane32_swap_b32 v20, v22
  v_permlane32_swap_b32 v21, v23
  v_pk_mul_f32 v[148:149], v[148:149], s[48:49] op_sel:[0,1] op_sel_hi:[1,1]
  v_pk_mul_f32 v[150:151], v[150:151], s[48:49] op_sel:[0,1] op_sel_hi:[1,1]
  v_permlane16_swap_b32 v20, v22
  v_permlane16_swap_b32 v21, v23
  v_cvt_pk_bf16_f32 v4, v144, v145
  v_accvgpr_write_b32 a20, v20
  v_accvgpr_write_b32 a22, v22
  v_accvgpr_write_b32 a21, v21
  v_accvgpr_write_b32 a23, v23
  v_cvt_pk_bf16_f32 v5, v146, v147
  v_cvt_pk_bf16_f32 v6, v148, v149
  v_cvt_pk_bf16_f32 v7, v150, v151
  v_pk_mul_f32 v[152:153], v[152:153], s[48:49] op_sel:[0,1] op_sel_hi:[1,1]
  v_pk_mul_f32 v[154:155], v[154:155], s[48:49] op_sel:[0,1] op_sel_hi:[1,1]
  v_permlane32_swap_b32 v4, v6
  v_permlane32_swap_b32 v5, v7
  v_pk_mul_f32 v[156:157], v[156:157], s[48:49] op_sel:[0,1] op_sel_hi:[1,1]
  v_pk_mul_f32 v[158:159], v[158:159], s[48:49] op_sel:[0,1] op_sel_hi:[1,1]
  v_permlane16_swap_b32 v4, v6
  v_permlane16_swap_b32 v5, v7
  v_cvt_pk_bf16_f32 v20, v152, v153
  v_accvgpr_write_b32 a24, v4
  v_accvgpr_write_b32 a26, v6
  v_accvgpr_write_b32 a25, v5
  v_accvgpr_write_b32 a27, v7
  v_cvt_pk_bf16_f32 v21, v154, v155
  v_cvt_pk_bf16_f32 v22, v156, v157
  v_cvt_pk_bf16_f32 v23, v158, v159
  v_pk_mul_f32 v[160:161], v[160:161], s[48:49] op_sel:[0,1] op_sel_hi:[1,1]
  v_pk_mul_f32 v[162:163], v[162:163], s[48:49] op_sel:[0,1] op_sel_hi:[1,1]
  v_permlane32_swap_b32 v20, v22
  v_permlane32_swap_b32 v21, v23
  v_pk_mul_f32 v[164:165], v[164:165], s[48:49] op_sel:[0,1] op_sel_hi:[1,1]
  v_pk_mul_f32 v[166:167], v[166:167], s[48:49] op_sel:[0,1] op_sel_hi:[1,1]
  v_permlane16_swap_b32 v20, v22
  v_permlane16_swap_b32 v21, v23
  v_cvt_pk_bf16_f32 v4, v160, v161
  v_accvgpr_write_b32 a28, v20
  v_accvgpr_write_b32 a30, v22
  v_accvgpr_write_b32 a29, v21
  v_accvgpr_write_b32 a31, v23
  v_cvt_pk_bf16_f32 v5, v162, v163
  v_cvt_pk_bf16_f32 v6, v164, v165
  v_cvt_pk_bf16_f32 v7, v166, v167
  s_waitcnt lgkmcnt(0)
  s_waitcnt vmcnt(16)
  s_barrier
  v_pk_mul_f32 v[168:169], v[168:169], s[48:49] op_sel:[0,1] op_sel_hi:[1,1]
  v_pk_mul_f32 v[170:171], v[170:171], s[48:49] op_sel:[0,1] op_sel_hi:[1,1]
  v_permlane32_swap_b32 v4, v6
  v_permlane32_swap_b32 v5, v7
  v_pk_mul_f32 v[172:173], v[172:173], s[48:49] op_sel:[0,1] op_sel_hi:[1,1]
  v_pk_mul_f32 v[174:175], v[174:175], s[48:49] op_sel:[0,1] op_sel_hi:[1,1]
  v_permlane16_swap_b32 v4, v6
  v_permlane16_swap_b32 v5, v7
  v_cvt_pk_bf16_f32 v20, v168, v169
  v_accvgpr_write_b32 a32, v4
  v_accvgpr_write_b32 a34, v6
  v_accvgpr_write_b32 a33, v5
  v_accvgpr_write_b32 a35, v7
  v_cvt_pk_bf16_f32 v21, v170, v171
  v_cvt_pk_bf16_f32 v22, v172, v173
  v_cvt_pk_bf16_f32 v23, v174, v175
  v_pk_mul_f32 v[176:177], v[176:177], s[48:49] op_sel:[0,1] op_sel_hi:[1,1]
  v_pk_mul_f32 v[178:179], v[178:179], s[48:49] op_sel:[0,1] op_sel_hi:[1,1]
  v_permlane32_swap_b32 v20, v22
  v_permlane32_swap_b32 v21, v23
  v_pk_mul_f32 v[180:181], v[180:181], s[48:49] op_sel:[0,1] op_sel_hi:[1,1]
  v_pk_mul_f32 v[182:183], v[182:183], s[48:49] op_sel:[0,1] op_sel_hi:[1,1]
  v_permlane16_swap_b32 v20, v22
  v_permlane16_swap_b32 v21, v23
  v_cvt_pk_bf16_f32 v4, v176, v177
  v_accvgpr_write_b32 a36, v20
  v_accvgpr_write_b32 a38, v22
  v_accvgpr_write_b32 a37, v21
  v_accvgpr_write_b32 a39, v23
  v_cvt_pk_bf16_f32 v5, v178, v179
  v_cvt_pk_bf16_f32 v6, v180, v181
  v_cvt_pk_bf16_f32 v7, v182, v183
  v_pk_mul_f32 v[184:185], v[184:185], s[48:49] op_sel:[0,1] op_sel_hi:[1,1]
  v_pk_mul_f32 v[186:187], v[186:187], s[48:49] op_sel:[0,1] op_sel_hi:[1,1]
  v_permlane32_swap_b32 v4, v6
  v_permlane32_swap_b32 v5, v7
  v_pk_mul_f32 v[188:189], v[188:189], s[48:49] op_sel:[0,1] op_sel_hi:[1,1]
  v_pk_mul_f32 v[190:191], v[190:191], s[48:49] op_sel:[0,1] op_sel_hi:[1,1]
  v_permlane16_swap_b32 v4, v6
  v_permlane16_swap_b32 v5, v7
  v_cvt_pk_bf16_f32 v20, v184, v185
  v_accvgpr_write_b32 a40, v4
  v_accvgpr_write_b32 a42, v6
  v_accvgpr_write_b32 a41, v5
  v_accvgpr_write_b32 a43, v7
  v_cvt_pk_bf16_f32 v21, v186, v187
  v_cvt_pk_bf16_f32 v22, v188, v189
  v_cvt_pk_bf16_f32 v23, v190, v191
  v_pk_mul_f32 v[192:193], v[192:193], s[48:49] op_sel:[0,1] op_sel_hi:[1,1]
  v_pk_mul_f32 v[194:195], v[194:195], s[48:49] op_sel:[0,1] op_sel_hi:[1,1]
  v_permlane32_swap_b32 v20, v22
  v_permlane32_swap_b32 v21, v23
  v_pk_mul_f32 v[196:197], v[196:197], s[48:49] op_sel:[0,1] op_sel_hi:[1,1]
  v_pk_mul_f32 v[198:199], v[198:199], s[48:49] op_sel:[0,1] op_sel_hi:[1,1]
  v_permlane16_swap_b32 v20, v22
  v_permlane16_swap_b32 v21, v23
  v_cvt_pk_bf16_f32 v4, v192, v193
  v_accvgpr_write_b32 a44, v20
  v_accvgpr_write_b32 a46, v22
  v_accvgpr_write_b32 a45, v21
  v_accvgpr_write_b32 a47, v23
  v_cvt_pk_bf16_f32 v5, v194, v195
  v_cvt_pk_bf16_f32 v6, v196, v197
  v_cvt_pk_bf16_f32 v7, v198, v199
  v_pk_mul_f32 v[200:201], v[200:201], s[48:49] op_sel:[0,1] op_sel_hi:[1,1]
  v_pk_mul_f32 v[202:203], v[202:203], s[48:49] op_sel:[0,1] op_sel_hi:[1,1]
  v_permlane32_swap_b32 v4, v6
  v_permlane32_swap_b32 v5, v7
  v_pk_mul_f32 v[204:205], v[204:205], s[48:49] op_sel:[0,1] op_sel_hi:[1,1]
  v_pk_mul_f32 v[206:207], v[206:207], s[48:49] op_sel:[0,1] op_sel_hi:[1,1]
  v_permlane16_swap_b32 v4, v6
  v_permlane16_swap_b32 v5, v7
  v_cvt_pk_bf16_f32 v20, v200, v201
  v_accvgpr_write_b32 a48, v4
  v_accvgpr_write_b32 a50, v6
  v_accvgpr_write_b32 a49, v5
  v_accvgpr_write_b32 a51, v7
  v_cvt_pk_bf16_f32 v21, v202, v203
  v_cvt_pk_bf16_f32 v22, v204, v205
  v_cvt_pk_bf16_f32 v23, v206, v207
  v_pk_mul_f32 v[208:209], v[208:209], s[48:49] op_sel:[0,1] op_sel_hi:[1,1]
  v_pk_mul_f32 v[210:211], v[210:211], s[48:49] op_sel:[0,1] op_sel_hi:[1,1]
  v_permlane32_swap_b32 v20, v22
  v_permlane32_swap_b32 v21, v23
  v_pk_mul_f32 v[212:213], v[212:213], s[48:49] op_sel:[0,1] op_sel_hi:[1,1]
  v_pk_mul_f32 v[214:215], v[214:215], s[48:49] op_sel:[0,1] op_sel_hi:[1,1]
  v_permlane16_swap_b32 v20, v22
  v_permlane16_swap_b32 v21, v23
  v_cvt_pk_bf16_f32 v4, v208, v209
  v_accvgpr_write_b32 a52, v20
  v_accvgpr_write_b32 a54, v22
  v_accvgpr_write_b32 a53, v21
  v_accvgpr_write_b32 a55, v23
  v_cvt_pk_bf16_f32 v5, v210, v211
  v_cvt_pk_bf16_f32 v6, v212, v213
  v_cvt_pk_bf16_f32 v7, v214, v215
  v_pk_mul_f32 v[216:217], v[216:217], s[48:49] op_sel:[0,1] op_sel_hi:[1,1]
  v_pk_mul_f32 v[218:219], v[218:219], s[48:49] op_sel:[0,1] op_sel_hi:[1,1]
  v_permlane32_swap_b32 v4, v6
  v_permlane32_swap_b32 v5, v7
  v_pk_mul_f32 v[220:221], v[220:221], s[48:49] op_sel:[0,1] op_sel_hi:[1,1]
  v_pk_mul_f32 v[222:223], v[222:223], s[48:49] op_sel:[0,1] op_sel_hi:[1,1]
  v_permlane16_swap_b32 v4, v6
  v_permlane16_swap_b32 v5, v7
  v_cvt_pk_bf16_f32 v20, v216, v217
  v_accvgpr_write_b32 a56, v4
  v_accvgpr_write_b32 a58, v6
  v_accvgpr_write_b32 a57, v5
  v_accvgpr_write_b32 a59, v7
  v_cvt_pk_bf16_f32 v21, v218, v219
  v_cvt_pk_bf16_f32 v22, v220, v221
  v_cvt_pk_bf16_f32 v23, v222, v223
  s_nop 0
  s_nop 0
  v_permlane32_swap_b32 v20, v22
  v_permlane32_swap_b32 v21, v23
  s_nop 0
  s_nop 0
  v_permlane16_swap_b32 v20, v22
  v_permlane16_swap_b32 v21, v23
  s_nop 0
  v_accvgpr_write_b32 a60, v20
  v_accvgpr_write_b32 a62, v22
  v_accvgpr_write_b32 a61, v21
  v_accvgpr_write_b32 a63, v23
  v_mov_b32 v72, 0
  v_mov_b32 v73, 0
  v_mov_b32 v74, 0
  v_mov_b32 v75, 0
  v_mov_b32 v88, 0
  v_mov_b32 v89, 0
  v_mov_b32 v90, 0
  v_mov_b32 v91, 0
  v_mov_b32 v92, 0
  v_mov_b32 v93, 0
  v_mov_b32 v94, 0
  v_mov_b32 v95, 0
  s_mov_b32 s8, s56
  s_mov_b32 s9, s57
  s_mov_b32 s10, s58
  s_and_b32 s78, s3, 3
  s_lshl_b32 s78, s78, 10
  s_lshl_b32 s38, s29, 5
  s_add_u32 s78, s78, s38
  s_mul_i32 s78, s78, 1152
  s_mul_i32 s38, s4, 288
  s_add_u32 s78, s78, s38
  s_mov_b32 s52, 73728
  s_mul_i32 s77, s29, 9216
  s_add_u32 s77, s77, 18432
  s_lshl_b32 s79, s4, 2
  s_mov_b32 s36, 0x75eca864
  s_mov_b32 s37, 0xfdb9
  s_mov_b32 s34, 0
  s_mov_b32 s51, 0x53800000
  s_mov_b32 s40, 0
  s_mov_b32 s45, 0
  s_cmp_eq_u32 s31, 0
  s_cbranch_scc1 L_tags
L_tagbs:
  s_lshr_b32 s62, s2, 3
  s_mul_i32 s63, s3, 0
  s_add_u32 s62, s62, s63
  s_and_b32 s62, s62, 7
  s_add_u32 s62, s62, 3
  s_sub_u32 s63, s62, 1
  s_add_u32 s43, s30, 10
  s_and_b32 s43, s43, 31
  s_lshl_b32 s43, s43, 12
  s_add_u32 s42, s47, 81920
  s_waitcnt lgkmcnt(0)
  v_mfma_f32_16x16x32_bf16 v[80:83], a[80:83], a[0:3], 0
  s_xor_b32 m0, s42, 0
  s_add_u32 s38, s43, 4096
  s_bitset0_b32 s38, 17
  v_mfma_f32_16x16x32_bf16 v[80:83], a[84:87], a[4:7], v[80:83]
  buffer_load_dwordx4 v56, s[68:71], s43 offen offset:0 nt lds
  v_mfma_f32_16x16x32_bf16 v[80:83], a[88:91], a[8:11], v[80:83]
  buffer_load_dwordx4 v57, s[68:71], s43 offen offset:1024 nt lds
  v_mfma_f32_16x16x32_bf16 v[80:83], a[92:95], a[12:15], v[80:83]
  v_mfma_f32_16x16x32_bf16 v[84:87], a[96:99], a[0:3], 0
  buffer_load_dwordx4 v56, s[68:71], s43 offen offset:2048 nt lds
  v_mfma_f32_16x16x32_bf16 v[84:87], a[100:103], a[4:7], v[84:87]
  v_mfma_f32_16x16x32_bf16 v[84:87], a[104:107], a[8:11], v[84:87]
  buffer_load_dwordx4 v57, s[68:71], s43 offen offset:3072 nt lds
  v_mfma_f32_16x16x32_bf16 v[84:87], a[108:111], a[12:15], v[84:87]
  s_xor_b32 m0, s42, 4096
  s_nop 3
  v_exp_f32 v80, v80
  s_nop 0
  v_exp_f32 v81, v81
  s_nop 0
  v_exp_f32 v82, v82
  s_nop 0
  v_exp_f32 v83, v83
  s_nop 0
  v_exp_f32 v84, v84
  s_nop 0
  v_exp_f32 v85, v85
  s_nop 0
  buffer_load_dwordx4 v56, s[68:71], s38 offen offset:0 nt lds
  v_exp_f32 v86, v86
  s_nop 0
  v_exp_f32 v87, v87
  v_mfma_f32_16x16x32_bf16 v[88:91], a[80:83], a[16:19], 0
  v_add_f32 v72, v72, v80
  v_mfma_f32_16x16x32_bf16 v[88:91], a[84:87], a[20:23], v[88:91]
  buffer_load_dwordx4 v57, s[68:71], s38 offen offset:1024 nt lds
  v_add_f32 v72, v72, v81
  v_add_f32 v72, v72, v82
  v_mfma_f32_16x16x32_bf16 v[88:91], a[88:91], a[24:27], v[88:91]
  v_add_f32 v72, v72, v83
  v_mfma_f32_16x16x32_bf16 v[88:91], a[92:95], a[28:31], v[88:91]
  buffer_load_dwordx4 v56, s[68:71], s38 offen offset:2048 nt lds
  v_cvt_pk_bf16_f32 v80, v80, v81
  v_cvt_pk_bf16_f32 v81, v82, v83
  v_mfma_f32_16x16x32_bf16 v[92:95], a[96:99], a[16:19], 0
  v_cvt_pk_bf16_f32 v82, v84, v85
  v_mfma_f32_16x16x32_bf16 v[92:95], a[100:103], a[20:23], v[92:95]
  buffer_load_dwordx4 v57, s[68:71], s38 offen offset:3072 nt lds
  v_cvt_pk_bf16_f32 v83, v86, v87
  v_add_f32 v72, v72, v84
  v_mfma_f32_16x16x32_bf16 v[92:95], a[104:107], a[24:27], v[92:95]
  s_xor_b32 m0, s42, 8192
  v_add_f32 v72, v72, v85
  v_mfma_f32_16x16x32_bf16 v[92:95], a[108:111], a[28:31], v[92:95]
  buffer_load_dwordx4 v56, s[12:15], s43 offen offset:0 nt lds
  v_add_f32 v72, v72, v86
  v_add_f32 v72, v72, v87
  v_mfma_f32_16x16x32_bf16 v[96:99], a[144:147], v[80:83], 0
  v_exp_f32 v88, v88
  v_mfma_f32_16x16x32_bf16 v[100:103], a[148:151], v[80:83], 0
  v_exp_f32 v89, v89
  v_mfma_f32_16x16x32_bf16 v[104:107], a[152:155], v[80:83], 0
  v_exp_f32 v90, v90
  v_mfma_f32_16x16x32_bf16 v[108:111], a[156:159], v[80:83], 0
  v_exp_f32 v91, v91
  v_mfma_f32_16x16x32_bf16 v[112:115], a[160:163], v[80:83], 0
  v_exp_f32 v92, v92
  v_mfma_f32_16x16x32_bf16 v[116:119], a[164:167], v[80:83], 0
  v_exp_f32 v93, v93
  v_mfma_f32_16x16x32_bf16 v[120:123], a[168:171], v[80:83], 0
  v_exp_f32 v94, v94
  v_mfma_f32_16x16x32_bf16 v[124:127], a[172:175], v[80:83], 0
  v_exp_f32 v95, v95
  v_mfma_f32_16x16x32_bf16 v[80:83], a[80:83], a[32:35], 0
  v_add_f32 v73, v73, v88
  v_mfma_f32_16x16x32_bf16 v[80:83], a[84:87], a[36:39], v[80:83]
  buffer_load_dwordx4 v57, s[12:15], s43 offen offset:1024 nt lds
  v_add_f32 v73, v73, v89
  v_add_f32 v73, v73, v90
  v_mfma_f32_16x16x32_bf16 v[80:83], a[88:91], a[40:43], v[80:83]
  v_add_f32 v73, v73, v91
  v_mfma_f32_16x16x32_bf16 v[80:83], a[92:95], a[44:47], v[80:83]
  buffer_load_dwordx4 v56, s[12:15], s43 offen offset:2048 nt lds
  v_cvt_pk_bf16_f32 v88, v88, v89
  v_cvt_pk_bf16_f32 v89, v90, v91
  v_mfma_f32_16x16x32_bf16 v[84:87], a[96:99], a[32:35], 0
  v_cvt_pk_bf16_f32 v90, v92, v93
  v_mfma_f32_16x16x32_bf16 v[84:87], a[100:103], a[36:39], v[84:87]
  buffer_load_dwordx4 v57, s[12:15], s43 offen offset:3072 nt lds
  v_cvt_pk_bf16_f32 v91, v94, v95
  v_add_f32 v73, v73, v92
  v_mfma_f32_16x16x32_bf16 v[84:87], a[104:107], a[40:43], v[84:87]
  s_xor_b32 m0, s42, 12288
  v_add_f32 v73, v73, v93
  v_mfma_f32_16x16x32_bf16 v[84:87], a[108:111], a[44:47], v[84:87]
  buffer_load_dwordx4 v56, s[12:15], s38 offen offset:0 nt lds
  v_add_f32 v73, v73, v94
  v_add_f32 v73, v73, v95
  v_mfma_f32_16x16x32_bf16 v[128:131], a[144:147], v[88:91], 0
  v_exp_f32 v80, v80
  v_mfma_f32_16x16x32_bf16 v[132:135], a[148:151], v[88:91], 0
  buffer_load_dwordx4 v57, s[12:15], s38 offen offset:1024 nt lds
  v_exp_f32 v81, v81
  v_mfma_f32_16x16x32_bf16 v[136:139], a[152:155], v[88:91], 0
  v_exp_f32 v82, v82
  v_mfma_f32_16x16x32_bf16 v[140:143], a[156:159], v[88:91], 0
  v_exp_f32 v83, v83
  v_mfma_f32_16x16x32_bf16 v[144:147], a[160:163], v[88:91], 0
  v_exp_f32 v84, v84
  v_mfma_f32_16x16x32_bf16 v[148:151], a[164:167], v[88:91], 0
  v_exp_f32 v85, v85
  v_mfma_f32_16x16x32_bf16 v[152:155], a[168:171], v[88:91], 0
  v_exp_f32 v86, v86
  v_mfma_f32_16x16x32_bf16 v[156:159], a[172:175], v[88:91], 0
  v_exp_f32 v87, v87
  v_mfma_f32_16x16x32_bf16 v[88:91], a[80:83], a[48:51], 0
  v_add_f32 v74, v74, v80
  v_mfma_f32_16x16x32_bf16 v[88:91], a[84:87], a[52:55], v[88:91]
  buffer_load_dwordx4 v56, s[12:15], s38 offen offset:2048 nt lds
  v_add_f32 v74, v74, v81
  v_add_f32 v74, v74, v82
  v_mfma_f32_16x16x32_bf16 v[88:91], a[88:91], a[56:59], v[88:91]
  v_add_f32 v74, v74, v83
  v_mfma_f32_16x16x32_bf16 v[88:91], a[92:95], a[60:63], v[88:91]
  buffer_load_dwordx4 v57, s[12:15], s38 offen offset:3072 nt lds
  v_cvt_pk_bf16_f32 v80, v80, v81
  v_cvt_pk_bf16_f32 v81, v82, v83
  v_mfma_f32_16x16x32_bf16 v[92:95], a[96:99], a[48:51], 0
  v_cvt_pk_bf16_f32 v82, v84, v85
  v_mfma_f32_16x16x32_bf16 v[92:95], a[100:103], a[52:55], v[92:95]
  v_cvt_pk_bf16_f32 v83, v86, v87
  v_add_f32 v74, v74, v84
  v_mfma_f32_16x16x32_bf16 v[92:95], a[104:107], a[56:59], v[92:95]
  v_add_f32 v74, v74, v85
  v_mfma_f32_16x16x32_bf16 v[92:95], a[108:111], a[60:63], v[92:95]
  v_add_f32 v74, v74, v86
  v_add_f32 v74, v74, v87
  v_mfma_f32_16x16x32_bf16 v[160:163], a[144:147], v[80:83], 0
  v_exp_f32 v88, v88
  v_mfma_f32_16x16x32_bf16 v[164:167], a[148:151], v[80:83], 0
  v_exp_f32 v89, v89
  v_mfma_f32_16x16x32_bf16 v[168:171], a[152:155], v[80:83], 0
  v_exp_f32 v90, v90
  v_mfma_f32_16x16x32_bf16 v[172:175], a[156:159], v[80:83], 0
  v_exp_f32 v91, v91
  v_mfma_f32_16x16x32_bf16 v[176:179], a[160:163], v[80:83], 0
  v_exp_f32 v92, v92
  v_mfma_f32_16x16x32_bf16 v[180:183], a[164:167], v[80:83], 0
  v_exp_f32 v93, v93
  v_mfma_f32_16x16x32_bf16 v[184:187], a[168:171], v[80:83], 0
  v_exp_f32 v94, v94
  v_mfma_f32_16x16x32_bf16 v[188:191], a[172:175], v[80:83], 0
  v_exp_f32 v95, v95
  s_waitcnt lgkmcnt(0)
  v_mfma_f32_16x16x32_bf16 v[80:83], a[112:115], a[0:3], 0
  ds_read_b128 a[80:83], v60 offset:0
  v_add_f32 v75, v75, v88
  v_mfma_f32_16x16x32_bf16 v[80:83], a[116:119], a[4:7], v[80:83]
  v_add_f32 v75, v75, v89
  v_add_f32 v75, v75, v90
  v_mfma_f32_16x16x32_bf16 v[80:83], a[120:123], a[8:11], v[80:83]
  ds_read_b128 a[84:87], v61 offset:0
  v_add_f32 v75, v75, v91
  v_mfma_f32_16x16x32_bf16 v[80:83], a[124:127], a[12:15], v[80:83]
  v_cvt_pk_bf16_f32 v88, v88, v89
  v_cvt_pk_bf16_f32 v89, v90, v91
  v_mfma_f32_16x16x32_bf16 v[84:87], a[128:131], a[0:3], 0
  ds_read_b128 a[88:91], v62 offset:0
  v_cvt_pk_bf16_f32 v90, v92, v93
  v_mfma_f32_16x16x32_bf16 v[84:87], a[132:135], a[4:7], v[84:87]
  ds_read_b128 a[92:95], v63 offset:0
  v_cvt_pk_bf16_f32 v91, v94, v95
  v_add_f32 v75, v75, v92
  v_mfma_f32_16x16x32_bf16 v[84:87], a[136:139], a[8:11], v[84:87]
  ds_read_b128 a[96:99], v60 offset:4096
  v_add_f32 v75, v75, v93
  v_mfma_f32_16x16x32_bf16 v[84:87], a[140:143], a[12:15], v[84:87]
  v_add_f32 v75, v75, v94
  v_add_f32 v75, v75, v95
  v_mfma_f32_16x16x32_bf16 v[192:195], a[144:147], v[88:91], 0
  v_exp_f32 v80, v80
  v_mfma_f32_16x16x32_bf16 v[196:199], a[148:151], v[88:91], 0
  v_exp_f32 v81, v81
  v_mfma_f32_16x16x32_bf16 v[200:203], a[152:155], v[88:91], 0
  ds_read_b128 a[100:103], v61 offset:4096
  v_exp_f32 v82, v82
  v_mfma_f32_16x16x32_bf16 v[204:207], a[156:159], v[88:91], 0
  v_exp_f32 v83, v83
  v_mfma_f32_16x16x32_bf16 v[208:211], a[160:163], v[88:91], 0
  v_exp_f32 v84, v84
  v_mfma_f32_16x16x32_bf16 v[212:215], a[164:167], v[88:91], 0
  v_exp_f32 v85, v85
  v_mfma_f32_16x16x32_bf16 v[216:219], a[168:171], v[88:91], 0
  ds_read_b128 a[104:107], v62 offset:4096
  v_exp_f32 v86, v86
  v_mfma_f32_16x16x32_bf16 v[220:223], a[172:175], v[88:91], 0
  v_exp_f32 v87, v87
  v_mfma_f32_16x16x32_bf16 v[88:91], a[112:115], a[16:19], 0
  ds_read_b128 a[108:111], v63 offset:4096
  v_add_f32 v72, v72, v80
  v_mfma_f32_16x16x32_bf16 v[88:91], a[116:119], a[20:23], v[88:91]
  v_add_f32 v72, v72, v81
  v_add_f32 v72, v72, v82
  v_mfma_f32_16x16x32_bf16 v[88:91], a[120:123], a[24:27], v[88:91]
  ds_read_b64_tr_b16 a[144:145], v64 offset:0
  v_add_f32 v72, v72, v83
  v_mfma_f32_16x16x32_bf16 v[88:91], a[124:127], a[28:31], v[88:91]
  v_cvt_pk_bf16_f32 v80, v80, v81
  v_cvt_pk_bf16_f32 v81, v82, v83
  v_mfma_f32_16x16x32_bf16 v[92:95], a[128:131], a[16:19], 0
  ds_read_b64_tr_b16 a[146:147], v64 offset:4096
  v_cvt_pk_bf16_f32 v82, v84, v85
  v_mfma_f32_16x16x32_bf16 v[92:95], a[132:135], a[20:23], v[92:95]
  ds_read_b64_tr_b16 a[148:149], v65 offset:0
  v_cvt_pk_bf16_f32 v83, v86, v87
  v_add_f32 v72, v72, v84
  v_mfma_f32_16x16x32_bf16 v[92:95], a[136:139], a[24:27], v[92:95]
  ds_read_b64_tr_b16 a[150:151], v65 offset:4096
  v_add_f32 v72, v72, v85
  v_mfma_f32_16x16x32_bf16 v[92:95], a[140:143], a[28:31], v[92:95]
  v_add_f32 v72, v72, v86
  v_add_f32 v72, v72, v87
  v_mfma_f32_16x16x32_bf16 v[96:99], a[176:179], v[80:83], v[96:99]
  v_exp_f32 v88, v88
  v_mfma_f32_16x16x32_bf16 v[100:103], a[180:183], v[80:83], v[100:103]
  v_exp_f32 v89, v89
  v_mfma_f32_16x16x32_bf16 v[104:107], a[184:187], v[80:83], v[104:107]
  ds_read_b64_tr_b16 a[152:153], v66 offset:0
  v_exp_f32 v90, v90
  v_mfma_f32_16x16x32_bf16 v[108:111], a[188:191], v[80:83], v[108:111]
  v_exp_f32 v91, v91
  v_mfma_f32_16x16x32_bf16 v[112:115], a[192:195], v[80:83], v[112:115]
  v_exp_f32 v92, v92
  v_mfma_f32_16x16x32_bf16 v[116:119], a[196:199], v[80:83], v[116:119]
  ds_read_b64_tr_b16 a[154:155], v66 offset:4096
  v_exp_f32 v93, v93
  v_mfma_f32_16x16x32_bf16 v[120:123], a[200:203], v[80:83], v[120:123]
  v_exp_f32 v94, v94
  v_mfma_f32_16x16x32_bf16 v[124:127], a[204:207], v[80:83], v[124:127]
  v_exp_f32 v95, v95
  v_mfma_f32_16x16x32_bf16 v[80:83], a[112:115], a[32:35], 0
  ds_read_b64_tr_b16 a[156:157], v67 offset:0
  v_add_f32 v73, v73, v88
  v_mfma_f32_16x16x32_bf16 v[80:83], a[116:119], a[36:39], v[80:83]
  v_add_f32 v73, v73, v89
  v_add_f32 v73, v73, v90
  v_mfma_f32_16x16x32_bf16 v[80:83], a[120:123], a[40:43], v[80:83]
  ds_read_b64_tr_b16 a[158:159], v67 offset:4096
  v_add_f32 v73, v73, v91
  v_mfma_f32_16x16x32_bf16 v[80:83], a[124:127], a[44:47], v[80:83]
  ds_read_b64_tr_b16 a[160:161], v68 offset:0
  v_cvt_pk_bf16_f32 v88, v88, v89
  v_cvt_pk_bf16_f32 v89, v90, v91
  v_mfma_f32_16x16x32_bf16 v[84:87], a[128:131], a[32:35], 0
  ds_read_b64_tr_b16 a[162:163], v68 offset:4096
  v_cvt_pk_bf16_f32 v90, v92, v93
  v_mfma_f32_16x16x32_bf16 v[84:87], a[132:135], a[36:39], v[84:87]
  v_cvt_pk_bf16_f32 v91, v94, v95
  v_add_f32 v73, v73, v92
  v_mfma_f32_16x16x32_bf16 v[84:87], a[136:139], a[40:43], v[84:87]
  ds_read_b64_tr_b16 a[164:165], v69 offset:0
  v_add_f32 v73, v73, v93
  v_mfma_f32_16x16x32_bf16 v[84:87], a[140:143], a[44:47], v[84:87]
  v_add_f32 v73, v73, v94
  v_add_f32 v73, v73, v95
  v_mfma_f32_16x16x32_bf16 v[128:131], a[176:179], v[88:91], v[128:131]
  v_exp_f32 v80, v80
  v_mfma_f32_16x16x32_bf16 v[132:135], a[180:183], v[88:91], v[132:135]
  ds_read_b64_tr_b16 a[166:167], v69 offset:4096
  v_exp_f32 v81, v81
  v_mfma_f32_16x16x32_bf16 v[136:139], a[184:187], v[88:91], v[136:139]
  v_exp_f32 v82, v82
  v_mfma_f32_16x16x32_bf16 v[140:143], a[188:191], v[88:91], v[140:143]
  v_exp_f32 v83, v83
  v_mfma_f32_16x16x32_bf16 v[144:147], a[192:195], v[88:91], v[144:147]
  v_exp_f32 v84, v84
  v_mfma_f32_16x16x32_bf16 v[148:151], a[196:199], v[88:91], v[148:151]
  ds_read_b64_tr_b16 a[168:169], v70 offset:0
  v_exp_f32 v85, v85
  v_mfma_f32_16x16x32_bf16 v[152:155], a[200:203], v[88:91], v[152:155]
  v_exp_f32 v86, v86
  v_mfma_f32_16x16x32_bf16 v[156:159], a[204:207], v[88:91], v[156:159]
  v_exp_f32 v87, v87
  v_mfma_f32_16x16x32_bf16 v[88:91], a[112:115], a[48:51], 0
  ds_read_b64_tr_b16 a[170:171], v70 offset:4096
  v_add_f32 v74, v74, v80
  v_mfma_f32_16x16x32_bf16 v[88:91], a[116:119], a[52:55], v[88:91]
  v_add_f32 v74, v74, v81
  v_add_f32 v74, v74, v82
  v_mfma_f32_16x16x32_bf16 v[88:91], a[120:123], a[56:59], v[88:91]
  ds_read_b64_tr_b16 a[172:173], v71 offset:0
  v_add_f32 v74, v74, v83
  v_mfma_f32_16x16x32_bf16 v[88:91], a[124:127], a[60:63], v[88:91]
  ds_read_b64_tr_b16 a[174:175], v71 offset:4096
  v_cvt_pk_bf16_f32 v80, v80, v81
  v_cvt_pk_bf16_f32 v81, v82, v83
  v_mfma_f32_16x16x32_bf16 v[92:95], a[128:131], a[48:51], 0
  v_cvt_pk_bf16_f32 v82, v84, v85
  v_mfma_f32_16x16x32_bf16 v[92:95], a[132:135], a[52:55], v[92:95]
  v_cvt_pk_bf16_f32 v83, v86, v87
  v_add_f32 v74, v74, v84
  v_mfma_f32_16x16x32_bf16 v[92:95], a[136:139], a[56:59], v[92:95]
  v_add_f32 v74, v74, v85
  v_mfma_f32_16x16x32_bf16 v[92:95], a[140:143], a[60:63], v[92:95]
  v_add_f32 v74, v74, v86
  v_add_f32 v74, v74, v87
  v_mfma_f32_16x16x32_bf16 v[160:163], a[176:179], v[80:83], v[160:163]
  v_exp_f32 v88, v88
  v_mfma_f32_16x16x32_bf16 v[164:167], a[180:183], v[80:83], v[164:167]
  v_exp_f32 v89, v89
  v_mfma_f32_16x16x32_bf16 v[168:171], a[184:187], v[80:83], v[168:171]
  v_exp_f32 v90, v90
  v_mfma_f32_16x16x32_bf16 v[172:175], a[188:191], v[80:83], v[172:175]
  v_exp_f32 v91, v91
  v_mfma_f32_16x16x32_bf16 v[176:179], a[192:195], v[80:83], v[176:179]
  v_exp_f32 v92, v92
  v_mfma_f32_16x16x32_bf16 v[180:183], a[196:199], v[80:83], v[180:183]
  v_exp_f32 v93, v93
  v_mfma_f32_16x16x32_bf16 v[184:187], a[200:203], v[80:83], v[184:187]
  v_exp_f32 v94, v94
  v_mfma_f32_16x16x32_bf16 v[188:191], a[204:207], v[80:83], v[188:191]
  v_exp_f32 v95, v95
  s_mov_b32 s40, 2
L_as:
  s_cmp_gt_i32 s40, s62
  s_cselect_b32 s38, 3, 4
  s_add_u32 s38, s38, s40
  s_lshl_b32 s43, s38, 1
  s_add_u32 s43, s43, s30
  s_and_b32 s43, s43, 31
  s_lshl_b32 s43, s43, 12
  s_and_b32 s42, s38, 1
  s_lshl_b32 s42, s42, 14
  s_add_u32 s42, s42, s47
  s_andn2_b32 s41, 2, s38
  s_lshl_b32 s41, s41, 15
  s_add_u32 s42, s42, s41
  s_cmp_eq_u32 s40, s62
  s_cselect_b32 s38, 16, s38
  s_cmp_ge_u32 s38, 16
  s_cselect_b32 s42, 196608, s42
  s_cselect_b32 s43, 1073741824, s43
  s_waitcnt lgkmcnt(0)
  s_cmp_lt_i32 s40, s62
  s_cbranch_scc0 L_pc0
  s_waitcnt vmcnt(8)
L_pc0:
  s_sub_u32 s39, s40, 3
  s_cmp_ge_i32 s39, s62
  s_cbranch_scc0 L_pd0
  s_waitcnt vmcnt(16)
L_pd0:
  s_waitcnt vmcnt(32)
  s_barrier
  v_mfma_f32_16x16x32_bf16 v[80:83], a[80:83], a[0:3], 0
  s_xor_b32 m0, s42, 0
  v_add_f32 v75, v75, v88
  s_add_u32 s38, s43, 4096
  v_mfma_f32_16x16x32_bf16 v[80:83], a[84:87], a[4:7], v[80:83]
  s_bitset0_b32 s38, 17
  buffer_load_dwordx4 v56, s[68:71], s43 offen offset:0 nt lds
  v_add_f32 v75, v75, v89
  v_add_f32 v75, v75, v90
  v_mfma_f32_16x16x32_bf16 v[80:83], a[88:91], a[8:11], v[80:83]
  ds_read_b128 a[112:115], v60 offset:16384
  v_add_f32 v75, v75, v91
  v_mfma_f32_16x16x32_bf16 v[80:83], a[92:95], a[12:15], v[80:83]
  buffer_load_dwordx4 v57, s[68:71], s43 offen offset:1024 nt lds
  v_cvt_pk_bf16_f32 v88, v88, v89
  v_cvt_pk_bf16_f32 v89, v90, v91
  v_mfma_f32_16x16x32_bf16 v[84:87], a[96:99], a[0:3], 0
  ds_read_b128 a[116:119], v61 offset:16384
  v_cvt_pk_bf16_f32 v90, v92, v93
  v_mfma_f32_16x16x32_bf16 v[84:87], a[100:103], a[4:7], v[84:87]
  v_cvt_pk_bf16_f32 v91, v94, v95
  v_add_f32 v75, v75, v92
  v_mfma_f32_16x16x32_bf16 v[84:87], a[104:107], a[8:11], v[84:87]
  ds_read_b128 a[120:123], v62 offset:16384
  v_add_f32 v75, v75, v93
  v_mfma_f32_16x16x32_bf16 v[84:87], a[108:111], a[12:15], v[84:87]
  buffer_load_dwordx4 v56, s[68:71], s43 offen offset:2048 nt lds
  v_add_f32 v75, v75, v94
  v_add_f32 v75, v75, v95
  v_mfma_f32_16x16x32_bf16 v[192:195], a[176:179], v[88:91], v[192:195]
  ds_read_b128 a[124:127], v63 offset:16384
  v_exp_f32 v80, v80
  v_mfma_f32_16x16x32_bf16 v[196:199], a[180:183], v[88:91], v[196:199]
  v_exp_f32 v81, v81
  v_mfma_f32_16x16x32_bf16 v[200:203], a[184:187], v[88:91], v[200:203]
  buffer_load_dwordx4 v57, s[68:71], s43 offen offset:3072 nt lds
  v_exp_f32 v82, v82
  v_mfma_f32_16x16x32_bf16 v[204:207], a[188:191], v[88:91], v[204:207]
  s_xor_b32 m0, s42, 4096
  ds_read_b128 a[128:131], v60 offset:20480
  v_exp_f32 v83, v83
  v_mfma_f32_16x16x32_bf16 v[208:211], a[192:195], v[88:91], v[208:211]
  v_exp_f32 v84, v84
  v_mfma_f32_16x16x32_bf16 v[212:215], a[196:199], v[88:91], v[212:215]
  ds_read_b128 a[132:135], v61 offset:20480
  v_exp_f32 v85, v85
  v_mfma_f32_16x16x32_bf16 v[216:219], a[200:203], v[88:91], v[216:219]
  buffer_load_dwordx4 v56, s[68:71], s38 offen offset:0 nt lds
  v_exp_f32 v86, v86
  v_mfma_f32_16x16x32_bf16 v[220:223], a[204:207], v[88:91], v[220:223]
  ds_read_b128 a[136:139], v62 offset:20480
  v_exp_f32 v87, v87
  v_mfma_f32_16x16x32_bf16 v[88:91], a[80:83], a[16:19], 0
  v_add_f32 v72, v72, v80
  v_mfma_f32_16x16x32_bf16 v[88:91], a[84:87], a[20:23], v[88:91]
  buffer_load_dwordx4 v57, s[68:71], s38 offen offset:1024 nt lds
  v_add_f32 v72, v72, v81
  v_add_f32 v72, v72, v82
  v_mfma_f32_16x16x32_bf16 v[88:91], a[88:91], a[24:27], v[88:91]
  ds_read_b128 a[140:143], v63 offset:20480
  v_add_f32 v72, v72, v83
  v_mfma_f32_16x16x32_bf16 v[88:91], a[92:95], a[28:31], v[88:91]
  ds_read_b64_tr_b16 a[176:177], v64 offset:16384
  v_cvt_pk_bf16_f32 v80, v80, v81
  v_cvt_pk_bf16_f32 v81, v82, v83
  v_mfma_f32_16x16x32_bf16 v[92:95], a[96:99], a[16:19], 0
  buffer_load_dwordx4 v56, s[68:71], s38 offen offset:2048 nt lds
  v_cvt_pk_bf16_f32 v82, v84, v85
  v_mfma_f32_16x16x32_bf16 v[92:95], a[100:103], a[20:23], v[92:95]
  ds_read_b64_tr_b16 a[178:179], v64 offset:20480
  v_cvt_pk_bf16_f32 v83, v86, v87
  v_add_f32 v72, v72, v84
  v_mfma_f32_16x16x32_bf16 v[92:95], a[104:107], a[24:27], v[92:95]
  v_add_f32 v72, v72, v85
  v_mfma_f32_16x16x32_bf16 v[92:95], a[108:111], a[28:31], v[92:95]
  buffer_load_dwordx4 v57, s[68:71], s38 offen offset:3072 nt lds
  v_add_f32 v72, v72, v86
  v_add_f32 v72, v72, v87
  v_mfma_f32_16x16x32_bf16 v[96:99], a[144:147], v[80:83], v[96:99]
  s_xor_b32 m0, s42, 8192
  ds_read_b64_tr_b16 a[180:181], v65 offset:16384
  v_exp_f32 v88, v88
  v_mfma_f32_16x16x32_bf16 v[100:103], a[148:151], v[80:83], v[100:103]
  ds_read_b64_tr_b16 a[182:183], v65 offset:20480
  v_exp_f32 v89, v89
  v_mfma_f32_16x16x32_bf16 v[104:107], a[152:155], v[80:83], v[104:107]
  v_exp_f32 v90, v90
  v_mfma_f32_16x16x32_bf16 v[108:111], a[156:159], v[80:83], v[108:111]
  buffer_load_dwordx4 v56, s[12:15], s43 offen offset:0 nt lds
  v_exp_f32 v91, v91
  v_mfma_f32_16x16x32_bf16 v[112:115], a[160:163], v[80:83], v[112:115]
  ds_read_b64_tr_b16 a[184:185], v66 offset:16384
  v_exp_f32 v92, v92
  v_mfma_f32_16x16x32_bf16 v[116:119], a[164:167], v[80:83], v[116:119]
  v_exp_f32 v93, v93
  v_mfma_f32_16x16x32_bf16 v[120:123], a[168:171], v[80:83], v[120:123]
  buffer_load_dwordx4 v57, s[12:15], s43 offen offset:1024 nt lds
  v_exp_f32 v94, v94
  v_mfma_f32_16x16x32_bf16 v[124:127], a[172:175], v[80:83], v[124:127]
  ds_read_b64_tr_b16 a[186:187], v66 offset:20480
  v_exp_f32 v95, v95
  v_mfma_f32_16x16x32_bf16 v[80:83], a[80:83], a[32:35], 0
  ds_read_b64_tr_b16 a[188:189], v67 offset:16384
  v_add_f32 v73, v73, v88
  v_mfma_f32_16x16x32_bf16 v[80:83], a[84:87], a[36:39], v[80:83]
  v_add_f32 v73, v73, v89
  v_add_f32 v73, v73, v90
  v_mfma_f32_16x16x32_bf16 v[80:83], a[88:91], a[40:43], v[80:83]
  buffer_load_dwordx4 v56, s[12:15], s43 offen offset:2048 nt lds
  v_add_f32 v73, v73, v91
  v_mfma_f32_16x16x32_bf16 v[80:83], a[92:95], a[44:47], v[80:83]
  ds_read_b64_tr_b16 a[190:191], v67 offset:20480
  v_cvt_pk_bf16_f32 v88, v88, v89
  v_cvt_pk_bf16_f32 v89, v90, v91
  v_mfma_f32_16x16x32_bf16 v[84:87], a[96:99], a[32:35], 0
  buffer_load_dwordx4 v57, s[12:15], s43 offen offset:3072 nt lds
  v_cvt_pk_bf16_f32 v90, v92, v93
  v_mfma_f32_16x16x32_bf16 v[84:87], a[100:103], a[36:39], v[84:87]
  s_xor_b32 m0, s42, 12288
  ds_read_b64_tr_b16 a[192:193], v68 offset:16384
  v_cvt_pk_bf16_f32 v91, v94, v95
  v_add_f32 v73, v73, v92
  v_mfma_f32_16x16x32_bf16 v[84:87], a[104:107], a[40:43], v[84:87]
  ds_read_b64_tr_b16 a[194:195], v68 offset:20480
  v_add_f32 v73, v73, v93
  v_mfma_f32_16x16x32_bf16 v[84:87], a[108:111], a[44:47], v[84:87]
  v_add_f32 v73, v73, v94
  v_add_f32 v73, v73, v95
  v_mfma_f32_16x16x32_bf16 v[128:131], a[144:147], v[88:91], v[128:131]
  buffer_load_dwordx4 v56, s[12:15], s38 offen offset:0 nt lds
  v_exp_f32 v80, v80
  v_mfma_f32_16x16x32_bf16 v[132:135], a[148:151], v[88:91], v[132:135]
  ds_read_b64_tr_b16 a[196:197], v69 offset:16384
  v_exp_f32 v81, v81
  v_mfma_f32_16x16x32_bf16 v[136:139], a[152:155], v[88:91], v[136:139]
  buffer_load_dwordx4 v57, s[12:15], s38 offen offset:1024 nt lds
  v_exp_f32 v82, v82
  v_mfma_f32_16x16x32_bf16 v[140:143], a[156:159], v[88:91], v[140:143]
  v_exp_f32 v83, v83
  v_mfma_f32_16x16x32_bf16 v[144:147], a[160:163], v[88:91], v[144:147]
  ds_read_b64_tr_b16 a[198:199], v69 offset:20480
  v_exp_f32 v84, v84
  v_mfma_f32_16x16x32_bf16 v[148:151], a[164:167], v[88:91], v[148:151]
  ds_read_b64_tr_b16 a[200:201], v70 offset:16384
  v_exp_f32 v85, v85
  v_mfma_f32_16x16x32_bf16 v[152:155], a[168:171], v[88:91], v[152:155]
  v_exp_f32 v86, v86
  v_mfma_f32_16x16x32_bf16 v[156:159], a[172:175], v[88:91], v[156:159]
  buffer_load_dwordx4 v56, s[12:15], s38 offen offset:2048 nt lds
  v_exp_f32 v87, v87
  v_mfma_f32_16x16x32_bf16 v[88:91], a[80:83], a[48:51], 0
  ds_read_b64_tr_b16 a[202:203], v70 offset:20480
  v_add_f32 v74, v74, v80
  v_mfma_f32_16x16x32_bf16 v[88:91], a[84:87], a[52:55], v[88:91]
  buffer_load_dwordx4 v57, s[12:15], s38 offen offset:3072 nt lds
  v_add_f32 v74, v74, v81
  v_add_f32 v74, v74, v82
  v_mfma_f32_16x16x32_bf16 v[88:91], a[88:91], a[56:59], v[88:91]
  ds_read_b64_tr_b16 a[204:205], v71 offset:16384
  v_add_f32 v74, v74, v83
  v_mfma_f32_16x16x32_bf16 v[88:91], a[92:95], a[60:63], v[88:91]
  v_cvt_pk_bf16_f32 v80, v80, v81
  v_cvt_pk_bf16_f32 v81, v82, v83
  v_mfma_f32_16x16x32_bf16 v[92:95], a[96:99], a[48:51], 0
  ds_read_b64_tr_b16 a[206:207], v71 offset:20480
  v_cvt_pk_bf16_f32 v82, v84, v85
  v_xor_b32 v60, 0x10000, v60
  v_mfma_f32_16x16x32_bf16 v[92:95], a[100:103], a[52:55], v[92:95]
  v_cvt_pk_bf16_f32 v83, v86, v87
  v_add_f32 v74, v74, v84
  v_xor_b32 v61, 0x10000, v61
  v_mfma_f32_16x16x32_bf16 v[92:95], a[104:107], a[56:59], v[92:95]
  v_add_f32 v74, v74, v85
  v_xor_b32 v62, 0x10000, v62
  v_mfma_f32_16x16x32_bf16 v[92:95], a[108:111], a[60:63], v[92:95]
  v_add_f32 v74, v74, v86
  v_add_f32 v74, v74, v87
  v_xor_b32 v63, 0x10000, v63
  v_mfma_f32_16x16x32_bf16 v[160:163], a[144:147], v[80:83], v[160:163]
  v_exp_f32 v88, v88
  v_xor_b32 v64, 0x10000, v64
  v_mfma_f32_16x16x32_bf16 v[164:167], a[148:151], v[80:83], v[164:167]
  v_exp_f32 v89, v89
  v_xor_b32 v65, 0x10000, v65
  v_mfma_f32_16x16x32_bf16 v[168:171], a[152:155], v[80:83], v[168:171]
  v_exp_f32 v90, v90
  v_xor_b32 v66, 0x10000, v66
  v_mfma_f32_16x16x32_bf16 v[172:175], a[156:159], v[80:83], v[172:175]
  v_exp_f32 v91, v91
  v_xor_b32 v67, 0x10000, v67
  v_mfma_f32_16x16x32_bf16 v[176:179], a[160:163], v[80:83], v[176:179]
  v_exp_f32 v92, v92
  v_xor_b32 v68, 0x10000, v68
  v_mfma_f32_16x16x32_bf16 v[180:183], a[164:167], v[80:83], v[180:183]
  v_exp_f32 v93, v93
  v_xor_b32 v69, 0x10000, v69
  v_mfma_f32_16x16x32_bf16 v[184:187], a[168:171], v[80:83], v[184:187]
  v_exp_f32 v94, v94
  v_xor_b32 v70, 0x10000, v70
  v_mfma_f32_16x16x32_bf16 v[188:191], a[172:175], v[80:83], v[188:191]
  v_exp_f32 v95, v95
  v_xor_b32 v71, 0x10000, v71
L_a1s:
  s_cmp_gt_i32 s40, s63
  s_cselect_b32 s38, 4, 5
  s_add_u32 s38, s38, s40
  s_lshl_b32 s43, s38, 1
  s_add_u32 s43, s43, s30
  s_and_b32 s43, s43, 31
  s_lshl_b32 s43, s43, 12
  s_and_b32 s42, s38, 1
  s_lshl_b32 s42, s42, 14
  s_add_u32 s42, s42, s47
  s_andn2_b32 s41, 2, s38
  s_lshl_b32 s41, s41, 15
  s_add_u32 s42, s42, s41
  s_cmp_eq_u32 s40, s63
  s_cselect_b32 s38, 16, s38
  s_cmp_ge_u32 s38, 16
  s_cselect_b32 s42, 196608, s42
  s_cselect_b32 s43, 1073741824, s43
  s_waitcnt lgkmcnt(0)
  s_cmp_lt_i32 s40, s63
  s_cbranch_scc0 L_pc1
  s_waitcnt vmcnt(8)
L_pc1:
  s_sub_u32 s39, s40, 3
  s_cmp_ge_i32 s39, s63
  s_cbranch_scc0 L_pd1
  s_waitcnt vmcnt(16)
L_pd1:
  s_waitcnt vmcnt(32)
  s_barrier
  s_cmp_eq_u32 s40, 12
  s_cbranch_scc1 L_w1
L_wb1:
  v_mfma_f32_16x16x32_bf16 v[80:83], a[112:115], a[0:3], 0
  s_xor_b32 m0, s42, 0
  v_add_f32 v75, v75, v88
  s_add_u32 s38, s43, 4096
  v_mfma_f32_16x16x32_bf16 v[80:83], a[116:119], a[4:7], v[80:83]
  s_bitset0_b32 s38, 17
  buffer_load_dwordx4 v56, s[68:71], s43 offen offset:0 nt lds
  v_add_f32 v75, v75, v89
  v_add_f32 v75, v75, v90
  v_mfma_f32_16x16x32_bf16 v[80:83], a[120:123], a[8:11], v[80:83]
  ds_read_b128 a[80:83], v60 offset:0
  v_add_f32 v75, v75, v91
  v_mfma_f32_16x16x32_bf16 v[80:83], a[124:127], a[12:15], v[80:83]
  buffer_load_dwordx4 v57, s[68:71], s43 offen offset:1024 nt lds
  v_cvt_pk_bf16_f32 v88, v88, v89
  v_cvt_pk_bf16_f32 v89, v90, v91
  v_mfma_f32_16x16x32_bf16 v[84:87], a[128:131], a[0:3], 0
  ds_read_b128 a[84:87], v61 offset:0
  v_cvt_pk_bf16_f32 v90, v92, v93
  v_mfma_f32_16x16x32_bf16 v[84:87], a[132:135], a[4:7], v[84:87]
  v_cvt_pk_bf16_f32 v91, v94, v95
  v_add_f32 v75, v75, v92
  v_mfma_f32_16x16x32_bf16 v[84:87], a[136:139], a[8:11], v[84:87]
  ds_read_b128 a[88:91], v62 offset:0
  v_add_f32 v75, v75, v93
  v_mfma_f32_16x16x32_bf16 v[84:87], a[140:143], a[12:15], v[84:87]
  buffer_load_dwordx4 v56, s[68:71], s43 offen offset:2048 nt lds
  v_add_f32 v75, v75, v94
  v_add_f32 v75, v75, v95
  v_mfma_f32_16x16x32_bf16 v[192:195], a[144:147], v[88:91], v[192:195]
  ds_read_b128 a[92:95], v63 offset:0
  v_exp_f32 v80, v80
  v_mfma_f32_16x16x32_bf16 v[196:199], a[148:151], v[88:91], v[196:199]
  v_exp_f32 v81, v81
  v_mfma_f32_16x16x32_bf16 v[200:203], a[152:155], v[88:91], v[200:203]
  buffer_load_dwordx4 v57, s[68:71], s43 offen offset:3072 nt lds
  v_exp_f32 v82, v82
  v_mfma_f32_16x16x32_bf16 v[204:207], a[156:159], v[88:91], v[204:207]
  s_xor_b32 m0, s42, 4096
  ds_read_b128 a[96:99], v60 offset:4096
  v_exp_f32 v83, v83
  v_mfma_f32_16x16x32_bf16 v[208:211], a[160:163], v[88:91], v[208:211]
  v_exp_f32 v84, v84
  v_mfma_f32_16x16x32_bf16 v[212:215], a[164:167], v[88:91], v[212:215]
  ds_read_b128 a[100:103], v61 offset:4096
  v_exp_f32 v85, v85
  v_mfma_f32_16x16x32_bf16 v[216:219], a[168:171], v[88:91], v[216:219]
  buffer_load_dwordx4 v56, s[68:71], s38 offen offset:0 nt lds
  v_exp_f32 v86, v86
  v_mfma_f32_16x16x32_bf16 v[220:223], a[172:175], v[88:91], v[220:223]
  ds_read_b128 a[104:107], v62 offset:4096
  v_exp_f32 v87, v87
  v_mfma_f32_16x16x32_bf16 v[88:91], a[112:115], a[16:19], 0
  v_add_f32 v72, v72, v80
  v_mfma_f32_16x16x32_bf16 v[88:91], a[116:119], a[20:23], v[88:91]
  buffer_load_dwordx4 v57, s[68:71], s38 offen offset:1024 nt lds
  v_add_f32 v72, v72, v81
  v_add_f32 v72, v72, v82
  v_mfma_f32_16x16x32_bf16 v[88:91], a[120:123], a[24:27], v[88:91]
  ds_read_b128 a[108:111], v63 offset:4096
  v_add_f32 v72, v72, v83
  v_mfma_f32_16x16x32_bf16 v[88:91], a[124:127], a[28:31], v[88:91]
  ds_read_b64_tr_b16 a[144:145], v64 offset:0
  v_cvt_pk_bf16_f32 v80, v80, v81
  v_cvt_pk_bf16_f32 v81, v82, v83
  v_mfma_f32_16x16x32_bf16 v[92:95], a[128:131], a[16:19], 0
  buffer_load_dwordx4 v56, s[68:71], s38 offen offset:2048 nt lds
  v_cvt_pk_bf16_f32 v82, v84, v85
  v_mfma_f32_16x16x32_bf16 v[92:95], a[132:135], a[20:23], v[92:95]
  ds_read_b64_tr_b16 a[146:147], v64 offset:4096
  v_cvt_pk_bf16_f32 v83, v86, v87
  v_add_f32 v72, v72, v84
  v_mfma_f32_16x16x32_bf16 v[92:95], a[136:139], a[24:27], v[92:95]
  v_add_f32 v72, v72, v85
  v_mfma_f32_16x16x32_bf16 v[92:95], a[140:143], a[28:31], v[92:95]
  buffer_load_dwordx4 v57, s[68:71], s38 offen offset:3072 nt lds
  v_add_f32 v72, v72, v86
  v_add_f32 v72, v72, v87
  v_mfma_f32_16x16x32_bf16 v[96:99], a[176:179], v[80:83], v[96:99]
  s_xor_b32 m0, s42, 8192
  ds_read_b64_tr_b16 a[148:149], v65 offset:0
  v_exp_f32 v88, v88
  v_mfma_f32_16x16x32_bf16 v[100:103], a[180:183], v[80:83], v[100:103]
  ds_read_b64_tr_b16 a[150:151], v65 offset:4096
  v_exp_f32 v89, v89
  v_mfma_f32_16x16x32_bf16 v[104:107], a[184:187], v[80:83], v[104:107]
  v_exp_f32 v90, v90
  v_mfma_f32_16x16x32_bf16 v[108:111], a[188:191], v[80:83], v[108:111]
  buffer_load_dwordx4 v56, s[12:15], s43 offen offset:0 nt lds
  v_exp_f32 v91, v91
  v_mfma_f32_16x16x32_bf16 v[112:115], a[192:195], v[80:83], v[112:115]
  ds_read_b64_tr_b16 a[152:153], v66 offset:0
  v_exp_f32 v92, v92
  v_mfma_f32_16x16x32_bf16 v[116:119], a[196:199], v[80:83], v[116:119]
  v_exp_f32 v93, v93
  v_mfma_f32_16x16x32_bf16 v[120:123], a[200:203], v[80:83], v[120:123]
  buffer_load_dwordx4 v57, s[12:15], s43 offen offset:1024 nt lds
  v_exp_f32 v94, v94
  v_mfma_f32_16x16x32_bf16 v[124:127], a[204:207], v[80:83], v[124:127]
  ds_read_b64_tr_b16 a[154:155], v66 offset:4096
  v_exp_f32 v95, v95
  v_mfma_f32_16x16x32_bf16 v[80:83], a[112:115], a[32:35], 0
  ds_read_b64_tr_b16 a[156:157], v67 offset:0
  v_add_f32 v73, v73, v88
  v_mfma_f32_16x16x32_bf16 v[80:83], a[116:119], a[36:39], v[80:83]
  v_add_f32 v73, v73, v89
  v_add_f32 v73, v73, v90
  v_mfma_f32_16x16x32_bf16 v[80:83], a[120:123], a[40:43], v[80:83]
  buffer_load_dwordx4 v56, s[12:15], s43 offen offset:2048 nt lds
  v_add_f32 v73, v73, v91
  v_mfma_f32_16x16x32_bf16 v[80:83], a[124:127], a[44:47], v[80:83]
  ds_read_b64_tr_b16 a[158:159], v67 offset:4096
  v_cvt_pk_bf16_f32 v88, v88, v89
  v_cvt_pk_bf16_f32 v89, v90, v91
  v_mfma_f32_16x16x32_bf16 v[84:87], a[128:131], a[32:35], 0
  buffer_load_dwordx4 v57, s[12:15], s43 offen offset:3072 nt lds
  v_cvt_pk_bf16_f32 v90, v92, v93
  v_mfma_f32_16x16x32_bf16 v[84:87], a[132:135], a[36:39], v[84:87]
  s_xor_b32 m0, s42, 12288
  ds_read_b64_tr_b16 a[160:161], v68 offset:0
  v_cvt_pk_bf16_f32 v91, v94, v95
  v_add_f32 v73, v73, v92
  v_mfma_f32_16x16x32_bf16 v[84:87], a[136:139], a[40:43], v[84:87]
  ds_read_b64_tr_b16 a[162:163], v68 offset:4096
  v_add_f32 v73, v73, v93
  v_mfma_f32_16x16x32_bf16 v[84:87], a[140:143], a[44:47], v[84:87]
  v_add_f32 v73, v73, v94
  v_add_f32 v73, v73, v95
  v_mfma_f32_16x16x32_bf16 v[128:131], a[176:179], v[88:91], v[128:131]
  buffer_load_dwordx4 v56, s[12:15], s38 offen offset:0 nt lds
  v_exp_f32 v80, v80
  v_mfma_f32_16x16x32_bf16 v[132:135], a[180:183], v[88:91], v[132:135]
  ds_read_b64_tr_b16 a[164:165], v69 offset:0
  v_exp_f32 v81, v81
  v_mfma_f32_16x16x32_bf16 v[136:139], a[184:187], v[88:91], v[136:139]
  buffer_load_dwordx4 v57, s[12:15], s38 offen offset:1024 nt lds
  v_exp_f32 v82, v82
  v_mfma_f32_16x16x32_bf16 v[140:143], a[188:191], v[88:91], v[140:143]
  v_exp_f32 v83, v83
  v_mfma_f32_16x16x32_bf16 v[144:147], a[192:195], v[88:91], v[144:147]
  ds_read_b64_tr_b16 a[166:167], v69 offset:4096
  v_exp_f32 v84, v84
  v_mfma_f32_16x16x32_bf16 v[148:151], a[196:199], v[88:91], v[148:151]
  ds_read_b64_tr_b16 a[168:169], v70 offset:0
  v_exp_f32 v85, v85
  v_mfma_f32_16x16x32_bf16 v[152:155], a[200:203], v[88:91], v[152:155]
  v_exp_f32 v86, v86
  v_mfma_f32_16x16x32_bf16 v[156:159], a[204:207], v[88:91], v[156:159]
  buffer_load_dwordx4 v56, s[12:15], s38 offen offset:2048 nt lds
  v_exp_f32 v87, v87
  v_mfma_f32_16x16x32_bf16 v[88:91], a[112:115], a[48:51], 0
  ds_read_b64_tr_b16 a[170:171], v70 offset:4096
  v_add_f32 v74, v74, v80
  v_mfma_f32_16x16x32_bf16 v[88:91], a[116:119], a[52:55], v[88:91]
  buffer_load_dwordx4 v57, s[12:15], s38 offen offset:3072 nt lds
  v_add_f32 v74, v74, v81
  v_add_f32 v74, v74, v82
  v_mfma_f32_16x16x32_bf16 v[88:91], a[120:123], a[56:59], v[88:91]
  ds_read_b64_tr_b16 a[172:173], v71 offset:0
  v_add_f32 v74, v74, v83
  v_mfma_f32_16x16x32_bf16 v[88:91], a[124:127], a[60:63], v[88:91]
  v_cvt_pk_bf16_f32 v80, v80, v81
  v_cvt_pk_bf16_f32 v81, v82, v83
  v_mfma_f32_16x16x32_bf16 v[92:95], a[128:131], a[48:51], 0
  ds_read_b64_tr_b16 a[174:175], v71 offset:4096
  v_cvt_pk_bf16_f32 v82, v84, v85
  v_mfma_f32_16x16x32_bf16 v[92:95], a[132:135], a[52:55], v[92:95]
  v_cvt_pk_bf16_f32 v83, v86, v87
  v_add_f32 v74, v74, v84
  v_mfma_f32_16x16x32_bf16 v[92:95], a[136:139], a[56:59], v[92:95]
  v_add_f32 v74, v74, v85
  v_mfma_f32_16x16x32_bf16 v[92:95], a[140:143], a[60:63], v[92:95]
  v_add_f32 v74, v74, v86
  v_add_f32 v74, v74, v87
  v_mfma_f32_16x16x32_bf16 v[160:163], a[176:179], v[80:83], v[160:163]
  v_exp_f32 v88, v88
  v_mfma_f32_16x16x32_bf16 v[164:167], a[180:183], v[80:83], v[164:167]
  v_exp_f32 v89, v89
  v_mfma_f32_16x16x32_bf16 v[168:171], a[184:187], v[80:83], v[168:171]
  v_exp_f32 v90, v90
  v_mfma_f32_16x16x32_bf16 v[172:175], a[188:191], v[80:83], v[172:175]
  v_exp_f32 v91, v91
  v_mfma_f32_16x16x32_bf16 v[176:179], a[192:195], v[80:83], v[176:179]
  v_exp_f32 v92, v92
  v_mfma_f32_16x16x32_bf16 v[180:183], a[196:199], v[80:83], v[180:183]
  v_exp_f32 v93, v93
  v_mfma_f32_16x16x32_bf16 v[184:187], a[200:203], v[80:83], v[184:187]
  v_exp_f32 v94, v94
  v_mfma_f32_16x16x32_bf16 v[188:191], a[204:207], v[80:83], v[188:191]
  v_exp_f32 v95, v95
  s_xor_b32 s45, s45, 0x10000
  s_add_u32 s40, s40, 2
  s_cmp_lt_u32 s40, 14
  s_cbranch_scc1 L_as
  s_waitcnt lgkmcnt(0)
  v_mfma_f32_16x16x32_bf16 v[80:83], a[80:83], a[0:3], 0
  v_add_f32 v75, v75, v88
  v_mfma_f32_16x16x32_bf16 v[80:83], a[84:87], a[4:7], v[80:83]
  v_add_f32 v75, v75, v89
  v_add_f32 v75, v75, v90
  v_mfma_f32_16x16x32_bf16 v[80:83], a[88:91], a[8:11], v[80:83]
  v_add_f32 v75, v75, v91
  v_mfma_f32_16x16x32_bf16 v[80:83], a[92:95], a[12:15], v[80:83]
  v_cvt_pk_bf16_f32 v88, v88, v89
  v_cvt_pk_bf16_f32 v89, v90, v91
  v_mfma_f32_16x16x32_bf16 v[84:87], a[96:99], a[0:3], 0
  v_cvt_pk_bf16_f32 v90, v92, v93
  v_mfma_f32_16x16x32_bf16 v[84:87], a[100:103], a[4:7], v[84:87]
  v_cvt_pk_bf16_f32 v91, v94, v95
  v_add_f32 v75, v75, v92
  v_mfma_f32_16x16x32_bf16 v[84:87], a[104:107], a[8:11], v[84:87]
  v_add_f32 v75, v75, v93
  v_mfma_f32_16x16x32_bf16 v[84:87], a[108:111], a[12:15], v[84:87]
  v_add_f32 v75, v75, v94
  v_add_f32 v75, v75, v95
  v_mfma_f32_16x16x32_bf16 v[192:195], a[176:179], v[88:91], v[192:195]
  v_exp_f32 v80, v80
  v_mfma_f32_16x16x32_bf16 v[196:199], a[180:183], v[88:91], v[196:199]
  v_exp_f32 v81, v81
  v_mfma_f32_16x16x32_bf16 v[200:203], a[184:187], v[88:91], v[200:203]
  v_exp_f32 v82, v82
  v_mfma_f32_16x16x32_bf16 v[204:207], a[188:191], v[88:91], v[204:207]
  v_exp_f32 v83, v83
  v_mfma_f32_16x16x32_bf16 v[208:211], a[192:195], v[88:91], v[208:211]
  v_exp_f32 v84, v84
  v_mfma_f32_16x16x32_bf16 v[212:215], a[196:199], v[88:91], v[212:215]
  v_exp_f32 v85, v85
  v_mfma_f32_16x16x32_bf16 v[216:219], a[200:203], v[88:91], v[216:219]
  v_exp_f32 v86, v86
  v_mfma_f32_16x16x32_bf16 v[220:223], a[204:207], v[88:91], v[220:223]
  v_exp_f32 v87, v87
  v_mfma_f32_16x16x32_bf16 v[88:91], a[80:83], a[16:19], 0
  v_add_f32 v72, v72, v80
  v_mfma_f32_16x16x32_bf16 v[88:91], a[84:87], a[20:23], v[88:91]
  v_add_f32 v72, v72, v81
  v_add_f32 v72, v72, v82
  v_mfma_f32_16x16x32_bf16 v[88:91], a[88:91], a[24:27], v[88:91]
  v_add_f32 v72, v72, v83
  v_mfma_f32_16x16x32_bf16 v[88:91], a[92:95], a[28:31], v[88:91]
  v_cvt_pk_bf16_f32 v80, v80, v81
  v_cvt_pk_bf16_f32 v81, v82, v83
  v_mfma_f32_16x16x32_bf16 v[92:95], a[96:99], a[16:19], 0
  v_cvt_pk_bf16_f32 v82, v84, v85
  v_mfma_f32_16x16x32_bf16 v[92:95], a[100:103], a[20:23], v[92:95]
  v_cvt_pk_bf16_f32 v83, v86, v87
  v_add_f32 v72, v72, v84
  v_mfma_f32_16x16x32_bf16 v[92:95], a[104:107], a[24:27], v[92:95]
  v_add_f32 v72, v72, v85
  v_mfma_f32_16x16x32_bf16 v[92:95], a[108:111], a[28:31], v[92:95]
  v_add_f32 v72, v72, v86
  v_add_f32 v72, v72, v87
  v_mfma_f32_16x16x32_bf16 v[96:99], a[144:147], v[80:83], v[96:99]
  v_exp_f32 v88, v88
  v_mfma_f32_16x16x32_bf16 v[100:103], a[148:151], v[80:83], v[100:103]
  v_exp_f32 v89, v89
  v_mfma_f32_16x16x32_bf16 v[104:107], a[152:155], v[80:83], v[104:107]
  v_exp_f32 v90, v90
  v_mfma_f32_16x16x32_bf16 v[108:111], a[156:159], v[80:83], v[108:111]
  v_exp_f32 v91, v91
  v_mfma_f32_16x16x32_bf16 v[112:115], a[160:163], v[80:83], v[112:115]
  v_exp_f32 v92, v92
  v_mfma_f32_16x16x32_bf16 v[116:119], a[164:167], v[80:83], v[116:119]
  v_exp_f32 v93, v93
  v_mfma_f32_16x16x32_bf16 v[120:123], a[168:171], v[80:83], v[120:123]
  v_exp_f32 v94, v94
  v_mfma_f32_16x16x32_bf16 v[124:127], a[172:175], v[80:83], v[124:127]
  v_exp_f32 v95, v95
  s_waitcnt vmcnt(34)
  s_barrier
  v_mfma_f32_16x16x32_bf16 v[80:83], a[80:83], a[32:35], 0
  ds_read_b128 a[112:115], v60 offset:16384
  v_add_f32 v73, v73, v88
  v_mfma_f32_16x16x32_bf16 v[80:83], a[84:87], a[36:39], v[80:83]
  ds_read_b128 a[116:119], v61 offset:16384
  v_add_f32 v73, v73, v89
  v_add_f32 v73, v73, v90
  v_mfma_f32_16x16x32_bf16 v[80:83], a[88:91], a[40:43], v[80:83]
  ds_read_b128 a[120:123], v62 offset:16384
  v_add_f32 v73, v73, v91
  v_mfma_f32_16x16x32_bf16 v[80:83], a[92:95], a[44:47], v[80:83]
  ds_read_b128 a[124:127], v63 offset:16384
  v_cvt_pk_bf16_f32 v88, v88, v89
  v_cvt_pk_bf16_f32 v89, v90, v91
  v_mfma_f32_16x16x32_bf16 v[84:87], a[96:99], a[32:35], 0
  ds_read_b128 a[128:131], v60 offset:20480
  v_cvt_pk_bf16_f32 v90, v92, v93
  v_mfma_f32_16x16x32_bf16 v[84:87], a[100:103], a[36:39], v[84:87]
  ds_read_b128 a[132:135], v61 offset:20480
  v_cvt_pk_bf16_f32 v91, v94, v95
  v_add_f32 v73, v73, v92
  v_mfma_f32_16x16x32_bf16 v[84:87], a[104:107], a[40:43], v[84:87]
  ds_read_b128 a[136:139], v62 offset:20480
  v_add_f32 v73, v73, v93
  v_mfma_f32_16x16x32_bf16 v[84:87], a[108:111], a[44:47], v[84:87]
  ds_read_b128 a[140:143], v63 offset:20480
  v_add_f32 v73, v73, v94
  v_add_f32 v73, v73, v95
  v_mfma_f32_16x16x32_bf16 v[128:131], a[144:147], v[88:91], v[128:131]
  ds_read_b64_tr_b16 a[176:177], v64 offset:16384
  v_exp_f32 v80, v80
  v_mfma_f32_16x16x32_bf16 v[132:135], a[148:151], v[88:91], v[132:135]
  ds_read_b64_tr_b16 a[178:179], v64 offset:20480
  v_exp_f32 v81, v81
  v_mfma_f32_16x16x32_bf16 v[136:139], a[152:155], v[88:91], v[136:139]
  ds_read_b64_tr_b16 a[180:181], v65 offset:16384
  v_exp_f32 v82, v82
  v_mfma_f32_16x16x32_bf16 v[140:143], a[156:159], v[88:91], v[140:143]
  ds_read_b64_tr_b16 a[182:183], v65 offset:20480
  v_exp_f32 v83, v83
  v_mfma_f32_16x16x32_bf16 v[144:147], a[160:163], v[88:91], v[144:147]
  ds_read_b64_tr_b16 a[184:185], v66 offset:16384
  v_exp_f32 v84, v84
  v_mfma_f32_16x16x32_bf16 v[148:151], a[164:167], v[88:91], v[148:151]
  ds_read_b64_tr_b16 a[186:187], v66 offset:20480
  v_exp_f32 v85, v85
  v_mfma_f32_16x16x32_bf16 v[152:155], a[168:171], v[88:91], v[152:155]
  ds_read_b64_tr_b16 a[188:189], v67 offset:16384
  v_exp_f32 v86, v86
  v_mfma_f32_16x16x32_bf16 v[156:159], a[172:175], v[88:91], v[156:159]
  ds_read_b64_tr_b16 a[190:191], v67 offset:20480
  v_exp_f32 v87, v87
  v_mfma_f32_16x16x32_bf16 v[88:91], a[80:83], a[48:51], 0
  ds_read_b64_tr_b16 a[192:193], v68 offset:16384
  v_add_f32 v74, v74, v80
  v_mfma_f32_16x16x32_bf16 v[88:91], a[84:87], a[52:55], v[88:91]
  ds_read_b64_tr_b16 a[194:195], v68 offset:20480
  v_add_f32 v74, v74, v81
  v_add_f32 v74, v74, v82
  v_mfma_f32_16x16x32_bf16 v[88:91], a[88:91], a[56:59], v[88:91]
  ds_read_b64_tr_b16 a[196:197], v69 offset:16384
  v_add_f32 v74, v74, v83
  v_mfma_f32_16x16x32_bf16 v[88:91], a[92:95], a[60:63], v[88:91]
  ds_read_b64_tr_b16 a[198:199], v69 offset:20480
  v_cvt_pk_bf16_f32 v80, v80, v81
  v_cvt_pk_bf16_f32 v81, v82, v83
  v_mfma_f32_16x16x32_bf16 v[92:95], a[96:99], a[48:51], 0
  ds_read_b64_tr_b16 a[200:201], v70 offset:16384
  v_cvt_pk_bf16_f32 v82, v84, v85
  v_mfma_f32_16x16x32_bf16 v[92:95], a[100:103], a[52:55], v[92:95]
  ds_read_b64_tr_b16 a[202:203], v70 offset:20480
  v_cvt_pk_bf16_f32 v83, v86, v87
  v_add_f32 v74, v74, v84
  v_mfma_f32_16x16x32_bf16 v[92:95], a[104:107], a[56:59], v[92:95]
  ds_read_b64_tr_b16 a[204:205], v71 offset:16384
  v_add_f32 v74, v74, v85
  v_mfma_f32_16x16x32_bf16 v[92:95], a[108:111], a[60:63], v[92:95]
  ds_read_b64_tr_b16 a[206:207], v71 offset:20480
  v_add_f32 v74, v74, v86
  v_add_f32 v74, v74, v87
  v_mfma_f32_16x16x32_bf16 v[160:163], a[144:147], v[80:83], v[160:163]
  v_exp_f32 v88, v88
  v_mfma_f32_16x16x32_bf16 v[164:167], a[148:151], v[80:83], v[164:167]
  v_exp_f32 v89, v89
  v_mfma_f32_16x16x32_bf16 v[168:171], a[152:155], v[80:83], v[168:171]
  v_exp_f32 v90, v90
  v_mfma_f32_16x16x32_bf16 v[172:175], a[156:159], v[80:83], v[172:175]
  v_exp_f32 v91, v91
  v_mfma_f32_16x16x32_bf16 v[176:179], a[160:163], v[80:83], v[176:179]
  v_exp_f32 v92, v92
  v_mfma_f32_16x16x32_bf16 v[180:183], a[164:167], v[80:83], v[180:183]
  v_exp_f32 v93, v93
  v_mfma_f32_16x16x32_bf16 v[184:187], a[168:171], v[80:83], v[184:187]
  v_exp_f32 v94, v94
  v_mfma_f32_16x16x32_bf16 v[188:191], a[172:175], v[80:83], v[188:191]
  v_exp_f32 v95, v95
  s_waitcnt lgkmcnt(0)
  s_barrier
  s_add_u32 s76, s79, 0
  s_and_b32 s76, s76, 15
  s_mul_i32 s76, s76, s52
  s_add_u32 s76, s76, s78
  s_add_u32 s75, s77, 0
  s_add_u32 m0, s75, 0
  s_nop 0
  buffer_load_dwordx4 v32, s[8:11], s76 offen offset:0  lds
  buffer_load_dwordx4 v33, s[8:11], s76 offen offset:1024  lds
  buffer_load_dwordx4 v34, s[8:11], s76 offen offset:2048  lds
  buffer_load_dwordx4 v35, s[8:11], s76 offen offset:3072  lds
  s_add_u32 m0, s75, 4096
  s_nop 0
  buffer_load_dwordx4 v36, s[8:11], s76 offen offset:0  lds
  buffer_load_dwordx4 v37, s[8:11], s76 offen offset:1024  lds
  buffer_load_dwordx4 v38, s[8:11], s76 offen offset:2048  lds
  buffer_load_dwordx4 v39, s[8:11], s76 offen offset:3072  lds
  s_add_u32 m0, s75, 8192
  s_nop 0
  buffer_load_dwordx4 v40, s[8:11], s76 offen offset:0  lds
  s_add_u32 s76, s79, 1
  s_and_b32 s76, s76, 15
  s_mul_i32 s76, s76, s52
  s_add_u32 s76, s76, s78
  s_add_u32 s75, s77, 36864
  s_add_u32 m0, s75, 0
  s_nop 0
  buffer_load_dwordx4 v32, s[8:11], s76 offen offset:0  lds
  buffer_load_dwordx4 v33, s[8:11], s76 offen offset:1024  lds
  buffer_load_dwordx4 v34, s[8:11], s76 offen offset:2048  lds
  buffer_load_dwordx4 v35, s[8:11], s76 offen offset:3072  lds
  s_add_u32 m0, s75, 4096
  s_nop 0
  buffer_load_dwordx4 v36, s[8:11], s76 offen offset:0  lds
  buffer_load_dwordx4 v37, s[8:11], s76 offen offset:1024  lds
  buffer_load_dwordx4 v38, s[8:11], s76 offen offset:2048  lds
  buffer_load_dwordx4 v39, s[8:11], s76 offen offset:3072  lds
  s_add_u32 m0, s75, 8192
  s_nop 0
  buffer_load_dwordx4 v40, s[8:11], s76 offen offset:0  lds
  v_mfma_f32_16x16x32_bf16 v[80:83], a[112:115], a[0:3], 0
  v_add_f32 v75, v75, v88
  v_mfma_f32_16x16x32_bf16 v[80:83], a[116:119], a[4:7], v[80:83]
  v_add_f32 v75, v75, v89
  v_add_f32 v75, v75, v90
  v_mfma_f32_16x16x32_bf16 v[80:83], a[120:123], a[8:11], v[80:83]
  v_add_f32 v75, v75, v91
  v_mfma_f32_16x16x32_bf16 v[80:83], a[124:127], a[12:15], v[80:83]
  v_cvt_pk_bf16_f32 v88, v88, v89
  v_cvt_pk_bf16_f32 v89, v90, v91
  v_mfma_f32_16x16x32_bf16 v[84:87], a[128:131], a[0:3], 0
  v_cvt_pk_bf16_f32 v90, v92, v93
  v_mfma_f32_16x16x32_bf16 v[84:87], a[132:135], a[4:7], v[84:87]
  v_cvt_pk_bf16_f32 v91, v94, v95
  v_add_f32 v75, v75, v92
  v_mfma_f32_16x16x32_bf16 v[84:87], a[136:139], a[8:11], v[84:87]
  v_add_f32 v75, v75, v93
  v_mfma_f32_16x16x32_bf16 v[84:87], a[140:143], a[12:15], v[84:87]
  v_add_f32 v75, v75, v94
  v_add_f32 v75, v75, v95
  v_mfma_f32_16x16x32_bf16 v[192:195], a[144:147], v[88:91], v[192:195]
  v_exp_f32 v80, v80
  v_mfma_f32_16x16x32_bf16 v[196:199], a[148:151], v[88:91], v[196:199]
  v_exp_f32 v81, v81
  v_mfma_f32_16x16x32_bf16 v[200:203], a[152:155], v[88:91], v[200:203]
  v_exp_f32 v82, v82
  v_mfma_f32_16x16x32_bf16 v[204:207], a[156:159], v[88:91], v[204:207]
  v_exp_f32 v83, v83
  v_mfma_f32_16x16x32_bf16 v[208:211], a[160:163], v[88:91], v[208:211]
  v_exp_f32 v84, v84
  v_mfma_f32_16x16x32_bf16 v[212:215], a[164:167], v[88:91], v[212:215]
  v_exp_f32 v85, v85
  v_mfma_f32_16x16x32_bf16 v[216:219], a[168:171], v[88:91], v[216:219]
  v_exp_f32 v86, v86
  v_mfma_f32_16x16x32_bf16 v[220:223], a[172:175], v[88:91], v[220:223]
  v_exp_f32 v87, v87
  v_mfma_f32_16x16x32_bf16 v[88:91], a[112:115], a[16:19], 0
  v_add_f32 v72, v72, v80
  v_mfma_f32_16x16x32_bf16 v[88:91], a[116:119], a[20:23], v[88:91]
  v_add_f32 v72, v72, v81
  v_add_f32 v72, v72, v82
  v_mfma_f32_16x16x32_bf16 v[88:91], a[120:123], a[24:27], v[88:91]
  v_add_f32 v72, v72, v83
  v_mfma_f32_16x16x32_bf16 v[88:91], a[124:127], a[28:31], v[88:91]
  v_cvt_pk_bf16_f32 v80, v80, v81
  v_cvt_pk_bf16_f32 v81, v82, v83
  v_mfma_f32_16x16x32_bf16 v[92:95], a[128:131], a[16:19], 0
  v_cvt_pk_bf16_f32 v82, v84, v85
  v_mfma_f32_16x16x32_bf16 v[92:95], a[132:135], a[20:23], v[92:95]
  v_cvt_pk_bf16_f32 v83, v86, v87
  v_add_f32 v72, v72, v84
  v_mfma_f32_16x16x32_bf16 v[92:95], a[136:139], a[24:27], v[92:95]
  v_add_f32 v72, v72, v85
  v_mfma_f32_16x16x32_bf16 v[92:95], a[140:143], a[28:31], v[92:95]
  v_add_f32 v72, v72, v86
  v_add_f32 v72, v72, v87
  v_mfma_f32_16x16x32_bf16 v[96:99], a[176:179], v[80:83], v[96:99]
  v_exp_f32 v88, v88
  v_mfma_f32_16x16x32_bf16 v[100:103], a[180:183], v[80:83], v[100:103]
  v_exp_f32 v89, v89
  v_mfma_f32_16x16x32_bf16 v[104:107], a[184:187], v[80:83], v[104:107]
  v_exp_f32 v90, v90
  v_mfma_f32_16x16x32_bf16 v[108:111], a[188:191], v[80:83], v[108:111]
  v_exp_f32 v91, v91
  v_mfma_f32_16x16x32_bf16 v[112:115], a[192:195], v[80:83], v[112:115]
  v_exp_f32 v92, v92
  v_mfma_f32_16x16x32_bf16 v[116:119], a[196:199], v[80:83], v[116:119]
  v_exp_f32 v93, v93
  v_mfma_f32_16x16x32_bf16 v[120:123], a[200:203], v[80:83], v[120:123]
  v_exp_f32 v94, v94
  v_mfma_f32_16x16x32_bf16 v[124:127], a[204:207], v[80:83], v[124:127]
  v_exp_f32 v95, v95
  v_mfma_f32_16x16x32_bf16 v[80:83], a[112:115], a[32:35], 0
  v_add_f32 v73, v73, v88
  v_mfma_f32_16x16x32_bf16 v[80:83], a[116:119], a[36:39], v[80:83]
  v_add_f32 v73, v73, v89
  v_add_f32 v73, v73, v90
  v_mfma_f32_16x16x32_bf16 v[80:83], a[120:123], a[40:43], v[80:83]
  v_add_f32 v73, v73, v91
  v_mfma_f32_16x16x32_bf16 v[80:83], a[124:127], a[44:47], v[80:83]
  v_cvt_pk_bf16_f32 v88, v88, v89
  v_cvt_pk_bf16_f32 v89, v90, v91
  v_mfma_f32_16x16x32_bf16 v[84:87], a[128:131], a[32:35], 0
  v_cvt_pk_bf16_f32 v90, v92, v93
  v_mfma_f32_16x16x32_bf16 v[84:87], a[132:135], a[36:39], v[84:87]
  v_cvt_pk_bf16_f32 v91, v94, v95
  v_add_f32 v73, v73, v92
  v_mfma_f32_16x16x32_bf16 v[84:87], a[136:139], a[40:43], v[84:87]
  v_add_f32 v73, v73, v93
  v_mfma_f32_16x16x32_bf16 v[84:87], a[140:143], a[44:47], v[84:87]
  v_add_f32 v73, v73, v94
  v_add_f32 v73, v73, v95
  v_mfma_f32_16x16x32_bf16 v[128:131], a[176:179], v[88:91], v[128:131]
  v_exp_f32 v80, v80
  v_mfma_f32_16x16x32_bf16 v[132:135], a[180:183], v[88:91], v[132:135]
  v_exp_f32 v81, v81
  v_mfma_f32_16x16x32_bf16 v[136:139], a[184:187], v[88:91], v[136:139]
  v_exp_f32 v82, v82
  v_mfma_f32_16x16x32_bf16 v[140:143], a[188:191], v[88:91], v[140:143]
  v_exp_f32 v83, v83
  v_mfma_f32_16x16x32_bf16 v[144:147], a[192:195], v[88:91], v[144:147]
  v_exp_f32 v84, v84
  v_mfma_f32_16x16x32_bf16 v[148:151], a[196:199], v[88:91], v[148:151]
  v_exp_f32 v85, v85
  v_mfma_f32_16x16x32_bf16 v[152:155], a[200:203], v[88:91], v[152:155]
  v_exp_f32 v86, v86
  v_mfma_f32_16x16x32_bf16 v[156:159], a[204:207], v[88:91], v[156:159]
  v_exp_f32 v87, v87
  v_mfma_f32_16x16x32_bf16 v[88:91], a[112:115], a[48:51], 0
  v_add_f32 v74, v74, v80
  v_mfma_f32_16x16x32_bf16 v[88:91], a[116:119], a[52:55], v[88:91]
  v_add_f32 v74, v74, v81
  v_add_f32 v74, v74, v82
  v_mfma_f32_16x16x32_bf16 v[88:91], a[120:123], a[56:59], v[88:91]
  v_add_f32 v74, v74, v83
  v_mfma_f32_16x16x32_bf16 v[88:91], a[124:127], a[60:63], v[88:91]
  v_cvt_pk_bf16_f32 v80, v80, v81
  v_cvt_pk_bf16_f32 v81, v82, v83
  v_mfma_f32_16x16x32_bf16 v[92:95], a[128:131], a[48:51], 0
  v_cvt_pk_bf16_f32 v82, v84, v85
  v_mfma_f32_16x16x32_bf16 v[92:95], a[132:135], a[52:55], v[92:95]
  v_cvt_pk_bf16_f32 v83, v86, v87
  v_add_f32 v74, v74, v84
  v_mfma_f32_16x16x32_bf16 v[92:95], a[136:139], a[56:59], v[92:95]
  v_add_f32 v74, v74, v85
  v_mfma_f32_16x16x32_bf16 v[92:95], a[140:143], a[60:63], v[92:95]
  v_add_f32 v74, v74, v86
  v_add_f32 v74, v74, v87
  v_mfma_f32_16x16x32_bf16 v[160:163], a[176:179], v[80:83], v[160:163]
  v_exp_f32 v88, v88
  v_mfma_f32_16x16x32_bf16 v[164:167], a[180:183], v[80:83], v[164:167]
  v_exp_f32 v89, v89
  v_mfma_f32_16x16x32_bf16 v[168:171], a[184:187], v[80:83], v[168:171]
  v_exp_f32 v90, v90
  v_mfma_f32_16x16x32_bf16 v[172:175], a[188:191], v[80:83], v[172:175]
  v_exp_f32 v91, v91
  v_mfma_f32_16x16x32_bf16 v[176:179], a[192:195], v[80:83], v[176:179]
  v_exp_f32 v92, v92
  v_mfma_f32_16x16x32_bf16 v[180:183], a[196:199], v[80:83], v[180:183]
  v_exp_f32 v93, v93
  v_mfma_f32_16x16x32_bf16 v[184:187], a[200:203], v[80:83], v[184:187]
  v_exp_f32 v94, v94
  v_mfma_f32_16x16x32_bf16 v[188:191], a[204:207], v[80:83], v[188:191]
  v_exp_f32 v95, v95
  s_nop 0
  v_add_f32 v75, v75, v88
  v_add_f32 v75, v75, v89
  v_add_f32 v75, v75, v90
  v_add_f32 v75, v75, v91
  v_cvt_pk_bf16_f32 v88, v88, v89
  v_cvt_pk_bf16_f32 v89, v90, v91
  v_cvt_pk_bf16_f32 v90, v92, v93
  v_cvt_pk_bf16_f32 v91, v94, v95
  v_add_f32 v75, v75, v92
  v_add_f32 v75, v75, v93
  v_add_f32 v75, v75, v94
  v_add_f32 v75, v75, v95
  v_mfma_f32_16x16x32_bf16 v[192:195], a[176:179], v[88:91], v[192:195]
  v_mov_b32 v1, v72
  v_mov_b32 v2, v73
  v_mov_b32 v3, v74
  v_mov_b32 v4, v75
  v_mfma_f32_16x16x32_bf16 v[196:199], a[180:183], v[88:91], v[196:199]
  s_nop 1
  v_permlane32_swap_b32 v1, v72
  v_permlane32_swap_b32 v2, v73
  v_permlane32_swap_b32 v3, v74
  v_mfma_f32_16x16x32_bf16 v[200:203], a[184:187], v[88:91], v[200:203]
  v_permlane32_swap_b32 v4, v75
  s_nop 1
  v_add_f32 v72, v72, v1
  v_add_f32 v73, v73, v2
  v_mfma_f32_16x16x32_bf16 v[204:207], a[188:191], v[88:91], v[204:207]
  v_add_f32 v74, v74, v3
  v_add_f32 v75, v75, v4
  v_mov_b32 v1, v72
  v_mov_b32 v2, v73
  v_mfma_f32_16x16x32_bf16 v[208:211], a[192:195], v[88:91], v[208:211]
  v_mov_b32 v3, v74
  v_mov_b32 v4, v75
  s_nop 1
  v_permlane16_swap_b32 v1, v72
  v_mfma_f32_16x16x32_bf16 v[212:215], a[196:199], v[88:91], v[212:215]
  v_permlane16_swap_b32 v2, v73
  v_permlane16_swap_b32 v3, v74
  v_permlane16_swap_b32 v4, v75
  s_nop 1
  v_mfma_f32_16x16x32_bf16 v[216:219], a[200:203], v[88:91], v[216:219]
  v_add_f32 v72, v72, v1
  v_add_f32 v73, v73, v2
  v_add_f32 v74, v74, v3
  v_add_f32 v75, v75, v4
  v_mfma_f32_16x16x32_bf16 v[220:223], a[204:207], v[88:91], v[220:223]
L_es:
  v_mov_b32 v6, v72
  v_mov_b32 v7, v72
  v_min_u32 v6, v6, v73
  v_max_u32 v7, v7, v73
  v_min_u32 v6, v6, v74
  v_max_u32 v7, v7, v74
  v_min_u32 v6, v6, v75
  v_max_u32 v7, v7, v75
  v_cmp_gt_u32 vcc, 0x35800000, v6
  v_cmp_lt_u32 s[80:81], s51, v7
  s_nop 1
  s_or_b64 vcc, vcc, s[80:81]
  s_cbranch_vccz L_oks
  v_mov_b32 v6, 163836
  v_mov_b32 v7, 1
  ds_write_b32 v6, v7
L_oks:
  v_rcp_f32 v72, v72
  v_rcp_f32 v73, v73
  v_rcp_f32 v74, v74
  v_rcp_f32 v75, v75
  s_nop 0
  v_pk_mul_f32 v[96:97], v[96:97], v[72:73] op_sel:[0,0] op_sel_hi:[1,0]
  v_pk_mul_f32 v[98:99], v[98:99], v[72:73] op_sel:[0,0] op_sel_hi:[1,0]
  v_pk_mul_f32 v[100:101], v[100:101], v[72:73] op_sel:[0,0] op_sel_hi:[1,0]
  v_pk_mul_f32 v[102:103], v[102:103], v[72:73] op_sel:[0,0] op_sel_hi:[1,0]
  v_cvt_pk_bf16_f32 v8, v96, v97
  v_cvt_pk_bf16_f32 v9, v98, v99
  v_cvt_pk_bf16_f32 v10, v100, v101
  v_cvt_pk_bf16_f32 v11, v102, v103
  ds_write_b128 v49, v[8:11] offset:0
  s_add_u32 s38, s50, 0
  s_nop 0
  buffer_store_dwordx4 v[8:11], v52, s[24:27], s38 offen offset:0 sc1
  v_pk_mov_b32 v[96:97], 0, 0
  v_pk_mov_b32 v[98:99], 0, 0
  v_pk_mov_b32 v[100:101], 0, 0
  v_pk_mov_b32 v[102:103], 0, 0
  v_pk_mul_f32 v[104:105], v[104:105], v[72:73] op_sel:[0,0] op_sel_hi:[1,0]
  v_pk_mul_f32 v[106:107], v[106:107], v[72:73] op_sel:[0,0] op_sel_hi:[1,0]
  v_pk_mul_f32 v[108:109], v[108:109], v[72:73] op_sel:[0,0] op_sel_hi:[1,0]
  v_pk_mul_f32 v[110:111], v[110:111], v[72:73] op_sel:[0,0] op_sel_hi:[1,0]
  v_cvt_pk_bf16_f32 v12, v104, v105
  v_cvt_pk_bf16_f32 v13, v106, v107
  v_cvt_pk_bf16_f32 v14, v108, v109
  v_cvt_pk_bf16_f32 v15, v110, v111
  ds_write_b128 v49, v[12:15] offset:9216
  s_add_u32 s38, s50, 9216
  s_nop 0
  buffer_store_dwordx4 v[12:15], v52, s[24:27], s38 offen offset:0 sc1
  v_pk_mov_b32 v[104:105], 0, 0
  v_pk_mov_b32 v[106:107], 0, 0
  v_pk_mov_b32 v[108:109], 0, 0
  v_pk_mov_b32 v[110:111], 0, 0
  v_pk_mul_f32 v[128:129], v[128:129], v[72:73] op_sel:[0,1] op_sel_hi:[1,1]
  v_pk_mul_f32 v[130:131], v[130:131], v[72:73] op_sel:[0,1] op_sel_hi:[1,1]
  v_pk_mul_f32 v[132:133], v[132:133], v[72:73] op_sel:[0,1] op_sel_hi:[1,1]
  v_pk_mul_f32 v[134:135], v[134:135], v[72:73] op_sel:[0,1] op_sel_hi:[1,1]
  v_cvt_pk_bf16_f32 v80, v128, v129
  v_cvt_pk_bf16_f32 v81, v130, v131
  v_cvt_pk_bf16_f32 v82, v132, v133
  v_cvt_pk_bf16_f32 v83, v134, v135
  ds_write_b128 v49, v[80:83] offset:1024
  s_add_u32 s38, s50, 0
  s_nop 0
  buffer_store_dwordx4 v[80:83], v52, s[24:27], s38 offen offset:1024 sc1
  v_pk_mov_b32 v[128:129], 0, 0
  v_pk_mov_b32 v[130:131], 0, 0
  v_pk_mov_b32 v[132:133], 0, 0
  v_pk_mov_b32 v[134:135], 0, 0
  v_pk_mul_f32 v[136:137], v[136:137], v[72:73] op_sel:[0,1] op_sel_hi:[1,1]
  v_pk_mul_f32 v[138:139], v[138:139], v[72:73] op_sel:[0,1] op_sel_hi:[1,1]
  v_pk_mul_f32 v[140:141], v[140:141], v[72:73] op_sel:[0,1] op_sel_hi:[1,1]
  v_pk_mul_f32 v[142:143], v[142:143], v[72:73] op_sel:[0,1] op_sel_hi:[1,1]
  v_cvt_pk_bf16_f32 v84, v136, v137
  v_cvt_pk_bf16_f32 v85, v138, v139
  v_cvt_pk_bf16_f32 v86, v140, v141
  v_cvt_pk_bf16_f32 v87, v142, v143
  ds_write_b128 v49, v[84:87] offset:10240
  s_add_u32 s38, s50, 9216
  s_nop 0
  buffer_store_dwordx4 v[84:87], v52, s[24:27], s38 offen offset:1024 sc1
  v_pk_mov_b32 v[136:137], 0, 0
  v_pk_mov_b32 v[138:139], 0, 0
  v_pk_mov_b32 v[140:141], 0, 0
  v_pk_mov_b32 v[142:143], 0, 0
  v_pk_mul_f32 v[160:161], v[160:161], v[74:75] op_sel:[0,0] op_sel_hi:[1,0]
  v_pk_mul_f32 v[162:163], v[162:163], v[74:75] op_sel:[0,0] op_sel_hi:[1,0]
  v_pk_mul_f32 v[164:165], v[164:165], v[74:75] op_sel:[0,0] op_sel_hi:[1,0]
  v_pk_mul_f32 v[166:167], v[166:167], v[74:75] op_sel:[0,0] op_sel_hi:[1,0]
  v_cvt_pk_bf16_f32 v8, v160, v161
  v_cvt_pk_bf16_f32 v9, v162, v163
  v_cvt_pk_bf16_f32 v10, v164, v165
  v_cvt_pk_bf16_f32 v11, v166, v167
  ds_write_b128 v49, v[8:11] offset:2048
  s_add_u32 s38, s50, 0
  s_nop 0
  buffer_store_dwordx4 v[8:11], v52, s[24:27], s38 offen offset:2048 sc1
  v_pk_mov_b32 v[160:161], 0, 0
  v_pk_mov_b32 v[162:163], 0, 0
  v_pk_mov_b32 v[164:165], 0, 0
  v_pk_mov_b32 v[166:167], 0, 0
  v_pk_mul_f32 v[168:169], v[168:169], v[74:75] op_sel:[0,0] op_sel_hi:[1,0]
  v_pk_mul_f32 v[170:171], v[170:171], v[74:75] op_sel:[0,0] op_sel_hi:[1,0]
  v_pk_mul_f32 v[172:173], v[172:173], v[74:75] op_sel:[0,0] op_sel_hi:[1,0]
  v_pk_mul_f32 v[174:175], v[174:175], v[74:75] op_sel:[0,0] op_sel_hi:[1,0]
  v_cvt_pk_bf16_f32 v12, v168, v169
  v_cvt_pk_bf16_f32 v13, v170, v171
  v_cvt_pk_bf16_f32 v14, v172, v173
  v_cvt_pk_bf16_f32 v15, v174, v175
  ds_write_b128 v49, v[12:15] offset:11264
  s_add_u32 s38, s50, 9216
  s_nop 0
  buffer_store_dwordx4 v[12:15], v52, s[24:27], s38 offen offset:2048 sc1
  v_pk_mov_b32 v[168:169], 0, 0
  v_pk_mov_b32 v[170:171], 0, 0
  v_pk_mov_b32 v[172:173], 0, 0
  v_pk_mov_b32 v[174:175], 0, 0
  v_pk_mul_f32 v[192:193], v[192:193], v[74:75] op_sel:[0,1] op_sel_hi:[1,1]
  v_pk_mul_f32 v[194:195], v[194:195], v[74:75] op_sel:[0,1] op_sel_hi:[1,1]
  v_pk_mul_f32 v[196:197], v[196:197], v[74:75] op_sel:[0,1] op_sel_hi:[1,1]
  v_pk_mul_f32 v[198:199], v[198:199], v[74:75] op_sel:[0,1] op_sel_hi:[1,1]
  v_cvt_pk_bf16_f32 v80, v192, v193
  v_cvt_pk_bf16_f32 v81, v194, v195
  v_cvt_pk_bf16_f32 v82, v196, v197
  v_cvt_pk_bf16_f32 v83, v198, v199
  ds_write_b128 v49, v[80:83] offset:3072
  s_add_u32 s38, s50, 0
  s_nop 0
  buffer_store_dwordx4 v[80:83], v52, s[24:27], s38 offen offset:3072 sc1
  v_pk_mul_f32 v[200:201], v[200:201], v[74:75] op_sel:[0,1] op_sel_hi:[1,1]
  v_pk_mul_f32 v[202:203], v[202:203], v[74:75] op_sel:[0,1] op_sel_hi:[1,1]
  v_pk_mul_f32 v[204:205], v[204:205], v[74:75] op_sel:[0,1] op_sel_hi:[1,1]
  v_pk_mul_f32 v[206:207], v[206:207], v[74:75] op_sel:[0,1] op_sel_hi:[1,1]
  v_cvt_pk_bf16_f32 v84, v200, v201
  v_cvt_pk_bf16_f32 v85, v202, v203
  v_cvt_pk_bf16_f32 v86, v204, v205
  v_cvt_pk_bf16_f32 v87, v206, v207
  ds_write_b128 v49, v[84:87] offset:12288
  s_add_u32 s38, s50, 9216
  s_nop 0
  buffer_store_dwordx4 v[84:87], v52, s[24:27], s38 offen offset:3072 sc1
  v_pk_mul_f32 v[112:113], v[112:113], v[72:73] op_sel:[0,0] op_sel_hi:[1,0]
  v_pk_mul_f32 v[114:115], v[114:115], v[72:73] op_sel:[0,0] op_sel_hi:[1,0]
  v_pk_mul_f32 v[116:117], v[116:117], v[72:73] op_sel:[0,0] op_sel_hi:[1,0]
  v_pk_mul_f32 v[118:119], v[118:119], v[72:73] op_sel:[0,0] op_sel_hi:[1,0]
  v_cvt_pk_bf16_f32 v8, v112, v113
  v_cvt_pk_bf16_f32 v9, v114, v115
  v_cvt_pk_bf16_f32 v10, v116, v117
  v_cvt_pk_bf16_f32 v11, v118, v119
  ds_write_b128 v49, v[8:11] offset:36864
  s_add_u32 s38, s50, 18432
  s_nop 0
  buffer_store_dwordx4 v[8:11], v52, s[24:27], s38 offen offset:0 sc1
  v_pk_mov_b32 v[112:113], 0, 0
  v_pk_mov_b32 v[114:115], 0, 0
  v_pk_mov_b32 v[116:117], 0, 0
  v_pk_mov_b32 v[118:119], 0, 0
  v_pk_mul_f32 v[120:121], v[120:121], v[72:73] op_sel:[0,0] op_sel_hi:[1,0]
  v_pk_mul_f32 v[122:123], v[122:123], v[72:73] op_sel:[0,0] op_sel_hi:[1,0]
  v_pk_mul_f32 v[124:125], v[124:125], v[72:73] op_sel:[0,0] op_sel_hi:[1,0]
  v_pk_mul_f32 v[126:127], v[126:127], v[72:73] op_sel:[0,0] op_sel_hi:[1,0]
  v_cvt_pk_bf16_f32 v12, v120, v121
  v_cvt_pk_bf16_f32 v13, v122, v123
  v_cvt_pk_bf16_f32 v14, v124, v125
  v_cvt_pk_bf16_f32 v15, v126, v127
  ds_write_b128 v49, v[12:15] offset:46080
  s_add_u32 s38, s50, 27648
  s_nop 0
  buffer_store_dwordx4 v[12:15], v52, s[24:27], s38 offen offset:0 sc1
  v_pk_mov_b32 v[120:121], 0, 0
  v_pk_mov_b32 v[122:123], 0, 0
  v_pk_mov_b32 v[124:125], 0, 0
  v_pk_mov_b32 v[126:127], 0, 0
  v_pk_mul_f32 v[144:145], v[144:145], v[72:73] op_sel:[0,1] op_sel_hi:[1,1]
  v_pk_mul_f32 v[146:147], v[146:147], v[72:73] op_sel:[0,1] op_sel_hi:[1,1]
  v_pk_mul_f32 v[148:149], v[148:149], v[72:73] op_sel:[0,1] op_sel_hi:[1,1]
  v_pk_mul_f32 v[150:151], v[150:151], v[72:73] op_sel:[0,1] op_sel_hi:[1,1]
  v_cvt_pk_bf16_f32 v80, v144, v145
  v_cvt_pk_bf16_f32 v81, v146, v147
  v_cvt_pk_bf16_f32 v82, v148, v149
  v_cvt_pk_bf16_f32 v83, v150, v151
  ds_write_b128 v49, v[80:83] offset:37888
  s_add_u32 s38, s50, 18432
  s_nop 0
  buffer_store_dwordx4 v[80:83], v52, s[24:27], s38 offen offset:1024 sc1
  v_pk_mov_b32 v[144:145], 0, 0
  v_pk_mov_b32 v[146:147], 0, 0
  v_pk_mov_b32 v[148:149], 0, 0
  v_pk_mov_b32 v[150:151], 0, 0
  v_pk_mul_f32 v[152:153], v[152:153], v[72:73] op_sel:[0,1] op_sel_hi:[1,1]
  v_pk_mul_f32 v[154:155], v[154:155], v[72:73] op_sel:[0,1] op_sel_hi:[1,1]
  v_pk_mul_f32 v[156:157], v[156:157], v[72:73] op_sel:[0,1] op_sel_hi:[1,1]
  v_pk_mul_f32 v[158:159], v[158:159], v[72:73] op_sel:[0,1] op_sel_hi:[1,1]
  v_cvt_pk_bf16_f32 v84, v152, v153
  v_cvt_pk_bf16_f32 v85, v154, v155
  v_cvt_pk_bf16_f32 v86, v156, v157
  v_cvt_pk_bf16_f32 v87, v158, v159
  ds_write_b128 v49, v[84:87] offset:47104
  s_add_u32 s38, s50, 27648
  s_nop 0
  buffer_store_dwordx4 v[84:87], v52, s[24:27], s38 offen offset:1024 sc1
  v_pk_mov_b32 v[152:153], 0, 0
  v_pk_mov_b32 v[154:155], 0, 0
  v_pk_mov_b32 v[156:157], 0, 0
  v_pk_mov_b32 v[158:159], 0, 0
  v_pk_mul_f32 v[176:177], v[176:177], v[74:75] op_sel:[0,0] op_sel_hi:[1,0]
  v_pk_mul_f32 v[178:179], v[178:179], v[74:75] op_sel:[0,0] op_sel_hi:[1,0]
  v_pk_mul_f32 v[180:181], v[180:181], v[74:75] op_sel:[0,0] op_sel_hi:[1,0]
  v_pk_mul_f32 v[182:183], v[182:183], v[74:75] op_sel:[0,0] op_sel_hi:[1,0]
  v_cvt_pk_bf16_f32 v8, v176, v177
  v_cvt_pk_bf16_f32 v9, v178, v179
  v_cvt_pk_bf16_f32 v10, v180, v181
  v_cvt_pk_bf16_f32 v11, v182, v183
  ds_write_b128 v49, v[8:11] offset:38912
  s_add_u32 s38, s50, 18432
  s_nop 0
  buffer_store_dwordx4 v[8:11], v52, s[24:27], s38 offen offset:2048 sc1
  v_pk_mov_b32 v[176:177], 0, 0
  v_pk_mov_b32 v[178:179], 0, 0
  v_pk_mul_f32 v[184:185], v[184:185], v[74:75] op_sel:[0,0] op_sel_hi:[1,0]
  v_pk_mul_f32 v[186:187], v[186:187], v[74:75] op_sel:[0,0] op_sel_hi:[1,0]
  v_pk_mul_f32 v[188:189], v[188:189], v[74:75] op_sel:[0,0] op_sel_hi:[1,0]
  v_pk_mul_f32 v[190:191], v[190:191], v[74:75] op_sel:[0,0] op_sel_hi:[1,0]
  v_cvt_pk_bf16_f32 v12, v184, v185
  v_cvt_pk_bf16_f32 v13, v186, v187
  v_cvt_pk_bf16_f32 v14, v188, v189
  v_cvt_pk_bf16_f32 v15, v190, v191
  ds_write_b128 v49, v[12:15] offset:48128
  s_add_u32 s38, s50, 27648
  s_nop 0
  buffer_store_dwordx4 v[12:15], v52, s[24:27], s38 offen offset:2048 sc1
  v_pk_mul_f32 v[208:209], v[208:209], v[74:75] op_sel:[0,1] op_sel_hi:[1,1]
  v_pk_mul_f32 v[210:211], v[210:211], v[74:75] op_sel:[0,1] op_sel_hi:[1,1]
  v_pk_mul_f32 v[212:213], v[212:213], v[74:75] op_sel:[0,1] op_sel_hi:[1,1]
  v_pk_mul_f32 v[214:215], v[214:215], v[74:75] op_sel:[0,1] op_sel_hi:[1,1]
  v_cvt_pk_bf16_f32 v80, v208, v209
  v_cvt_pk_bf16_f32 v81, v210, v211
  v_cvt_pk_bf16_f32 v82, v212, v213
  v_cvt_pk_bf16_f32 v83, v214, v215
  ds_write_b128 v49, v[80:83] offset:39936
  s_add_u32 s38, s50, 18432
  s_nop 0
  buffer_store_dwordx4 v[80:83], v52, s[24:27], s38 offen offset:3072 sc1
  v_pk_mul_f32 v[216:217], v[216:217], v[74:75] op_sel:[0,1] op_sel_hi:[1,1]
  v_pk_mul_f32 v[218:219], v[218:219], v[74:75] op_sel:[0,1] op_sel_hi:[1,1]
  v_pk_mul_f32 v[220:221], v[220:221], v[74:75] op_sel:[0,1] op_sel_hi:[1,1]
  v_pk_mul_f32 v[222:223], v[222:223], v[74:75] op_sel:[0,1] op_sel_hi:[1,1]
  v_cvt_pk_bf16_f32 v84, v216, v217
  v_cvt_pk_bf16_f32 v85, v218, v219
  v_cvt_pk_bf16_f32 v86, v220, v221
  v_cvt_pk_bf16_f32 v87, v222, v223
  ds_write_b128 v49, v[84:87] offset:49152
  s_add_u32 s38, s50, 27648
  s_nop 0
  buffer_store_dwordx4 v[84:87], v52, s[24:27], s38 offen offset:3072 sc1
  s_mov_b32 s63, 0
  s_mov_b32 s67, 0
  s_mov_b32 s72, 36864
  s_mov_b32 s73, -110592
  s_mov_b32 s74, 36864
  s_mov_b32 s75, 196608
  s_mov_b32 m0, 196608
  s_mov_b32 s76, 1073741824
  s_mov_b32 s62, s77
  v_mov_b32 v1, 163836
  s_lshr_b32 s38, s2, 5
  s_lshl_b32 s38, s38, 3
  s_add_u32 s38, s38, s3
  s_lshl_b32 s38, s38, 8
  s_add_u32 s38, s38, 50331648
  s_add_u32 s80, s82, s38
  s_addc_u32 s81, s83, 0
  s_lshl_b32 s38, s4, 2
  v_mov_b32 v47, s38
  v_mov_b32 v48, s31
  s_mov_b32 s33, 0
  s_mov_b32 s32, 975
  s_cmp_eq_u32 s28, 0
  s_cselect_b32 s53, 8, 0
  s_add_u32 s64, s50, 18432
  s_add_u32 s65, s50, 27648
  s_add_u32 s66, s50, 22528
  s_add_u32 s61, s50, 31744
  s_mov_b32 s35, 7
  s_mov_b64 s[40:41], 0
  s_waitcnt lgkmcnt(0)
  s_waitcnt vmcnt(8)
  s_branch L_gemm
L_tags:
  s_memrealtime s[80:81]
  v_mov_b32 v1, 0
  v_mov_b32 v3, 0
  s_waitcnt lgkmcnt(0)
  s_or_b32 s80, s80, 1
  v_mov_b32 v2, s80
  s_mov_b64 exec, 1
  global_atomic_cmpswap v4, v1, v[2:3], s[6:7] sc0 sc1
  s_waitcnt vmcnt(0)
  s_mov_b64 exec, -1
  v_readfirstlane_b32 s31, v4
  s_nop 1
  s_cmp_eq_u32 s31, 0
  s_cselect_b32 s31, s80, s31
  s_branch L_tagbs
L_w1:
  s_add_u32 s76, s79, 2
  s_and_b32 s76, s76, 15
  s_mul_i32 s76, s76, s52
  s_add_u32 s76, s76, s78
  s_add_u32 s75, s77, 73728
  s_add_u32 m0, s75, 0
  s_nop 0
  buffer_load_dwordx4 v32, s[8:11], s76 offen offset:0  lds
  buffer_load_dwordx4 v33, s[8:11], s76 offen offset:1024  lds
  buffer_load_dwordx4 v34, s[8:11], s76 offen offset:2048  lds
  buffer_load_dwordx4 v35, s[8:11], s76 offen offset:3072  lds
  s_add_u32 m0, s75, 4096
  s_nop 0
  buffer_load_dwordx4 v36, s[8:11], s76 offen offset:0  lds
  buffer_load_dwordx4 v37, s[8:11], s76 offen offset:1024  lds
  buffer_load_dwordx4 v38, s[8:11], s76 offen offset:2048  lds
  buffer_load_dwordx4 v39, s[8:11], s76 offen offset:3072  lds
  s_add_u32 m0, s75, 8192
  s_nop 0
  buffer_load_dwordx4 v40, s[8:11], s76 offen offset:0  lds
  s_add_u32 s76, s79, 3
  s_and_b32 s76, s76, 15
  s_mul_i32 s76, s76, s52
  s_add_u32 s76, s76, s78
  s_add_u32 s75, s77, 110592
  s_add_u32 m0, s75, 0
  s_nop 0
  buffer_load_dwordx4 v32, s[8:11], s76 offen offset:0  lds
  buffer_load_dwordx4 v33, s[8:11], s76 offen offset:1024  lds
  buffer_load_dwordx4 v34, s[8:11], s76 offen offset:2048  lds
  buffer_load_dwordx4 v35, s[8:11], s76 offen offset:3072  lds
  s_add_u32 m0, s75, 4096
  s_nop 0
  buffer_load_dwordx4 v36, s[8:11], s76 offen offset:0  lds
  buffer_load_dwordx4 v37, s[8:11], s76 offen offset:1024  lds
  buffer_load_dwordx4 v38, s[8:11], s76 offen offset:2048  lds
  buffer_load_dwordx4 v39, s[8:11], s76 offen offset:3072  lds
  s_add_u32 m0, s75, 8192
  s_nop 0
  buffer_load_dwordx4 v40, s[8:11], s76 offen offset:0  lds
  s_branch L_wb1
L_redos:
  s_waitcnt vmcnt(0) lgkmcnt(0)
  s_barrier
  v_mov_b32 v6, 163836
  v_mov_b32 v7, 0
  ds_write_b32 v6, v7
  v_and_b32 v60, 0xffff, v60
  v_and_b32 v61, 0xffff, v61
  v_and_b32 v62, 0xffff, v62
  v_and_b32 v63, 0xffff, v63
  v_and_b32 v64, 0xffff, v64
  v_and_b32 v65, 0xffff, v65
  v_and_b32 v66, 0xffff, v66
  v_and_b32 v67, 0xffff, v67
  v_and_b32 v68, 0xffff, v68
  v_and_b32 v69, 0xffff, v69
  v_and_b32 v70, 0xffff, v70
  v_and_b32 v71, 0xffff, v71
  v_mov_b32 v72, 0xff800000
  v_mov_b32 v73, 0xff800000
  v_mov_b32 v74, 0xff800000
  v_mov_b32 v75, 0xff800000
  s_mov_b32 s43, 0
L_r0s:
  s_xor_b32 m0, s44, 0
  s_add_u32 s38, s43, 4096
  s_bitset0_b32 s38, 17
  buffer_load_dwordx4 v56, s[16:19], s43 offen offset:0 nt lds
  buffer_load_dwordx4 v57, s[16:19], s43 offen offset:1024 nt lds
  buffer_load_dwordx4 v56, s[16:19], s43 offen offset:2048 nt lds
  buffer_load_dwordx4 v57, s[16:19], s43 offen offset:3072 nt lds
  s_xor_b32 m0, s44, 4096
  s_nop 0
  buffer_load_dwordx4 v56, s[16:19], s38 offen offset:0 nt lds
  buffer_load_dwordx4 v57, s[16:19], s38 offen offset:1024 nt lds
  buffer_load_dwordx4 v56, s[16:19], s38 offen offset:2048 nt lds
  buffer_load_dwordx4 v57, s[16:19], s38 offen offset:3072 nt lds
  s_waitcnt vmcnt(0)
  s_barrier
  ds_read_b128 a[80:83], v60 offset:0
  ds_read_b128 a[84:87], v61 offset:0
  ds_read_b128 a[88:91], v62 offset:0
  ds_read_b128 a[92:95], v63 offset:0
  ds_read_b128 a[96:99], v60 offset:4096
  ds_read_b128 a[100:103], v61 offset:4096
  ds_read_b128 a[104:107], v62 offset:4096
  ds_read_b128 a[108:111], v63 offset:4096
  s_waitcnt lgkmcnt(0)
  s_barrier
  v_mfma_f32_16x16x32_bf16 v[80:83], a[80:83], a[0:3], 0
  v_mfma_f32_16x16x32_bf16 v[80:83], a[84:87], a[4:7], v[80:83]
  v_mfma_f32_16x16x32_bf16 v[80:83], a[88:91], a[8:11], v[80:83]
  v_mfma_f32_16x16x32_bf16 v[80:83], a[92:95], a[12:15], v[80:83]
  v_mfma_f32_16x16x32_bf16 v[84:87], a[96:99], a[0:3], 0
  v_mfma_f32_16x16x32_bf16 v[84:87], a[100:103], a[4:7], v[84:87]
  v_mfma_f32_16x16x32_bf16 v[84:87], a[104:107], a[8:11], v[84:87]
  v_mfma_f32_16x16x32_bf16 v[84:87], a[108:111], a[12:15], v[84:87]
  s_nop 7
  v_max3_f32 v72, v72, v80, v81
  v_max3_f32 v72, v72, v82, v83
  v_max3_f32 v72, v72, v84, v85
  v_max3_f32 v72, v72, v86, v87
  v_mfma_f32_16x16x32_bf16 v[80:83], a[80:83], a[16:19], 0
  v_mfma_f32_16x16x32_bf16 v[80:83], a[84:87], a[20:23], v[80:83]
  v_mfma_f32_16x16x32_bf16 v[80:83], a[88:91], a[24:27], v[80:83]
  v_mfma_f32_16x16x32_bf16 v[80:83], a[92:95], a[28:31], v[80:83]
  v_mfma_f32_16x16x32_bf16 v[84:87], a[96:99], a[16:19], 0
  v_mfma_f32_16x16x32_bf16 v[84:87], a[100:103], a[20:23], v[84:87]
  v_mfma_f32_16x16x32_bf16 v[84:87], a[104:107], a[24:27], v[84:87]
  v_mfma_f32_16x16x32_bf16 v[84:87], a[108:111], a[28:31], v[84:87]
  s_nop 7
  v_max3_f32 v73, v73, v80, v81
  v_max3_f32 v73, v73, v82, v83
  v_max3_f32 v73, v73, v84, v85
  v_max3_f32 v73, v73, v86, v87
  v_mfma_f32_16x16x32_bf16 v[80:83], a[80:83], a[32:35], 0
  v_mfma_f32_16x16x32_bf16 v[80:83], a[84:87], a[36:39], v[80:83]
  v_mfma_f32_16x16x32_bf16 v[80:83], a[88:91], a[40:43], v[80:83]
  v_mfma_f32_16x16x32_bf16 v[80:83], a[92:95], a[44:47], v[80:83]
  v_mfma_f32_16x16x32_bf16 v[84:87], a[96:99], a[32:35], 0
  v_mfma_f32_16x16x32_bf16 v[84:87], a[100:103], a[36:39], v[84:87]
  v_mfma_f32_16x16x32_bf16 v[84:87], a[104:107], a[40:43], v[84:87]
  v_mfma_f32_16x16x32_bf16 v[84:87], a[108:111], a[44:47], v[84:87]
  s_nop 7
  v_max3_f32 v74, v74, v80, v81
  v_max3_f32 v74, v74, v82, v83
  v_max3_f32 v74, v74, v84, v85
  v_max3_f32 v74, v74, v86, v87
  v_mfma_f32_16x16x32_bf16 v[80:83], a[80:83], a[48:51], 0
  v_mfma_f32_16x16x32_bf16 v[80:83], a[84:87], a[52:55], v[80:83]
  v_mfma_f32_16x16x32_bf16 v[80:83], a[88:91], a[56:59], v[80:83]
  v_mfma_f32_16x16x32_bf16 v[80:83], a[92:95], a[60:63], v[80:83]
  v_mfma_f32_16x16x32_bf16 v[84:87], a[96:99], a[48:51], 0
  v_mfma_f32_16x16x32_bf16 v[84:87], a[100:103], a[52:55], v[84:87]
  v_mfma_f32_16x16x32_bf16 v[84:87], a[104:107], a[56:59], v[84:87]
  v_mfma_f32_16x16x32_bf16 v[84:87], a[108:111], a[60:63], v[84:87]
  s_nop 7
  v_max3_f32 v75, v75, v80, v81
  v_max3_f32 v75, v75, v82, v83
  v_max3_f32 v75, v75, v84, v85
  v_max3_f32 v75, v75, v86, v87
  s_add_u32 s43, s43, 8192
  s_cmp_lt_u32 s43, 131072
  s_cbranch_scc1 L_r0s
  v_mov_b32 v1, v72
  v_mov_b32 v2, v73
  v_mov_b32 v3, v74
  v_mov_b32 v4, v75
  s_nop 1
  v_permlane32_swap_b32 v1, v72
  v_permlane32_swap_b32 v2, v73
  v_permlane32_swap_b32 v3, v74
  v_permlane32_swap_b32 v4, v75
  s_nop 1
  v_max_f32 v72, v72, v1
  v_max_f32 v73, v73, v2
  v_max_f32 v74, v74, v3
  v_max_f32 v75, v75, v4
  v_mov_b32 v1, v72
  v_mov_b32 v2, v73
  v_mov_b32 v3, v74
  v_mov_b32 v4, v75
  s_nop 1
  v_permlane16_swap_b32 v1, v72
  v_permlane16_swap_b32 v2, v73
  v_permlane16_swap_b32 v3, v74
  v_permlane16_swap_b32 v4, v75
  s_nop 1
  v_max_f32 v72, v72, v1
  v_max_f32 v73, v73, v2
  v_max_f32 v74, v74, v3
  v_max_f32 v75, v75, v4
  v_sub_f32 v8, 0, v72
  v_sub_f32 v9, 0, v72
  v_sub_f32 v10, 0, v72
  v_sub_f32 v11, 0, v72
  v_mov_b32 v72, 0
  v_sub_f32 v12, 0, v73
  v_sub_f32 v13, 0, v73
  v_sub_f32 v14, 0, v73
  v_sub_f32 v15, 0, v73
  v_mov_b32 v73, 0
  v_sub_f32 v16, 0, v74
  v_sub_f32 v17, 0, v74
  v_sub_f32 v18, 0, v74
  v_sub_f32 v19, 0, v74
  v_mov_b32 v74, 0
  v_sub_f32 v20, 0, v75
  v_sub_f32 v21, 0, v75
  v_sub_f32 v22, 0, v75
  v_sub_f32 v23, 0, v75
  v_mov_b32 v75, 0
  v_mov_b32 v96, 0
  v_mov_b32 v97, 0
  v_mov_b32 v98, 0
  v_mov_b32 v99, 0
  v_mov_b32 v100, 0
  v_mov_b32 v101, 0
  v_mov_b32 v102, 0
  v_mov_b32 v103, 0
  v_mov_b32 v104, 0
  v_mov_b32 v105, 0
  v_mov_b32 v106, 0
  v_mov_b32 v107, 0
  v_mov_b32 v108, 0
  v_mov_b32 v109, 0
  v_mov_b32 v110, 0
  v_mov_b32 v111, 0
  v_mov_b32 v112, 0
  v_mov_b32 v113, 0
  v_mov_b32 v114, 0
  v_mov_b32 v115, 0
  v_mov_b32 v116, 0
  v_mov_b32 v117, 0
  v_mov_b32 v118, 0
  v_mov_b32 v119, 0
  v_mov_b32 v120, 0
  v_mov_b32 v121, 0
  v_mov_b32 v122, 0
  v_mov_b32 v123, 0
  v_mov_b32 v124, 0
  v_mov_b32 v125, 0
  v_mov_b32 v126, 0
  v_mov_b32 v127, 0
  v_mov_b32 v128, 0
  v_mov_b32 v129, 0
  v_mov_b32 v130, 0
  v_mov_b32 v131, 0
  v_mov_b32 v132, 0
  v_mov_b32 v133, 0
  v_mov_b32 v134, 0
  v_mov_b32 v135, 0
  v_mov_b32 v136, 0
  v_mov_b32 v137, 0
  v_mov_b32 v138, 0
  v_mov_b32 v139, 0
  v_mov_b32 v140, 0
  v_mov_b32 v141, 0
  v_mov_b32 v142, 0
  v_mov_b32 v143, 0
  v_mov_b32 v144, 0
  v_mov_b32 v145, 0
  v_mov_b32 v146, 0
  v_mov_b32 v147, 0
  v_mov_b32 v148, 0
  v_mov_b32 v149, 0
  v_mov_b32 v150, 0
  v_mov_b32 v151, 0
  v_mov_b32 v152, 0
  v_mov_b32 v153, 0
  v_mov_b32 v154, 0
  v_mov_b32 v155, 0
  v_mov_b32 v156, 0
  v_mov_b32 v157, 0
  v_mov_b32 v158, 0
  v_mov_b32 v159, 0
  v_mov_b32 v160, 0
  v_mov_b32 v161, 0
  v_mov_b32 v162, 0
  v_mov_b32 v163, 0
  v_mov_b32 v164, 0
  v_mov_b32 v165, 0
  v_mov_b32 v166, 0
  v_mov_b32 v167, 0
  v_mov_b32 v168, 0
  v_mov_b32 v169, 0
  v_mov_b32 v170, 0
  v_mov_b32 v171, 0
  v_mov_b32 v172, 0
  v_mov_b32 v173, 0
  v_mov_b32 v174, 0
  v_mov_b32 v175, 0
  v_mov_b32 v176, 0
  v_mov_b32 v177, 0
  v_mov_b32 v178, 0
  v_mov_b32 v179, 0
  v_mov_b32 v180, 0
  v_mov_b32 v181, 0
  v_mov_b32 v182, 0
  v_mov_b32 v183, 0
  v_mov_b32 v184, 0
  v_mov_b32 v185, 0
  v_mov_b32 v186, 0
  v_mov_b32 v187, 0
  v_mov_b32 v188, 0
  v_mov_b32 v189, 0
  v_mov_b32 v190, 0
  v_mov_b32 v191, 0
  v_mov_b32 v192, 0
  v_mov_b32 v193, 0
  v_mov_b32 v194, 0
  v_mov_b32 v195, 0
  v_mov_b32 v196, 0
  v_mov_b32 v197, 0
  v_mov_b32 v198, 0
  v_mov_b32 v199, 0
  v_mov_b32 v200, 0
  v_mov_b32 v201, 0
  v_mov_b32 v202, 0
  v_mov_b32 v203, 0
  v_mov_b32 v204, 0
  v_mov_b32 v205, 0
  v_mov_b32 v206, 0
  v_mov_b32 v207, 0
  v_mov_b32 v208, 0
  v_mov_b32 v209, 0
  v_mov_b32 v210, 0
  v_mov_b32 v211, 0
  v_mov_b32 v212, 0
  v_mov_b32 v213, 0
  v_mov_b32 v214, 0
  v_mov_b32 v215, 0
  v_mov_b32 v216, 0
  v_mov_b32 v217, 0
  v_mov_b32 v218, 0
  v_mov_b32 v219, 0
  v_mov_b32 v220, 0
  v_mov_b32 v221, 0
  v_mov_b32 v222, 0
  v_mov_b32 v223, 0
  s_mov_b32 s43, 0
L_r1s:
  s_xor_b32 m0, s44, 0
  s_add_u32 s38, s43, 4096
  s_bitset0_b32 s38, 17
  buffer_load_dwordx4 v56, s[16:19], s43 offen offset:0 nt lds
  buffer_load_dwordx4 v57, s[16:19], s43 offen offset:1024 nt lds
  buffer_load_dwordx4 v56, s[16:19], s43 offen offset:2048 nt lds
  buffer_load_dwordx4 v57, s[16:19], s43 offen offset:3072 nt lds
  s_xor_b32 m0, s44, 4096
  s_nop 0
  buffer_load_dwordx4 v56, s[16:19], s38 offen offset:0 nt lds
  buffer_load_dwordx4 v57, s[16:19], s38 offen offset:1024 nt lds
  buffer_load_dwordx4 v56, s[16:19], s38 offen offset:2048 nt lds
  buffer_load_dwordx4 v57, s[16:19], s38 offen offset:3072 nt lds
  s_xor_b32 m0, s44, 8192
  s_nop 0
  buffer_load_dwordx4 v56, s[20:23], s43 offen offset:0 nt lds
  buffer_load_dwordx4 v57, s[20:23], s43 offen offset:1024 nt lds
  buffer_load_dwordx4 v56, s[20:23], s43 offen offset:2048 nt lds
  buffer_load_dwordx4 v57, s[20:23], s43 offen offset:3072 nt lds
  s_xor_b32 m0, s44, 12288
  s_nop 0
  buffer_load_dwordx4 v56, s[20:23], s38 offen offset:0 nt lds
  buffer_load_dwordx4 v57, s[20:23], s38 offen offset:1024 nt lds
  buffer_load_dwordx4 v56, s[20:23], s38 offen offset:2048 nt lds
  buffer_load_dwordx4 v57, s[20:23], s38 offen offset:3072 nt lds
  s_waitcnt vmcnt(0)
  s_barrier
  ds_read_b128 a[80:83], v60 offset:0
  ds_read_b128 a[84:87], v61 offset:0
  ds_read_b128 a[88:91], v62 offset:0
  ds_read_b128 a[92:95], v63 offset:0
  ds_read_b128 a[96:99], v60 offset:4096
  ds_read_b128 a[100:103], v61 offset:4096
  ds_read_b128 a[104:107], v62 offset:4096
  ds_read_b128 a[108:111], v63 offset:4096
  ds_read_b64_tr_b16 a[144:145], v64 offset:0
  ds_read_b64_tr_b16 a[146:147], v64 offset:4096
  ds_read_b64_tr_b16 a[148:149], v65 offset:0
  ds_read_b64_tr_b16 a[150:151], v65 offset:4096
  ds_read_b64_tr_b16 a[152:153], v66 offset:0
  ds_read_b64_tr_b16 a[154:155], v66 offset:4096
  ds_read_b64_tr_b16 a[156:157], v67 offset:0
  ds_read_b64_tr_b16 a[158:159], v67 offset:4096
  ds_read_b64_tr_b16 a[160:161], v68 offset:0
  ds_read_b64_tr_b16 a[162:163], v68 offset:4096
  ds_read_b64_tr_b16 a[164:165], v69 offset:0
  ds_read_b64_tr_b16 a[166:167], v69 offset:4096
  ds_read_b64_tr_b16 a[168:169], v70 offset:0
  ds_read_b64_tr_b16 a[170:171], v70 offset:4096
  ds_read_b64_tr_b16 a[172:173], v71 offset:0
  ds_read_b64_tr_b16 a[174:175], v71 offset:4096
  s_waitcnt lgkmcnt(0)
  s_barrier
  v_mfma_f32_16x16x32_bf16 v[80:83], a[80:83], a[0:3], v[8:11]
  v_mfma_f32_16x16x32_bf16 v[80:83], a[84:87], a[4:7], v[80:83]
  v_mfma_f32_16x16x32_bf16 v[80:83], a[88:91], a[8:11], v[80:83]
  v_mfma_f32_16x16x32_bf16 v[80:83], a[92:95], a[12:15], v[80:83]
  v_mfma_f32_16x16x32_bf16 v[84:87], a[96:99], a[0:3], v[8:11]
  v_mfma_f32_16x16x32_bf16 v[84:87], a[100:103], a[4:7], v[84:87]
  v_mfma_f32_16x16x32_bf16 v[84:87], a[104:107], a[8:11], v[84:87]
  v_mfma_f32_16x16x32_bf16 v[84:87], a[108:111], a[12:15], v[84:87]
  s_nop 7
  v_exp_f32 v80, v80
  v_exp_f32 v81, v81
  v_exp_f32 v82, v82
  v_exp_f32 v83, v83
  v_exp_f32 v84, v84
  v_exp_f32 v85, v85
  v_exp_f32 v86, v86
  v_exp_f32 v87, v87
  v_add_f32 v72, v72, v80
  v_add_f32 v72, v72, v81
  v_add_f32 v72, v72, v82
  v_add_f32 v72, v72, v83
  v_cvt_pk_bf16_f32 v80, v80, v81
  v_cvt_pk_bf16_f32 v81, v82, v83
  v_cvt_pk_bf16_f32 v82, v84, v85
  v_cvt_pk_bf16_f32 v83, v86, v87
  v_add_f32 v72, v72, v84
  v_add_f32 v72, v72, v85
  v_add_f32 v72, v72, v86
  v_add_f32 v72, v72, v87
  v_mfma_f32_16x16x32_bf16 v[96:99], a[144:147], v[80:83], v[96:99]
  v_mfma_f32_16x16x32_bf16 v[100:103], a[148:151], v[80:83], v[100:103]
  v_mfma_f32_16x16x32_bf16 v[104:107], a[152:155], v[80:83], v[104:107]
  v_mfma_f32_16x16x32_bf16 v[108:111], a[156:159], v[80:83], v[108:111]
  v_mfma_f32_16x16x32_bf16 v[112:115], a[160:163], v[80:83], v[112:115]
  v_mfma_f32_16x16x32_bf16 v[116:119], a[164:167], v[80:83], v[116:119]
  v_mfma_f32_16x16x32_bf16 v[120:123], a[168:171], v[80:83], v[120:123]
  v_mfma_f32_16x16x32_bf16 v[124:127], a[172:175], v[80:83], v[124:127]
  v_mfma_f32_16x16x32_bf16 v[80:83], a[80:83], a[16:19], v[12:15]
  v_mfma_f32_16x16x32_bf16 v[80:83], a[84:87], a[20:23], v[80:83]
  v_mfma_f32_16x16x32_bf16 v[80:83], a[88:91], a[24:27], v[80:83]
  v_mfma_f32_16x16x32_bf16 v[80:83], a[92:95], a[28:31], v[80:83]
  v_mfma_f32_16x16x32_bf16 v[84:87], a[96:99], a[16:19], v[12:15]
  v_mfma_f32_16x16x32_bf16 v[84:87], a[100:103], a[20:23], v[84:87]
  v_mfma_f32_16x16x32_bf16 v[84:87], a[104:107], a[24:27], v[84:87]
  v_mfma_f32_16x16x32_bf16 v[84:87], a[108:111], a[28:31], v[84:87]
  s_nop 7
  v_exp_f32 v80, v80
  v_exp_f32 v81, v81
  v_exp_f32 v82, v82
  v_exp_f32 v83, v83
  v_exp_f32 v84, v84
  v_exp_f32 v85, v85
  v_exp_f32 v86, v86
  v_exp_f32 v87, v87
  v_add_f32 v73, v73, v80
  v_add_f32 v73, v73, v81
  v_add_f32 v73, v73, v82
  v_add_f32 v73, v73, v83
  v_cvt_pk_bf16_f32 v80, v80, v81
  v_cvt_pk_bf16_f32 v81, v82, v83
  v_cvt_pk_bf16_f32 v82, v84, v85
  v_cvt_pk_bf16_f32 v83, v86, v87
  v_add_f32 v73, v73, v84
  v_add_f32 v73, v73, v85
  v_add_f32 v73, v73, v86
  v_add_f32 v73, v73, v87
  v_mfma_f32_16x16x32_bf16 v[128:131], a[144:147], v[80:83], v[128:131]
  v_mfma_f32_16x16x32_bf16 v[132:135], a[148:151], v[80:83], v[132:135]
  v_mfma_f32_16x16x32_bf16 v[136:139], a[152:155], v[80:83], v[136:139]
  v_mfma_f32_16x16x32_bf16 v[140:143], a[156:159], v[80:83], v[140:143]
  v_mfma_f32_16x16x32_bf16 v[144:147], a[160:163], v[80:83], v[144:147]
  v_mfma_f32_16x16x32_bf16 v[148:151], a[164:167], v[80:83], v[148:151]
  v_mfma_f32_16x16x32_bf16 v[152:155], a[168:171], v[80:83], v[152:155]
  v_mfma_f32_16x16x32_bf16 v[156:159], a[172:175], v[80:83], v[156:159]
  v_mfma_f32_16x16x32_bf16 v[80:83], a[80:83], a[32:35], v[16:19]
  v_mfma_f32_16x16x32_bf16 v[80:83], a[84:87], a[36:39], v[80:83]
  v_mfma_f32_16x16x32_bf16 v[80:83], a[88:91], a[40:43], v[80:83]
  v_mfma_f32_16x16x32_bf16 v[80:83], a[92:95], a[44:47], v[80:83]
  v_mfma_f32_16x16x32_bf16 v[84:87], a[96:99], a[32:35], v[16:19]
  v_mfma_f32_16x16x32_bf16 v[84:87], a[100:103], a[36:39], v[84:87]
  v_mfma_f32_16x16x32_bf16 v[84:87], a[104:107], a[40:43], v[84:87]
  v_mfma_f32_16x16x32_bf16 v[84:87], a[108:111], a[44:47], v[84:87]
  s_nop 7
  v_exp_f32 v80, v80
  v_exp_f32 v81, v81
  v_exp_f32 v82, v82
  v_exp_f32 v83, v83
  v_exp_f32 v84, v84
  v_exp_f32 v85, v85
  v_exp_f32 v86, v86
  v_exp_f32 v87, v87
  v_add_f32 v74, v74, v80
  v_add_f32 v74, v74, v81
  v_add_f32 v74, v74, v82
  v_add_f32 v74, v74, v83
  v_cvt_pk_bf16_f32 v80, v80, v81
  v_cvt_pk_bf16_f32 v81, v82, v83
  v_cvt_pk_bf16_f32 v82, v84, v85
  v_cvt_pk_bf16_f32 v83, v86, v87
  v_add_f32 v74, v74, v84
  v_add_f32 v74, v74, v85
  v_add_f32 v74, v74, v86
  v_add_f32 v74, v74, v87
  v_mfma_f32_16x16x32_bf16 v[160:163], a[144:147], v[80:83], v[160:163]
  v_mfma_f32_16x16x32_bf16 v[164:167], a[148:151], v[80:83], v[164:167]
  v_mfma_f32_16x16x32_bf16 v[168:171], a[152:155], v[80:83], v[168:171]
  v_mfma_f32_16x16x32_bf16 v[172:175], a[156:159], v[80:83], v[172:175]
  v_mfma_f32_16x16x32_bf16 v[176:179], a[160:163], v[80:83], v[176:179]
  v_mfma_f32_16x16x32_bf16 v[180:183], a[164:167], v[80:83], v[180:183]
  v_mfma_f32_16x16x32_bf16 v[184:187], a[168:171], v[80:83], v[184:187]
  v_mfma_f32_16x16x32_bf16 v[188:191], a[172:175], v[80:83], v[188:191]
  v_mfma_f32_16x16x32_bf16 v[80:83], a[80:83], a[48:51], v[20:23]
  v_mfma_f32_16x16x32_bf16 v[80:83], a[84:87], a[52:55], v[80:83]
  v_mfma_f32_16x16x32_bf16 v[80:83], a[88:91], a[56:59], v[80:83]
  v_mfma_f32_16x16x32_bf16 v[80:83], a[92:95], a[60:63], v[80:83]
  v_mfma_f32_16x16x32_bf16 v[84:87], a[96:99], a[48:51], v[20:23]
  v_mfma_f32_16x16x32_bf16 v[84:87], a[100:103], a[52:55], v[84:87]
  v_mfma_f32_16x16x32_bf16 v[84:87], a[104:107], a[56:59], v[84:87]
  v_mfma_f32_16x16x32_bf16 v[84:87], a[108:111], a[60:63], v[84:87]
  s_nop 7
  v_exp_f32 v80, v80
  v_exp_f32 v81, v81
  v_exp_f32 v82, v82
  v_exp_f32 v83, v83
  v_exp_f32 v84, v84
  v_exp_f32 v85, v85
  v_exp_f32 v86, v86
  v_exp_f32 v87, v87
  v_add_f32 v75, v75, v80
  v_add_f32 v75, v75, v81
  v_add_f32 v75, v75, v82
  v_add_f32 v75, v75, v83
  v_cvt_pk_bf16_f32 v80, v80, v81
  v_cvt_pk_bf16_f32 v81, v82, v83
  v_cvt_pk_bf16_f32 v82, v84, v85
  v_cvt_pk_bf16_f32 v83, v86, v87
  v_add_f32 v75, v75, v84
  v_add_f32 v75, v75, v85
  v_add_f32 v75, v75, v86
  v_add_f32 v75, v75, v87
  v_mfma_f32_16x16x32_bf16 v[192:195], a[144:147], v[80:83], v[192:195]
  v_mfma_f32_16x16x32_bf16 v[196:199], a[148:151], v[80:83], v[196:199]
  v_mfma_f32_16x16x32_bf16 v[200:203], a[152:155], v[80:83], v[200:203]
  v_mfma_f32_16x16x32_bf16 v[204:207], a[156:159], v[80:83], v[204:207]
  v_mfma_f32_16x16x32_bf16 v[208:211], a[160:163], v[80:83], v[208:211]
  v_mfma_f32_16x16x32_bf16 v[212:215], a[164:167], v[80:83], v[212:215]
  v_mfma_f32_16x16x32_bf16 v[216:219], a[168:171], v[80:83], v[216:219]
  v_mfma_f32_16x16x32_bf16 v[220:223], a[172:175], v[80:83], v[220:223]
  s_add_u32 s43, s43, 8192
  s_cmp_lt_u32 s43, 131072
  s_cbranch_scc1 L_r1s
  s_barrier
  s_add_u32 s76, s79, 0
  s_and_b32 s76, s76, 15
  s_mul_i32 s76, s76, s52
  s_add_u32 s76, s76, s78
  s_add_u32 s75, s77, 0
  s_add_u32 m0, s75, 0
  s_nop 0
  buffer_load_dwordx4 v32, s[8:11], s76 offen offset:0  lds
  buffer_load_dwordx4 v33, s[8:11], s76 offen offset:1024  lds
  buffer_load_dwordx4 v34, s[8:11], s76 offen offset:2048  lds
  buffer_load_dwordx4 v35, s[8:11], s76 offen offset:3072  lds
  s_add_u32 m0, s75, 4096
  s_nop 0
  buffer_load_dwordx4 v36, s[8:11], s76 offen offset:0  lds
  buffer_load_dwordx4 v37, s[8:11], s76 offen offset:1024  lds
  buffer_load_dwordx4 v38, s[8:11], s76 offen offset:2048  lds
  buffer_load_dwordx4 v39, s[8:11], s76 offen offset:3072  lds
  s_add_u32 m0, s75, 8192
  s_nop 0
  buffer_load_dwordx4 v40, s[8:11], s76 offen offset:0  lds
  s_add_u32 s76, s79, 1
  s_and_b32 s76, s76, 15
  s_mul_i32 s76, s76, s52
  s_add_u32 s76, s76, s78
  s_add_u32 s75, s77, 36864
  s_add_u32 m0, s75, 0
  s_nop 0
  buffer_load_dwordx4 v32, s[8:11], s76 offen offset:0  lds
  buffer_load_dwordx4 v33, s[8:11], s76 offen offset:1024  lds
  buffer_load_dwordx4 v34, s[8:11], s76 offen offset:2048  lds
  buffer_load_dwordx4 v35, s[8:11], s76 offen offset:3072  lds
  s_add_u32 m0, s75, 4096
  s_nop 0
  buffer_load_dwordx4 v36, s[8:11], s76 offen offset:0  lds
  buffer_load_dwordx4 v37, s[8:11], s76 offen offset:1024  lds
  buffer_load_dwordx4 v38, s[8:11], s76 offen offset:2048  lds
  buffer_load_dwordx4 v39, s[8:11], s76 offen offset:3072  lds
  s_add_u32 m0, s75, 8192
  s_nop 0
  buffer_load_dwordx4 v40, s[8:11], s76 offen offset:0  lds
  s_add_u32 s76, s79, 2
  s_and_b32 s76, s76, 15
  s_mul_i32 s76, s76, s52
  s_add_u32 s76, s76, s78
  s_add_u32 s75, s77, 73728
  s_add_u32 m0, s75, 0
  s_nop 0
  buffer_load_dwordx4 v32, s[8:11], s76 offen offset:0  lds
  buffer_load_dwordx4 v33, s[8:11], s76 offen offset:1024  lds
  buffer_load_dwordx4 v34, s[8:11], s76 offen offset:2048  lds
  buffer_load_dwordx4 v35, s[8:11], s76 offen offset:3072  lds
  s_add_u32 m0, s75, 4096
  s_nop 0
  buffer_load_dwordx4 v36, s[8:11], s76 offen offset:0  lds
  buffer_load_dwordx4 v37, s[8:11], s76 offen offset:1024  lds
  buffer_load_dwordx4 v38, s[8:11], s76 offen offset:2048  lds
  buffer_load_dwordx4 v39, s[8:11], s76 offen offset:3072  lds
  s_add_u32 m0, s75, 8192
  s_nop 0
  buffer_load_dwordx4 v40, s[8:11], s76 offen offset:0  lds
  s_add_u32 s76, s79, 3
  s_and_b32 s76, s76, 15
  s_mul_i32 s76, s76, s52
  s_add_u32 s76, s76, s78
  s_add_u32 s75, s77, 110592
  s_add_u32 m0, s75, 0
  s_nop 0
  buffer_load_dwordx4 v32, s[8:11], s76 offen offset:0  lds
  buffer_load_dwordx4 v33, s[8:11], s76 offen offset:1024  lds
  buffer_load_dwordx4 v34, s[8:11], s76 offen offset:2048  lds
  buffer_load_dwordx4 v35, s[8:11], s76 offen offset:3072  lds
  s_add_u32 m0, s75, 4096
  s_nop 0
  buffer_load_dwordx4 v36, s[8:11], s76 offen offset:0  lds
  buffer_load_dwordx4 v37, s[8:11], s76 offen offset:1024  lds
  buffer_load_dwordx4 v38, s[8:11], s76 offen offset:2048  lds
  buffer_load_dwordx4 v39, s[8:11], s76 offen offset:3072  lds
  s_add_u32 m0, s75, 8192
  s_nop 0
  buffer_load_dwordx4 v40, s[8:11], s76 offen offset:0  lds
  v_mov_b32 v1, v72
  v_mov_b32 v2, v73
  v_mov_b32 v3, v74
  v_mov_b32 v4, v75
  s_nop 1
  v_permlane32_swap_b32 v1, v72
  v_permlane32_swap_b32 v2, v73
  v_permlane32_swap_b32 v3, v74
  v_permlane32_swap_b32 v4, v75
  s_nop 1
  v_add_f32 v72, v72, v1
  v_add_f32 v73, v73, v2
  v_add_f32 v74, v74, v3
  v_add_f32 v75, v75, v4
  v_mov_b32 v1, v72
  v_mov_b32 v2, v73
  v_mov_b32 v3, v74
  v_mov_b32 v4, v75
  s_nop 1
  v_permlane16_swap_b32 v1, v72
  v_permlane16_swap_b32 v2, v73
  v_permlane16_swap_b32 v3, v74
  v_permlane16_swap_b32 v4, v75
  s_nop 1
  v_add_f32 v72, v72, v1
  v_add_f32 v73, v73, v2
  v_add_f32 v74, v74, v3
  v_add_f32 v75, v75, v4
  s_mov_b32 s34, 1
  s_branch L_es
L_gemm:
  s_barrier
  ds_read_b32 v2, v1
  ds_read_b64_tr_b16 a[80:81], v45 offset:0
  ds_read_b64_tr_b16 a[82:83], v45 offset:4608
  ds_read_b64_tr_b16 a[84:85], v45 offset:32
  ds_read_b64_tr_b16 a[86:87], v45 offset:4640
  ds_read_b64_tr_b16 a[88:89], v46 offset:0
  ds_read_b64_tr_b16 a[90:91], v46 offset:4608
  ds_read_b128 a[104:107], v41 offset:0
  ds_read_b128 a[108:111], v41 offset:1024
  ds_read_b128 a[112:115], v41 offset:2048
  ds_read_b128 a[116:119], v42 offset:0
  ds_read_b128 a[120:123], v42 offset:1024
  ds_read_b128 a[124:127], v43 offset:0
  s_waitcnt lgkmcnt(12)
  v_readfirstlane_b32 s38, v2
  ds_read_b128 a[128:131], v43 offset:1024
  ds_read_b128 a[132:135], v44 offset:0
  ds_read_b128 a[136:139], v44 offset:1024
  s_andn2_b32 s38, s38, s34
  s_cbranch_scc1 L_redo
  s_mov_b32 s46, s31
  s_mov_b32 s47, s31
  s_bitcmp1_b32 s28, 0
  s_cbranch_scc1 L_gsw
  s_lshr_b32 exec_lo, s53, 3
  s_mov_b32 exec_hi, 0
  global_store_dword v47, v48, s[80:81] sc1
  s_mov_b64 exec, -1
L_gso:
  s_waitcnt lgkmcnt(6)
  v_mfma_f32_16x16x32_bf16 v[96:99], a[80:83], a[104:107], v[96:99]
  s_nop 0
  ds_read_b64_tr_b16 a[92:93], v45 offset:9216
  ds_read_b64_tr_b16 a[94:95], v45 offset:13824
  v_mfma_f32_16x16x32_bf16 v[132:135], a[84:87], a[104:107], v[132:135]
  s_nop 0
  ds_read_b64_tr_b16 a[96:97], v45 offset:9248
  ds_read_b64_tr_b16 a[98:99], v45 offset:13856
  v_mfma_f32_16x16x32_bf16 v[168:171], a[88:91], a[104:107], v[168:171]
  s_nop 0
  ds_read_b64_tr_b16 a[100:101], v46 offset:9216
  ds_read_b64_tr_b16 a[102:103], v46 offset:13824
  v_mfma_f32_16x16x32_bf16 v[100:103], a[80:83], a[108:111], v[100:103]
  ds_read_b128 a[140:143], v41 offset:9216
  v_add_u32 v45, s74, v45
  v_mfma_f32_16x16x32_bf16 v[136:139], a[84:87], a[108:111], v[136:139]
  v_add_u32 v46, s74, v46
  v_mfma_f32_16x16x32_bf16 v[172:175], a[88:91], a[108:111], v[172:175]
  ds_read_b128 a[144:147], v41 offset:10240
  v_mfma_f32_16x16x32_bf16 v[104:107], a[80:83], a[112:115], v[104:107]
  s_waitcnt lgkmcnt(8)
  ds_read_b128 a[148:151], v41 offset:11264
  v_add_u32 v41, s74, v41
  v_mfma_f32_16x16x32_bf16 v[140:143], a[84:87], a[112:115], v[140:143]
  v_mfma_f32_16x16x32_bf16 v[108:111], a[80:83], a[116:119], v[108:111]
  ds_read_b128 a[152:155], v42 offset:9216
  v_mfma_f32_16x16x32_bf16 v[144:147], a[84:87], a[116:119], v[144:147]
  ds_read_b128 a[156:159], v42 offset:10240
  v_add_u32 v42, s74, v42
  v_mfma_f32_16x16x32_bf16 v[112:115], a[80:83], a[120:123], v[112:115]
  v_mfma_f32_16x16x32_bf16 v[148:151], a[84:87], a[120:123], v[148:151]
  ds_read_b128 a[160:163], v43 offset:9216
  v_mfma_f32_16x16x32_bf16 v[116:119], a[80:83], a[124:127], v[116:119]
  ds_read_b128 a[164:167], v43 offset:10240
  v_add_u32 v43, s74, v43
  v_mfma_f32_16x16x32_bf16 v[152:155], a[84:87], a[124:127], v[152:155]
  v_mfma_f32_16x16x32_bf16 v[120:123], a[80:83], a[128:131], v[120:123]
  ds_read_b128 a[168:171], v44 offset:9216
  v_mfma_f32_16x16x32_bf16 v[156:159], a[84:87], a[128:131], v[156:159]
  ds_read_b128 a[172:175], v44 offset:10240
  v_add_u32 v44, s74, v44
  v_mfma_f32_16x16x32_bf16 v[124:127], a[80:83], a[132:135], v[124:127]
  v_mfma_f32_16x16x32_bf16 v[160:163], a[84:87], a[132:135], v[160:163]
  v_mfma_f32_16x16x32_bf16 v[128:131], a[80:83], a[136:139], v[128:131]
  v_mfma_f32_16x16x32_bf16 v[164:167], a[84:87], a[136:139], v[164:167]
  s_waitcnt lgkmcnt(6)
  v_mfma_f32_16x16x32_bf16 v[96:99], a[92:95], a[140:143], v[96:99]
  s_and_b32 s60, s36, 15
  s_lshr_b64 s[36:37], s[36:37], 4
  s_add_u32 s60, s60, s79
  v_mfma_f32_16x16x32_bf16 v[132:135], a[96:99], a[140:143], v[132:135]
  s_and_b32 s60, s60, 15
  s_mul_i32 s60, s60, s52
  s_add_u32 s60, s60, s78
  v_mfma_f32_16x16x32_bf16 v[168:171], a[100:103], a[140:143], v[168:171]
  s_cmp_ge_u32 s63, 12
  s_cselect_b32 s75, 196608, s62
  s_cselect_b32 s76, 1073741824, s60
  v_mfma_f32_16x16x32_bf16 v[100:103], a[92:95], a[144:147], v[100:103]
  s_add_u32 s62, s62, s74
  s_add_u32 s67, s67, 1
  s_and_b32 s67, s67, 3
  v_mfma_f32_16x16x32_bf16 v[136:139], a[96:99], a[144:147], v[136:139]
  s_cmp_eq_u32 s67, 3
  s_cselect_b32 s74, s73, s72
  v_mfma_f32_16x16x32_bf16 v[172:175], a[100:103], a[144:147], v[172:175]
  s_waitcnt lgkmcnt(0)
  s_barrier
  v_mfma_f32_16x16x32_bf16 v[104:107], a[92:95], a[148:151], v[104:107]
  s_nop 0
  ds_read_b64_tr_b16 a[80:81], v45 offset:0
  ds_read_b64_tr_b16 a[82:83], v45 offset:4608
  v_mfma_f32_16x16x32_bf16 v[140:143], a[96:99], a[148:151], v[140:143]
  s_nop 0
  ds_read_b64_tr_b16 a[84:85], v45 offset:32
  ds_read_b64_tr_b16 a[86:87], v45 offset:4640
  v_mfma_f32_16x16x32_bf16 v[108:111], a[92:95], a[152:155], v[108:111]
  s_nop 0
  ds_read_b64_tr_b16 a[88:89], v46 offset:0
  ds_read_b64_tr_b16 a[90:91], v46 offset:4608
  v_mfma_f32_16x16x32_bf16 v[144:147], a[96:99], a[152:155], v[144:147]
  ds_read_b128 a[104:107], v41 offset:0
  v_mfma_f32_16x16x32_bf16 v[112:115], a[92:95], a[156:159], v[112:115]
  ds_read_b128 a[108:111], v41 offset:1024
  v_mfma_f32_16x16x32_bf16 v[148:151], a[96:99], a[156:159], v[148:151]
  ds_read_b128 a[112:115], v41 offset:2048
  v_mfma_f32_16x16x32_bf16 v[116:119], a[92:95], a[160:163], v[116:119]
  v_mfma_f32_16x16x32_bf16 v[152:155], a[96:99], a[160:163], v[152:155]
  s_add_u32 s63, s63, 1
  ds_read_b128 a[116:119], v42 offset:0
  v_mfma_f32_16x16x32_bf16 v[120:123], a[92:95], a[164:167], v[120:123]
  ds_read_b128 a[120:123], v42 offset:1024
  v_mfma_f32_16x16x32_bf16 v[156:159], a[96:99], a[164:167], v[156:159]
  v_mfma_f32_16x16x32_bf16 v[124:127], a[92:95], a[168:171], v[124:127]
  ds_read_b128 a[124:127], v43 offset:0
  v_mfma_f32_16x16x32_bf16 v[160:163], a[96:99], a[168:171], v[160:163]
  ds_read_b128 a[128:131], v43 offset:1024
  v_mfma_f32_16x16x32_bf16 v[128:131], a[92:95], a[172:175], v[128:131]
  v_mfma_f32_16x16x32_bf16 v[164:167], a[96:99], a[172:175], v[164:167]
  s_nop 0
  ds_read_b128 a[132:135], v44 offset:0
  ds_read_b128 a[136:139], v44 offset:1024
  s_waitcnt lgkmcnt(6)
  v_mfma_f32_16x16x32_bf16 v[96:99], a[80:83], a[104:107], v[96:99]
  s_nop 0
  ds_read_b64_tr_b16 a[92:93], v45 offset:9216
  ds_read_b64_tr_b16 a[94:95], v45 offset:13824
  v_mfma_f32_16x16x32_bf16 v[132:135], a[84:87], a[104:107], v[132:135]
  s_nop 0
  ds_read_b64_tr_b16 a[96:97], v45 offset:9248
  ds_read_b64_tr_b16 a[98:99], v45 offset:13856
  v_mfma_f32_16x16x32_bf16 v[168:171], a[88:91], a[104:107], v[168:171]
  s_nop 0
  ds_read_b64_tr_b16 a[100:101], v46 offset:9216
  ds_read_b64_tr_b16 a[102:103], v46 offset:13824
  v_mfma_f32_16x16x32_bf16 v[100:103], a[80:83], a[108:111], v[100:103]
  ds_read_b128 a[140:143], v41 offset:9216
  v_add_u32 v45, s74, v45
  v_mfma_f32_16x16x32_bf16 v[136:139], a[84:87], a[108:111], v[136:139]
  v_add_u32 v46, s74, v46
  v_mfma_f32_16x16x32_bf16 v[172:175], a[88:91], a[108:111], v[172:175]
  ds_read_b128 a[144:147], v41 offset:10240
  v_mfma_f32_16x16x32_bf16 v[104:107], a[80:83], a[112:115], v[104:107]
  s_waitcnt lgkmcnt(8)
  ds_read_b128 a[148:151], v41 offset:11264
  v_add_u32 v41, s74, v41
  v_mfma_f32_16x16x32_bf16 v[140:143], a[84:87], a[112:115], v[140:143]
  v_mfma_f32_16x16x32_bf16 v[108:111], a[80:83], a[116:119], v[108:111]
  ds_read_b128 a[152:155], v42 offset:9216
  v_mfma_f32_16x16x32_bf16 v[144:147], a[84:87], a[116:119], v[144:147]
  ds_read_b128 a[156:159], v42 offset:10240
  v_add_u32 v42, s74, v42
  v_mfma_f32_16x16x32_bf16 v[112:115], a[80:83], a[120:123], v[112:115]
  v_mfma_f32_16x16x32_bf16 v[148:151], a[84:87], a[120:123], v[148:151]
  ds_read_b128 a[160:163], v43 offset:9216
  v_mfma_f32_16x16x32_bf16 v[116:119], a[80:83], a[124:127], v[116:119]
  ds_read_b128 a[164:167], v43 offset:10240
  v_add_u32 v43, s74, v43
  v_mfma_f32_16x16x32_bf16 v[152:155], a[84:87], a[124:127], v[152:155]
  v_mfma_f32_16x16x32_bf16 v[120:123], a[80:83], a[128:131], v[120:123]
  ds_read_b128 a[168:171], v44 offset:9216
  v_mfma_f32_16x16x32_bf16 v[156:159], a[84:87], a[128:131], v[156:159]
  ds_read_b128 a[172:175], v44 offset:10240
  v_add_u32 v44, s74, v44
  v_mfma_f32_16x16x32_bf16 v[124:127], a[80:83], a[132:135], v[124:127]
  v_mfma_f32_16x16x32_bf16 v[160:163], a[84:87], a[132:135], v[160:163]
  v_mfma_f32_16x16x32_bf16 v[128:131], a[80:83], a[136:139], v[128:131]
  v_mfma_f32_16x16x32_bf16 v[164:167], a[84:87], a[136:139], v[164:167]
  s_waitcnt lgkmcnt(6)
  v_mfma_f32_16x16x32_bf16 v[96:99], a[92:95], a[140:143], v[96:99]
  s_and_b32 s60, s36, 15
  s_lshr_b64 s[36:37], s[36:37], 4
  s_add_u32 s60, s60, s79
  v_mfma_f32_16x16x32_bf16 v[132:135], a[96:99], a[140:143], v[132:135]
  s_and_b32 s60, s60, 15
  s_mul_i32 s60, s60, s52
  s_add_u32 s60, s60, s78
  v_mfma_f32_16x16x32_bf16 v[168:171], a[100:103], a[140:143], v[168:171]
  s_cmp_ge_u32 s63, 12
  s_cselect_b32 s75, 196608, s62
  s_cselect_b32 s76, 1073741824, s60
  v_mfma_f32_16x16x32_bf16 v[100:103], a[92:95], a[144:147], v[100:103]
  s_add_u32 s62, s62, s74
  s_add_u32 s67, s67, 1
  s_and_b32 s67, s67, 3
  v_mfma_f32_16x16x32_bf16 v[136:139], a[96:99], a[144:147], v[136:139]
  s_cmp_eq_u32 s67, 3
  s_cselect_b32 s74, s73, s72
  v_mfma_f32_16x16x32_bf16 v[172:175], a[100:103], a[144:147], v[172:175]
  s_waitcnt lgkmcnt(0)
  s_barrier
  s_load_dwordx4 s[40:43], s[80:81], s33 glc
  v_mfma_f32_16x16x32_bf16 v[104:107], a[92:95], a[148:151], v[104:107]
  s_nop 0
  ds_read_b64_tr_b16 a[80:81], v45 offset:0
  ds_read_b64_tr_b16 a[82:83], v45 offset:4608
  v_mfma_f32_16x16x32_bf16 v[140:143], a[96:99], a[148:151], v[140:143]
  s_nop 0
  ds_read_b64_tr_b16 a[84:85], v45 offset:32
  ds_read_b64_tr_b16 a[86:87], v45 offset:4640
  v_mfma_f32_16x16x32_bf16 v[108:111], a[92:95], a[152:155], v[108:111]
  s_nop 0
  ds_read_b64_tr_b16 a[88:89], v46 offset:0
  ds_read_b64_tr_b16 a[90:91], v46 offset:4608
  v_mfma_f32_16x16x32_bf16 v[144:147], a[96:99], a[152:155], v[144:147]
  ds_read_b128 a[104:107], v41 offset:0
  v_mfma_f32_16x16x32_bf16 v[112:115], a[92:95], a[156:159], v[112:115]
  ds_read_b128 a[108:111], v41 offset:1024
  v_mfma_f32_16x16x32_bf16 v[148:151], a[96:99], a[156:159], v[148:151]
  ds_read_b128 a[112:115], v41 offset:2048
  v_mfma_f32_16x16x32_bf16 v[116:119], a[92:95], a[160:163], v[116:119]
  v_mfma_f32_16x16x32_bf16 v[152:155], a[96:99], a[160:163], v[152:155]
  s_add_u32 s63, s63, 1
  ds_read_b128 a[116:119], v42 offset:0
  v_mfma_f32_16x16x32_bf16 v[120:123], a[92:95], a[164:167], v[120:123]
  ds_read_b128 a[120:123], v42 offset:1024
  v_mfma_f32_16x16x32_bf16 v[156:159], a[96:99], a[164:167], v[156:159]
  v_mfma_f32_16x16x32_bf16 v[124:127], a[92:95], a[168:171], v[124:127]
  ds_read_b128 a[124:127], v43 offset:0
  v_mfma_f32_16x16x32_bf16 v[160:163], a[96:99], a[168:171], v[160:163]
  ds_read_b128 a[128:131], v43 offset:1024
  v_mfma_f32_16x16x32_bf16 v[128:131], a[92:95], a[172:175], v[128:131]
  v_mfma_f32_16x16x32_bf16 v[164:167], a[96:99], a[172:175], v[164:167]
  s_nop 0
  ds_read_b128 a[132:135], v44 offset:0
  ds_read_b128 a[136:139], v44 offset:1024
  s_waitcnt lgkmcnt(6)
  v_mfma_f32_16x16x32_bf16 v[96:99], a[80:83], a[104:107], v[96:99]
  s_nop 0
  ds_read_b64_tr_b16 a[92:93], v45 offset:9216
  ds_read_b64_tr_b16 a[94:95], v45 offset:13824
  v_mfma_f32_16x16x32_bf16 v[132:135], a[84:87], a[104:107], v[132:135]
  s_nop 0
  ds_read_b64_tr_b16 a[96:97], v45 offset:9248
  ds_read_b64_tr_b16 a[98:99], v45 offset:13856
  v_mfma_f32_16x16x32_bf16 v[168:171], a[88:91], a[104:107], v[168:171]
  s_nop 0
  ds_read_b64_tr_b16 a[100:101], v46 offset:9216
  ds_read_b64_tr_b16 a[102:103], v46 offset:13824
  v_mfma_f32_16x16x32_bf16 v[100:103], a[80:83], a[108:111], v[100:103]
  ds_read_b128 a[140:143], v41 offset:9216
  v_add_u32 v45, s74, v45
  v_mfma_f32_16x16x32_bf16 v[136:139], a[84:87], a[108:111], v[136:139]
  v_add_u32 v46, s74, v46
  v_mfma_f32_16x16x32_bf16 v[172:175], a[88:91], a[108:111], v[172:175]
  ds_read_b128 a[144:147], v41 offset:10240
  v_mfma_f32_16x16x32_bf16 v[104:107], a[80:83], a[112:115], v[104:107]
  s_waitcnt lgkmcnt(8)
  ds_read_b128 a[148:151], v41 offset:11264
  v_add_u32 v41, s74, v41
  v_mfma_f32_16x16x32_bf16 v[140:143], a[84:87], a[112:115], v[140:143]
  v_mfma_f32_16x16x32_bf16 v[108:111], a[80:83], a[116:119], v[108:111]
  ds_read_b128 a[152:155], v42 offset:9216
  v_mfma_f32_16x16x32_bf16 v[144:147], a[84:87], a[116:119], v[144:147]
  ds_read_b128 a[156:159], v42 offset:10240
  v_add_u32 v42, s74, v42
  v_mfma_f32_16x16x32_bf16 v[112:115], a[80:83], a[120:123], v[112:115]
  v_mfma_f32_16x16x32_bf16 v[148:151], a[84:87], a[120:123], v[148:151]
  ds_read_b128 a[160:163], v43 offset:9216
  v_mfma_f32_16x16x32_bf16 v[116:119], a[80:83], a[124:127], v[116:119]
  ds_read_b128 a[164:167], v43 offset:10240
  v_add_u32 v43, s74, v43
  v_mfma_f32_16x16x32_bf16 v[152:155], a[84:87], a[124:127], v[152:155]
  v_mfma_f32_16x16x32_bf16 v[120:123], a[80:83], a[128:131], v[120:123]
  ds_read_b128 a[168:171], v44 offset:9216
  v_mfma_f32_16x16x32_bf16 v[156:159], a[84:87], a[128:131], v[156:159]
  ds_read_b128 a[172:175], v44 offset:10240
  v_add_u32 v44, s74, v44
  v_mfma_f32_16x16x32_bf16 v[124:127], a[80:83], a[132:135], v[124:127]
  v_mfma_f32_16x16x32_bf16 v[160:163], a[84:87], a[132:135], v[160:163]
  v_mfma_f32_16x16x32_bf16 v[128:131], a[80:83], a[136:139], v[128:131]
  v_mfma_f32_16x16x32_bf16 v[164:167], a[84:87], a[136:139], v[164:167]
  s_waitcnt lgkmcnt(6)
  v_mfma_f32_16x16x32_bf16 v[96:99], a[92:95], a[140:143], v[96:99]
  s_and_b32 s60, s36, 15
  s_lshr_b64 s[36:37], s[36:37], 4
  s_add_u32 s60, s60, s79
  v_mfma_f32_16x16x32_bf16 v[132:135], a[96:99], a[140:143], v[132:135]
  s_and_b32 s60, s60, 15
  s_mul_i32 s60, s60, s52
  s_add_u32 s60, s60, s78
  v_mfma_f32_16x16x32_bf16 v[168:171], a[100:103], a[140:143], v[168:171]
  s_cmp_ge_u32 s63, 12
  s_cselect_b32 s75, 196608, s62
  s_cselect_b32 s76, 1073741824, s60
  v_mfma_f32_16x16x32_bf16 v[100:103], a[92:95], a[144:147], v[100:103]
  s_add_u32 s62, s62, s74
  s_add_u32 s67, s67, 1
  s_and_b32 s67, s67, 3
  v_mfma_f32_16x16x32_bf16 v[136:139], a[96:99], a[144:147], v[136:139]
  s_cmp_eq_u32 s67, 3
  s_cselect_b32 s74, s73, s72
  v_mfma_f32_16x16x32_bf16 v[172:175], a[100:103], a[144:147], v[172:175]
  s_call_b64 s[54:55], L_ho
  v_mfma_f32_16x16x32_bf16 v[104:107], a[92:95], a[148:151], v[104:107]
  s_add_u32 m0, s75, 0
  ds_read_b64_tr_b16 a[80:81], v45 offset:0
  ds_read_b64_tr_b16 a[82:83], v45 offset:4608
  v_mfma_f32_16x16x32_bf16 v[140:143], a[96:99], a[148:151], v[140:143]
  s_nop 0
  ds_read_b64_tr_b16 a[84:85], v45 offset:32
  ds_read_b64_tr_b16 a[86:87], v45 offset:4640
  v_mfma_f32_16x16x32_bf16 v[108:111], a[92:95], a[152:155], v[108:111]
  s_nop 0
  ds_read_b64_tr_b16 a[88:89], v46 offset:0
  ds_read_b64_tr_b16 a[90:91], v46 offset:4608
  v_mfma_f32_16x16x32_bf16 v[144:147], a[96:99], a[152:155], v[144:147]
  ds_read_b128 a[104:107], v41 offset:0
  v_mfma_f32_16x16x32_bf16 v[112:115], a[92:95], a[156:159], v[112:115]
  ds_read_b128 a[108:111], v41 offset:1024
  v_mfma_f32_16x16x32_bf16 v[148:151], a[96:99], a[156:159], v[148:151]
  ds_read_b128 a[112:115], v41 offset:2048
  v_mfma_f32_16x16x32_bf16 v[116:119], a[92:95], a[160:163], v[116:119]
  buffer_load_dwordx4 v32, s[8:11], s76 offen offset:0 sc1 lds
  v_mfma_f32_16x16x32_bf16 v[152:155], a[96:99], a[160:163], v[152:155]
  s_add_u32 s63, s63, 1
  ds_read_b128 a[116:119], v42 offset:0
  v_mfma_f32_16x16x32_bf16 v[120:123], a[92:95], a[164:167], v[120:123]
  ds_read_b128 a[120:123], v42 offset:1024
  v_mfma_f32_16x16x32_bf16 v[156:159], a[96:99], a[164:167], v[156:159]
  buffer_load_dwordx4 v33, s[8:11], s76 offen offset:1024 sc1 lds
  v_mfma_f32_16x16x32_bf16 v[124:127], a[92:95], a[168:171], v[124:127]
  ds_read_b128 a[124:127], v43 offset:0
  v_mfma_f32_16x16x32_bf16 v[160:163], a[96:99], a[168:171], v[160:163]
  ds_read_b128 a[128:131], v43 offset:1024
  v_mfma_f32_16x16x32_bf16 v[128:131], a[92:95], a[172:175], v[128:131]
  buffer_load_dwordx4 v34, s[8:11], s76 offen offset:2048 sc1 lds
  v_mfma_f32_16x16x32_bf16 v[164:167], a[96:99], a[172:175], v[164:167]
  s_nop 0
  ds_read_b128 a[132:135], v44 offset:0
  ds_read_b128 a[136:139], v44 offset:1024
  s_getpc_b64 s[54:55]
L_gp:
  s_add_u32 s54, s54, L_hco-L_gp
  s_addc_u32 s55, s55, 0
L_go:
  s_waitcnt lgkmcnt(6)
  v_mfma_f32_16x16x32_bf16 v[96:99], a[80:83], a[104:107], v[96:99]
  s_nop 0
  ds_read_b64_tr_b16 a[92:93], v45 offset:9216
  ds_read_b64_tr_b16 a[94:95], v45 offset:13824
  v_mfma_f32_16x16x32_bf16 v[132:135], a[84:87], a[104:107], v[132:135]
  s_nop 0
  ds_read_b64_tr_b16 a[96:97], v45 offset:9248
  ds_read_b64_tr_b16 a[98:99], v45 offset:13856
  v_mfma_f32_16x16x32_bf16 v[168:171], a[88:91], a[104:107], v[168:171]
  s_nop 0
  ds_read_b64_tr_b16 a[100:101], v46 offset:9216
  ds_read_b64_tr_b16 a[102:103], v46 offset:13824
  v_mfma_f32_16x16x32_bf16 v[100:103], a[80:83], a[108:111], v[100:103]
  ds_read_b128 a[140:143], v41 offset:9216
  v_add_u32 v45, s74, v45
  v_mfma_f32_16x16x32_bf16 v[136:139], a[84:87], a[108:111], v[136:139]
  buffer_load_dwordx4 v35, s[8:11], s76 offen offset:3072 sc1 lds
  v_mfma_f32_16x16x32_bf16 v[172:175], a[88:91], a[108:111], v[172:175]
  s_add_u32 m0, s75, 4096
  ds_read_b128 a[144:147], v41 offset:10240
  v_add_u32 v46, s74, v46
  v_mfma_f32_16x16x32_bf16 v[104:107], a[80:83], a[112:115], v[104:107]
  s_waitcnt lgkmcnt(8)
  ds_read_b128 a[148:151], v41 offset:11264
  v_add_u32 v41, s74, v41
  v_mfma_f32_16x16x32_bf16 v[140:143], a[84:87], a[112:115], v[140:143]
  buffer_load_dwordx4 v36, s[8:11], s76 offen offset:0 sc1 lds
  v_mfma_f32_16x16x32_bf16 v[108:111], a[80:83], a[116:119], v[108:111]
  ds_read_b128 a[152:155], v42 offset:9216
  v_mfma_f32_16x16x32_bf16 v[144:147], a[84:87], a[116:119], v[144:147]
  ds_read_b128 a[156:159], v42 offset:10240
  v_add_u32 v42, s74, v42
  v_mfma_f32_16x16x32_bf16 v[112:115], a[80:83], a[120:123], v[112:115]
  buffer_load_dwordx4 v37, s[8:11], s76 offen offset:1024 sc1 lds
  v_mfma_f32_16x16x32_bf16 v[148:151], a[84:87], a[120:123], v[148:151]
  ds_read_b128 a[160:163], v43 offset:9216
  v_mfma_f32_16x16x32_bf16 v[116:119], a[80:83], a[124:127], v[116:119]
  ds_read_b128 a[164:167], v43 offset:10240
  v_add_u32 v43, s74, v43
  v_mfma_f32_16x16x32_bf16 v[152:155], a[84:87], a[124:127], v[152:155]
  buffer_load_dwordx4 v38, s[8:11], s76 offen offset:2048 sc1 lds
  v_mfma_f32_16x16x32_bf16 v[120:123], a[80:83], a[128:131], v[120:123]
  ds_read_b128 a[168:171], v44 offset:9216
  v_mfma_f32_16x16x32_bf16 v[156:159], a[84:87], a[128:131], v[156:159]
  ds_read_b128 a[172:175], v44 offset:10240
  v_add_u32 v44, s74, v44
  v_mfma_f32_16x16x32_bf16 v[124:127], a[80:83], a[132:135], v[124:127]
  buffer_load_dwordx4 v39, s[8:11], s76 offen offset:3072 sc1 lds
  v_mfma_f32_16x16x32_bf16 v[160:163], a[84:87], a[132:135], v[160:163]
  s_add_u32 m0, s75, 8192
  v_mfma_f32_16x16x32_bf16 v[128:131], a[80:83], a[136:139], v[128:131]
  v_mfma_f32_16x16x32_bf16 v[164:167], a[84:87], a[136:139], v[164:167]
  buffer_load_dwordx4 v40, s[8:11], s76 offen offset:0 sc1 lds
  s_waitcnt lgkmcnt(6)
  v_mfma_f32_16x16x32_bf16 v[96:99], a[92:95], a[140:143], v[96:99]
  s_and_b32 s60, s36, 15
  s_lshr_b64 s[36:37], s[36:37], 4
  s_add_u32 s60, s60, s79
  v_mfma_f32_16x16x32_bf16 v[132:135], a[96:99], a[140:143], v[132:135]
  s_and_b32 s60, s60, 15
  s_mul_i32 s60, s60, s52
  s_add_u32 s60, s60, s78
  v_mfma_f32_16x16x32_bf16 v[168:171], a[100:103], a[140:143], v[168:171]
  s_cmp_ge_u32 s63, 12
  s_cselect_b32 s75, 196608, s62
  s_cselect_b32 s76, 1073741824, s60
  v_mfma_f32_16x16x32_bf16 v[100:103], a[92:95], a[144:147], v[100:103]
  s_add_u32 s62, s62, s74
  s_add_u32 s67, s67, 1
  s_and_b32 s67, s67, 3
  v_mfma_f32_16x16x32_bf16 v[136:139], a[96:99], a[144:147], v[136:139]
  s_cmp_eq_u32 s67, 3
  s_cselect_b32 s74, s73, s72
  s_bitcmp1_b32 s35, s63
  v_mfma_f32_16x16x32_bf16 v[172:175], a[100:103], a[144:147], v[172:175]
  s_cbranch_scc1 L_ho
  s_waitcnt lgkmcnt(0)
  s_waitcnt vmcnt(18)
  s_barrier
L_hco:
  v_mfma_f32_16x16x32_bf16 v[104:107], a[92:95], a[148:151], v[104:107]
  s_add_u32 m0, s75, 0
  ds_read_b64_tr_b16 a[80:81], v45 offset:0
  ds_read_b64_tr_b16 a[82:83], v45 offset:4608
  v_mfma_f32_16x16x32_bf16 v[140:143], a[96:99], a[148:151], v[140:143]
  s_nop 0
  ds_read_b64_tr_b16 a[84:85], v45 offset:32
  ds_read_b64_tr_b16 a[86:87], v45 offset:4640
  v_mfma_f32_16x16x32_bf16 v[108:111], a[92:95], a[152:155], v[108:111]
  s_nop 0
  ds_read_b64_tr_b16 a[88:89], v46 offset:0
  ds_read_b64_tr_b16 a[90:91], v46 offset:4608
  v_mfma_f32_16x16x32_bf16 v[144:147], a[96:99], a[152:155], v[144:147]
  ds_read_b128 a[104:107], v41 offset:0
  v_mfma_f32_16x16x32_bf16 v[112:115], a[92:95], a[156:159], v[112:115]
  ds_read_b128 a[108:111], v41 offset:1024
  v_mfma_f32_16x16x32_bf16 v[148:151], a[96:99], a[156:159], v[148:151]
  ds_read_b128 a[112:115], v41 offset:2048
  v_mfma_f32_16x16x32_bf16 v[116:119], a[92:95], a[160:163], v[116:119]
  buffer_load_dwordx4 v32, s[8:11], s76 offen offset:0 sc1 lds
  v_mfma_f32_16x16x32_bf16 v[152:155], a[96:99], a[160:163], v[152:155]
  s_add_u32 s63, s63, 1
  ds_read_b128 a[116:119], v42 offset:0
  s_cmp_lt_u32 s63, 12
  v_mfma_f32_16x16x32_bf16 v[120:123], a[92:95], a[164:167], v[120:123]
  ds_read_b128 a[120:123], v42 offset:1024
  v_mfma_f32_16x16x32_bf16 v[156:159], a[96:99], a[164:167], v[156:159]
  buffer_load_dwordx4 v33, s[8:11], s76 offen offset:1024 sc1 lds
  v_mfma_f32_16x16x32_bf16 v[124:127], a[92:95], a[168:171], v[124:127]
  ds_read_b128 a[124:127], v43 offset:0
  v_mfma_f32_16x16x32_bf16 v[160:163], a[96:99], a[168:171], v[160:163]
  ds_read_b128 a[128:131], v43 offset:1024
  v_mfma_f32_16x16x32_bf16 v[128:131], a[92:95], a[172:175], v[128:131]
  buffer_load_dwordx4 v34, s[8:11], s76 offen offset:2048 sc1 lds
  v_mfma_f32_16x16x32_bf16 v[164:167], a[96:99], a[172:175], v[164:167]
  s_nop 0
  ds_read_b128 a[132:135], v44 offset:0
  ds_read_b128 a[136:139], v44 offset:1024
  s_cbranch_scc1 L_go
  s_waitcnt lgkmcnt(6)
  v_mfma_f32_16x16x32_bf16 v[96:99], a[80:83], a[104:107], v[96:99]
  s_nop 0
  ds_read_b64_tr_b16 a[92:93], v45 offset:9216
  ds_read_b64_tr_b16 a[94:95], v45 offset:13824
  v_mfma_f32_16x16x32_bf16 v[132:135], a[84:87], a[104:107], v[132:135]
  s_nop 0
  ds_read_b64_tr_b16 a[96:97], v45 offset:9248
  ds_read_b64_tr_b16 a[98:99], v45 offset:13856
  v_mfma_f32_16x16x32_bf16 v[168:171], a[88:91], a[104:107], v[168:171]
  s_nop 0
  ds_read_b64_tr_b16 a[100:101], v46 offset:9216
  ds_read_b64_tr_b16 a[102:103], v46 offset:13824
  v_mfma_f32_16x16x32_bf16 v[100:103], a[80:83], a[108:111], v[100:103]
  ds_read_b128 a[140:143], v41 offset:9216
  v_add_u32 v45, s74, v45
  v_mfma_f32_16x16x32_bf16 v[136:139], a[84:87], a[108:111], v[136:139]
  buffer_load_dwordx4 v35, s[8:11], s76 offen offset:3072 sc1 lds
  v_mfma_f32_16x16x32_bf16 v[172:175], a[88:91], a[108:111], v[172:175]
  s_add_u32 m0, s75, 4096
  ds_read_b128 a[144:147], v41 offset:10240
  v_add_u32 v46, s74, v46
  v_mfma_f32_16x16x32_bf16 v[104:107], a[80:83], a[112:115], v[104:107]
  s_waitcnt lgkmcnt(8)
  ds_read_b128 a[148:151], v41 offset:11264
  v_add_u32 v41, s74, v41
  v_mfma_f32_16x16x32_bf16 v[140:143], a[84:87], a[112:115], v[140:143]
  buffer_load_dwordx4 v36, s[8:11], s76 offen offset:0 sc1 lds
  v_mfma_f32_16x16x32_bf16 v[108:111], a[80:83], a[116:119], v[108:111]
  ds_read_b128 a[152:155], v42 offset:9216
  v_mfma_f32_16x16x32_bf16 v[144:147], a[84:87], a[116:119], v[144:147]
  ds_read_b128 a[156:159], v42 offset:10240
  v_add_u32 v42, s74, v42
  v_mfma_f32_16x16x32_bf16 v[112:115], a[80:83], a[120:123], v[112:115]
  buffer_load_dwordx4 v37, s[8:11], s76 offen offset:1024 sc1 lds
  v_mfma_f32_16x16x32_bf16 v[148:151], a[84:87], a[120:123], v[148:151]
  ds_read_b128 a[160:163], v43 offset:9216
  v_mfma_f32_16x16x32_bf16 v[116:119], a[80:83], a[124:127], v[116:119]
  ds_read_b128 a[164:167], v43 offset:10240
  v_add_u32 v43, s74, v43
  v_mfma_f32_16x16x32_bf16 v[152:155], a[84:87], a[124:127], v[152:155]
  buffer_load_dwordx4 v38, s[8:11], s76 offen offset:2048 sc1 lds
  v_mfma_f32_16x16x32_bf16 v[120:123], a[80:83], a[128:131], v[120:123]
  ds_read_b128 a[168:171], v44 offset:9216
  v_mfma_f32_16x16x32_bf16 v[156:159], a[84:87], a[128:131], v[156:159]
  ds_read_b128 a[172:175], v44 offset:10240
  v_add_u32 v44, s74, v44
  v_mfma_f32_16x16x32_bf16 v[124:127], a[80:83], a[132:135], v[124:127]
  buffer_load_dwordx4 v39, s[8:11], s76 offen offset:3072 sc1 lds
  v_mfma_f32_16x16x32_bf16 v[160:163], a[84:87], a[132:135], v[160:163]
  s_add_u32 m0, s75, 8192
  v_mfma_f32_16x16x32_bf16 v[128:131], a[80:83], a[136:139], v[128:131]
  v_mfma_f32_16x16x32_bf16 v[164:167], a[84:87], a[136:139], v[164:167]
  buffer_load_dwordx4 v40, s[8:11], s76 offen offset:0 sc1 lds
  s_waitcnt lgkmcnt(6)
  v_mfma_f32_16x16x32_bf16 v[96:99], a[92:95], a[140:143], v[96:99]
  s_add_u32 s67, s67, 1
  s_and_b32 s67, s67, 3
  s_cmp_eq_u32 s67, 3
  v_mfma_f32_16x16x32_bf16 v[132:135], a[96:99], a[140:143], v[132:135]
  s_cselect_b32 s74, s73, s72
  v_mfma_f32_16x16x32_bf16 v[168:171], a[100:103], a[140:143], v[168:171]
  v_mfma_f32_16x16x32_bf16 v[100:103], a[92:95], a[144:147], v[100:103]
  v_mfma_f32_16x16x32_bf16 v[136:139], a[96:99], a[144:147], v[136:139]
  v_mfma_f32_16x16x32_bf16 v[172:175], a[100:103], a[144:147], v[172:175]
  s_waitcnt vmcnt(18)
  s_waitcnt lgkmcnt(0)
  s_barrier
  v_mfma_f32_16x16x32_bf16 v[104:107], a[92:95], a[148:151], v[104:107]
  s_nop 0
  ds_read_b64_tr_b16 a[80:81], v45 offset:0
  ds_read_b64_tr_b16 a[82:83], v45 offset:4608
  v_mfma_f32_16x16x32_bf16 v[140:143], a[96:99], a[148:151], v[140:143]
  s_nop 0
  ds_read_b64_tr_b16 a[84:85], v45 offset:32
  ds_read_b64_tr_b16 a[86:87], v45 offset:4640
  v_mfma_f32_16x16x32_bf16 v[108:111], a[92:95], a[152:155], v[108:111]
  s_nop 0
  ds_read_b64_tr_b16 a[88:89], v46 offset:0
  ds_read_b64_tr_b16 a[90:91], v46 offset:4608
  v_mfma_f32_16x16x32_bf16 v[144:147], a[96:99], a[152:155], v[144:147]
  ds_read_b128 a[104:107], v41 offset:0
  v_mfma_f32_16x16x32_bf16 v[112:115], a[92:95], a[156:159], v[112:115]
  ds_read_b128 a[108:111], v41 offset:1024
  v_mfma_f32_16x16x32_bf16 v[148:151], a[96:99], a[156:159], v[148:151]
  ds_read_b128 a[112:115], v41 offset:2048
  v_mfma_f32_16x16x32_bf16 v[116:119], a[92:95], a[160:163], v[116:119]
  v_mfma_f32_16x16x32_bf16 v[152:155], a[96:99], a[160:163], v[152:155]
  s_add_u32 s63, s63, 1
  ds_read_b128 a[116:119], v42 offset:0
  v_mfma_f32_16x16x32_bf16 v[120:123], a[92:95], a[164:167], v[120:123]
  ds_read_b128 a[120:123], v42 offset:1024
  v_mfma_f32_16x16x32_bf16 v[156:159], a[96:99], a[164:167], v[156:159]
  v_mfma_f32_16x16x32_bf16 v[124:127], a[92:95], a[168:171], v[124:127]
  ds_read_b128 a[124:127], v43 offset:0
  v_mfma_f32_16x16x32_bf16 v[160:163], a[96:99], a[168:171], v[160:163]
  ds_read_b128 a[128:131], v43 offset:1024
  v_mfma_f32_16x16x32_bf16 v[128:131], a[92:95], a[172:175], v[128:131]
  v_mfma_f32_16x16x32_bf16 v[164:167], a[96:99], a[172:175], v[164:167]
  s_nop 0
  ds_read_b128 a[132:135], v44 offset:0
  ds_read_b128 a[136:139], v44 offset:1024
  s_waitcnt lgkmcnt(6)
  v_mfma_f32_16x16x32_bf16 v[96:99], a[80:83], a[104:107], v[96:99]
  s_nop 0
  ds_read_b64_tr_b16 a[92:93], v45 offset:9216
  ds_read_b64_tr_b16 a[94:95], v45 offset:13824
  v_mfma_f32_16x16x32_bf16 v[132:135], a[84:87], a[104:107], v[132:135]
  s_nop 0
  ds_read_b64_tr_b16 a[96:97], v45 offset:9248
  ds_read_b64_tr_b16 a[98:99], v45 offset:13856
  v_mfma_f32_16x16x32_bf16 v[168:171], a[88:91], a[104:107], v[168:171]
  s_nop 0
  ds_read_b64_tr_b16 a[100:101], v46 offset:9216
  ds_read_b64_tr_b16 a[102:103], v46 offset:13824
  v_mfma_f32_16x16x32_bf16 v[100:103], a[80:83], a[108:111], v[100:103]
  ds_read_b128 a[140:143], v41 offset:9216
  v_add_u32 v45, s74, v45
  v_mfma_f32_16x16x32_bf16 v[136:139], a[84:87], a[108:111], v[136:139]
  v_add_u32 v46, s74, v46
  v_mfma_f32_16x16x32_bf16 v[172:175], a[88:91], a[108:111], v[172:175]
  ds_read_b128 a[144:147], v41 offset:10240
  v_mfma_f32_16x16x32_bf16 v[104:107], a[80:83], a[112:115], v[104:107]
  s_waitcnt lgkmcnt(8)
  ds_read_b128 a[148:151], v41 offset:11264
  v_add_u32 v41, s74, v41
  v_mfma_f32_16x16x32_bf16 v[140:143], a[84:87], a[112:115], v[140:143]
  v_mfma_f32_16x16x32_bf16 v[108:111], a[80:83], a[116:119], v[108:111]
  ds_read_b128 a[152:155], v42 offset:9216
  v_mfma_f32_16x16x32_bf16 v[144:147], a[84:87], a[116:119], v[144:147]
  ds_read_b128 a[156:159], v42 offset:10240
  v_add_u32 v42, s74, v42
  v_mfma_f32_16x16x32_bf16 v[112:115], a[80:83], a[120:123], v[112:115]
  v_mfma_f32_16x16x32_bf16 v[148:151], a[84:87], a[120:123], v[148:151]
  ds_read_b128 a[160:163], v43 offset:9216
  v_mfma_f32_16x16x32_bf16 v[116:119], a[80:83], a[124:127], v[116:119]
  ds_read_b128 a[164:167], v43 offset:10240
  v_add_u32 v43, s74, v43
  v_mfma_f32_16x16x32_bf16 v[152:155], a[84:87], a[124:127], v[152:155]
  v_mfma_f32_16x16x32_bf16 v[120:123], a[80:83], a[128:131], v[120:123]
  ds_read_b128 a[168:171], v44 offset:9216
  v_mfma_f32_16x16x32_bf16 v[156:159], a[84:87], a[128:131], v[156:159]
  ds_read_b128 a[172:175], v44 offset:10240
  v_add_u32 v44, s74, v44
  v_mfma_f32_16x16x32_bf16 v[124:127], a[80:83], a[132:135], v[124:127]
  v_mfma_f32_16x16x32_bf16 v[160:163], a[84:87], a[132:135], v[160:163]
  v_mfma_f32_16x16x32_bf16 v[128:131], a[80:83], a[136:139], v[128:131]
  v_mfma_f32_16x16x32_bf16 v[164:167], a[84:87], a[136:139], v[164:167]
  s_waitcnt lgkmcnt(6)
  v_mfma_f32_16x16x32_bf16 v[96:99], a[92:95], a[140:143], v[96:99]
  s_add_u32 s67, s67, 1
  s_and_b32 s67, s67, 3
  s_cmp_eq_u32 s67, 3
  v_mfma_f32_16x16x32_bf16 v[132:135], a[96:99], a[140:143], v[132:135]
  s_cselect_b32 s74, s73, s72
  v_mfma_f32_16x16x32_bf16 v[168:171], a[100:103], a[140:143], v[168:171]
  v_mfma_f32_16x16x32_bf16 v[100:103], a[92:95], a[144:147], v[100:103]
  v_mfma_f32_16x16x32_bf16 v[136:139], a[96:99], a[144:147], v[136:139]
  v_mfma_f32_16x16x32_bf16 v[172:175], a[100:103], a[144:147], v[172:175]
  s_waitcnt vmcnt(9)
  s_waitcnt lgkmcnt(0)
  s_barrier
  v_mfma_f32_16x16x32_bf16 v[104:107], a[92:95], a[148:151], v[104:107]
  s_nop 0
  ds_read_b64_tr_b16 a[80:81], v45 offset:0
  ds_read_b64_tr_b16 a[82:83], v45 offset:4608
  v_mfma_f32_16x16x32_bf16 v[140:143], a[96:99], a[148:151], v[140:143]
  s_nop 0
  ds_read_b64_tr_b16 a[84:85], v45 offset:32
  ds_read_b64_tr_b16 a[86:87], v45 offset:4640
  v_mfma_f32_16x16x32_bf16 v[108:111], a[92:95], a[152:155], v[108:111]
  s_nop 0
  ds_read_b64_tr_b16 a[88:89], v46 offset:0
  ds_read_b64_tr_b16 a[90:91], v46 offset:4608
  v_mfma_f32_16x16x32_bf16 v[144:147], a[96:99], a[152:155], v[144:147]
  ds_read_b128 a[104:107], v41 offset:0
  v_mfma_f32_16x16x32_bf16 v[112:115], a[92:95], a[156:159], v[112:115]
  ds_read_b128 a[108:111], v41 offset:1024
  v_mfma_f32_16x16x32_bf16 v[148:151], a[96:99], a[156:159], v[148:151]
  ds_read_b128 a[112:115], v41 offset:2048
  v_mfma_f32_16x16x32_bf16 v[116:119], a[92:95], a[160:163], v[116:119]
  v_mfma_f32_16x16x32_bf16 v[152:155], a[96:99], a[160:163], v[152:155]
  s_add_u32 s63, s63, 1
  ds_read_b128 a[116:119], v42 offset:0
  v_mfma_f32_16x16x32_bf16 v[120:123], a[92:95], a[164:167], v[120:123]
  ds_read_b128 a[120:123], v42 offset:1024
  v_mfma_f32_16x16x32_bf16 v[156:159], a[96:99], a[164:167], v[156:159]
  v_mfma_f32_16x16x32_bf16 v[124:127], a[92:95], a[168:171], v[124:127]
  ds_read_b128 a[124:127], v43 offset:0
  v_mfma_f32_16x16x32_bf16 v[160:163], a[96:99], a[168:171], v[160:163]
  ds_read_b128 a[128:131], v43 offset:1024
  v_mfma_f32_16x16x32_bf16 v[128:131], a[92:95], a[172:175], v[128:131]
  v_mfma_f32_16x16x32_bf16 v[164:167], a[96:99], a[172:175], v[164:167]
  s_nop 0
  ds_read_b128 a[132:135], v44 offset:0
  ds_read_b128 a[136:139], v44 offset:1024
  s_waitcnt lgkmcnt(6)
  v_mfma_f32_16x16x32_bf16 v[96:99], a[80:83], a[104:107], v[96:99]
  s_nop 0
  ds_read_b64_tr_b16 a[92:93], v45 offset:9216
  ds_read_b64_tr_b16 a[94:95], v45 offset:13824
  v_mfma_f32_16x16x32_bf16 v[132:135], a[84:87], a[104:107], v[132:135]
  s_nop 0
  ds_read_b64_tr_b16 a[96:97], v45 offset:9248
  ds_read_b64_tr_b16 a[98:99], v45 offset:13856
  v_mfma_f32_16x16x32_bf16 v[168:171], a[88:91], a[104:107], v[168:171]
  s_nop 0
  ds_read_b64_tr_b16 a[100:101], v46 offset:9216
  ds_read_b64_tr_b16 a[102:103], v46 offset:13824
  v_mfma_f32_16x16x32_bf16 v[100:103], a[80:83], a[108:111], v[100:103]
  ds_read_b128 a[140:143], v41 offset:9216
  v_add_u32 v45, s74, v45
  v_mfma_f32_16x16x32_bf16 v[136:139], a[84:87], a[108:111], v[136:139]
  v_add_u32 v46, s74, v46
  v_mfma_f32_16x16x32_bf16 v[172:175], a[88:91], a[108:111], v[172:175]
  ds_read_b128 a[144:147], v41 offset:10240
  v_mfma_f32_16x16x32_bf16 v[104:107], a[80:83], a[112:115], v[104:107]
  s_waitcnt lgkmcnt(8)
  ds_read_b128 a[148:151], v41 offset:11264
  v_add_u32 v41, s74, v41
  v_mfma_f32_16x16x32_bf16 v[140:143], a[84:87], a[112:115], v[140:143]
  v_mfma_f32_16x16x32_bf16 v[108:111], a[80:83], a[116:119], v[108:111]
  ds_read_b128 a[152:155], v42 offset:9216
  v_mfma_f32_16x16x32_bf16 v[144:147], a[84:87], a[116:119], v[144:147]
  ds_read_b128 a[156:159], v42 offset:10240
  v_add_u32 v42, s74, v42
  v_mfma_f32_16x16x32_bf16 v[112:115], a[80:83], a[120:123], v[112:115]
  v_mfma_f32_16x16x32_bf16 v[148:151], a[84:87], a[120:123], v[148:151]
  ds_read_b128 a[160:163], v43 offset:9216
  v_mfma_f32_16x16x32_bf16 v[116:119], a[80:83], a[124:127], v[116:119]
  ds_read_b128 a[164:167], v43 offset:10240
  v_add_u32 v43, s74, v43
  v_mfma_f32_16x16x32_bf16 v[152:155], a[84:87], a[124:127], v[152:155]
  v_mfma_f32_16x16x32_bf16 v[120:123], a[80:83], a[128:131], v[120:123]
  ds_read_b128 a[168:171], v44 offset:9216
  v_mfma_f32_16x16x32_bf16 v[156:159], a[84:87], a[128:131], v[156:159]
  ds_read_b128 a[172:175], v44 offset:10240
  v_add_u32 v44, s74, v44
  v_mfma_f32_16x16x32_bf16 v[124:127], a[80:83], a[132:135], v[124:127]
  v_mfma_f32_16x16x32_bf16 v[160:163], a[84:87], a[132:135], v[160:163]
  v_mfma_f32_16x16x32_bf16 v[128:131], a[80:83], a[136:139], v[128:131]
  v_mfma_f32_16x16x32_bf16 v[164:167], a[84:87], a[136:139], v[164:167]
  s_waitcnt lgkmcnt(6)
  v_mfma_f32_16x16x32_bf16 v[96:99], a[92:95], a[140:143], v[96:99]
  s_add_u32 s67, s67, 1
  s_and_b32 s67, s67, 3
  s_cmp_eq_u32 s67, 3
  v_mfma_f32_16x16x32_bf16 v[132:135], a[96:99], a[140:143], v[132:135]
  s_cselect_b32 s74, s73, s72
  v_mfma_f32_16x16x32_bf16 v[168:171], a[100:103], a[140:143], v[168:171]
  v_mfma_f32_16x16x32_bf16 v[100:103], a[92:95], a[144:147], v[100:103]
  v_mfma_f32_16x16x32_bf16 v[136:139], a[96:99], a[144:147], v[136:139]
  v_mfma_f32_16x16x32_bf16 v[172:175], a[100:103], a[144:147], v[172:175]
  s_waitcnt vmcnt(0)
  s_waitcnt lgkmcnt(0)
  s_barrier
  v_mfma_f32_16x16x32_bf16 v[104:107], a[92:95], a[148:151], v[104:107]
  s_nop 0
  ds_read_b64_tr_b16 a[80:81], v45 offset:0
  ds_read_b64_tr_b16 a[82:83], v45 offset:4608
  v_mfma_f32_16x16x32_bf16 v[140:143], a[96:99], a[148:151], v[140:143]
  s_nop 0
  ds_read_b64_tr_b16 a[84:85], v45 offset:32
  ds_read_b64_tr_b16 a[86:87], v45 offset:4640
  v_mfma_f32_16x16x32_bf16 v[108:111], a[92:95], a[152:155], v[108:111]
  s_nop 0
  ds_read_b64_tr_b16 a[88:89], v46 offset:0
  ds_read_b64_tr_b16 a[90:91], v46 offset:4608
  v_mfma_f32_16x16x32_bf16 v[144:147], a[96:99], a[152:155], v[144:147]
  ds_read_b128 a[104:107], v41 offset:0
  v_mfma_f32_16x16x32_bf16 v[112:115], a[92:95], a[156:159], v[112:115]
  ds_read_b128 a[108:111], v41 offset:1024
  v_mfma_f32_16x16x32_bf16 v[148:151], a[96:99], a[156:159], v[148:151]
  ds_read_b128 a[112:115], v41 offset:2048
  v_mfma_f32_16x16x32_bf16 v[116:119], a[92:95], a[160:163], v[116:119]
  v_mfma_f32_16x16x32_bf16 v[152:155], a[96:99], a[160:163], v[152:155]
  s_add_u32 s63, s63, 1
  ds_read_b128 a[116:119], v42 offset:0
  v_mfma_f32_16x16x32_bf16 v[120:123], a[92:95], a[164:167], v[120:123]
  ds_read_b128 a[120:123], v42 offset:1024
  v_mfma_f32_16x16x32_bf16 v[156:159], a[96:99], a[164:167], v[156:159]
  v_mfma_f32_16x16x32_bf16 v[124:127], a[92:95], a[168:171], v[124:127]
  ds_read_b128 a[124:127], v43 offset:0
  v_mfma_f32_16x16x32_bf16 v[160:163], a[96:99], a[168:171], v[160:163]
  ds_read_b128 a[128:131], v43 offset:1024
  v_mfma_f32_16x16x32_bf16 v[128:131], a[92:95], a[172:175], v[128:131]
  v_mfma_f32_16x16x32_bf16 v[164:167], a[96:99], a[172:175], v[164:167]
  s_nop 0
  ds_read_b128 a[132:135], v44 offset:0
  ds_read_b128 a[136:139], v44 offset:1024
  s_waitcnt lgkmcnt(6)
  v_mfma_f32_16x16x32_bf16 v[96:99], a[80:83], a[104:107], v[96:99]
  s_nop 0
  ds_read_b64_tr_b16 a[92:93], v45 offset:9216
  ds_read_b64_tr_b16 a[94:95], v45 offset:13824
  v_mfma_f32_16x16x32_bf16 v[132:135], a[84:87], a[104:107], v[132:135]
  s_nop 0
  ds_read_b64_tr_b16 a[96:97], v45 offset:9248
  ds_read_b64_tr_b16 a[98:99], v45 offset:13856
  v_mfma_f32_16x16x32_bf16 v[168:171], a[88:91], a[104:107], v[168:171]
  s_nop 0
  ds_read_b64_tr_b16 a[100:101], v46 offset:9216
  ds_read_b64_tr_b16 a[102:103], v46 offset:13824
  v_mfma_f32_16x16x32_bf16 v[100:103], a[80:83], a[108:111], v[100:103]
  ds_read_b128 a[140:143], v41 offset:9216
  v_add_u32 v45, s74, v45
  v_mfma_f32_16x16x32_bf16 v[136:139], a[84:87], a[108:111], v[136:139]
  v_add_u32 v46, s74, v46
  v_mfma_f32_16x16x32_bf16 v[172:175], a[88:91], a[108:111], v[172:175]
  ds_read_b128 a[144:147], v41 offset:10240
  v_mfma_f32_16x16x32_bf16 v[104:107], a[80:83], a[112:115], v[104:107]
  s_waitcnt lgkmcnt(8)
  ds_read_b128 a[148:151], v41 offset:11264
  v_add_u32 v41, s74, v41
  v_mfma_f32_16x16x32_bf16 v[140:143], a[84:87], a[112:115], v[140:143]
  v_mfma_f32_16x16x32_bf16 v[108:111], a[80:83], a[116:119], v[108:111]
  ds_read_b128 a[152:155], v42 offset:9216
  v_mfma_f32_16x16x32_bf16 v[144:147], a[84:87], a[116:119], v[144:147]
  ds_read_b128 a[156:159], v42 offset:10240
  v_add_u32 v42, s74, v42
  v_mfma_f32_16x16x32_bf16 v[112:115], a[80:83], a[120:123], v[112:115]
  v_mfma_f32_16x16x32_bf16 v[148:151], a[84:87], a[120:123], v[148:151]
  ds_read_b128 a[160:163], v43 offset:9216
  v_mfma_f32_16x16x32_bf16 v[116:119], a[80:83], a[124:127], v[116:119]
  ds_read_b128 a[164:167], v43 offset:10240
  v_add_u32 v43, s74, v43
  v_mfma_f32_16x16x32_bf16 v[152:155], a[84:87], a[124:127], v[152:155]
  v_mfma_f32_16x16x32_bf16 v[120:123], a[80:83], a[128:131], v[120:123]
  ds_read_b128 a[168:171], v44 offset:9216
  v_mfma_f32_16x16x32_bf16 v[156:159], a[84:87], a[128:131], v[156:159]
  ds_read_b128 a[172:175], v44 offset:10240
  v_add_u32 v44, s74, v44
  v_mfma_f32_16x16x32_bf16 v[124:127], a[80:83], a[132:135], v[124:127]
  v_mfma_f32_16x16x32_bf16 v[160:163], a[84:87], a[132:135], v[160:163]
  v_mfma_f32_16x16x32_bf16 v[128:131], a[80:83], a[136:139], v[128:131]
  v_mfma_f32_16x16x32_bf16 v[164:167], a[84:87], a[136:139], v[164:167]
  s_waitcnt lgkmcnt(6)
  v_mfma_f32_16x16x32_bf16 v[96:99], a[92:95], a[140:143], v[96:99]
  s_add_u32 s67, s67, 1
  s_and_b32 s67, s67, 3
  s_cmp_eq_u32 s67, 3
  v_mfma_f32_16x16x32_bf16 v[132:135], a[96:99], a[140:143], v[132:135]
  s_cselect_b32 s74, s73, s72
  v_mfma_f32_16x16x32_bf16 v[168:171], a[100:103], a[140:143], v[168:171]
  v_mfma_f32_16x16x32_bf16 v[100:103], a[92:95], a[144:147], v[100:103]
  v_mfma_f32_16x16x32_bf16 v[136:139], a[96:99], a[144:147], v[136:139]
  v_mfma_f32_16x16x32_bf16 v[172:175], a[100:103], a[144:147], v[172:175]
  s_waitcnt lgkmcnt(0)
  s_barrier
  v_mfma_f32_16x16x32_bf16 v[104:107], a[92:95], a[148:151], v[104:107]
  s_and_b32 s38, s3, 3
  s_lshl_b32 s60, s38, 4
  s_lshr_b32 s61, s3, 2
  v_mfma_f32_16x16x32_bf16 v[140:143], a[96:99], a[148:151], v[140:143]
  s_lshl_b32 s61, s61, 3
  s_add_u32 s61, s61, s5
  s_add_u32 s60, s60, s61
  v_mfma_f32_16x16x32_bf16 v[108:111], a[92:95], a[152:155], v[108:111]
  s_lshl_b32 s60, s60, 2
  s_add_u32 s60, s60, s4
  s_mul_i32 s60, s60, 41472
  v_mfma_f32_16x16x32_bf16 v[144:147], a[96:99], a[152:155], v[144:147]
  s_add_u32 s12, s82, 33554432
  s_addc_u32 s13, s83, 0
  s_mov_b32 s14, 10616832
  v_mfma_f32_16x16x32_bf16 v[112:115], a[92:95], a[156:159], v[112:115]
  s_mul_i32 s62, s28, 9216
  s_add_u32 s62, s62, s60
  s_lshl_b32 s63, s28, 1
  v_mfma_f32_16x16x32_bf16 v[148:151], a[96:99], a[156:159], v[148:151]
  s_cmp_eq_u32 s28, 0
  s_cselect_b32 s64, 3, 0
  s_cmp_lt_u32 s28, 2
  v_mfma_f32_16x16x32_bf16 v[116:119], a[92:95], a[160:163], v[116:119]
  s_cselect_b32 s65, 5, 2
  s_cmp_lt_u32 s28, 3
  s_cselect_b32 s66, 7, 4
  v_mfma_f32_16x16x32_bf16 v[152:155], a[96:99], a[160:163], v[152:155]
  v_mfma_f32_16x16x32_bf16 v[120:123], a[92:95], a[164:167], v[120:123]
  v_mfma_f32_16x16x32_bf16 v[156:159], a[96:99], a[164:167], v[156:159]
  v_mfma_f32_16x16x32_bf16 v[124:127], a[92:95], a[168:171], v[124:127]
  v_mfma_f32_16x16x32_bf16 v[160:163], a[96:99], a[168:171], v[160:163]
  v_mfma_f32_16x16x32_bf16 v[128:131], a[92:95], a[172:175], v[128:131]
  v_mfma_f32_16x16x32_bf16 v[164:167], a[96:99], a[172:175], v[164:167]
  s_branch L_ge
L_gsw:
  s_waitcnt lgkmcnt(6)
  v_mfma_f32_16x16x32_bf16 v[96:99], a[80:83], a[104:107], v[96:99]
  s_nop 0
  ds_read_b64_tr_b16 a[92:93], v45 offset:9216
  ds_read_b64_tr_b16 a[94:95], v45 offset:13824
  v_mfma_f32_16x16x32_bf16 v[132:135], a[84:87], a[104:107], v[132:135]
  s_nop 0
  ds_read_b64_tr_b16 a[96:97], v45 offset:9248
  ds_read_b64_tr_b16 a[98:99], v45 offset:13856
  v_mfma_f32_16x16x32_bf16 v[168:171], a[88:91], a[104:107], v[168:171]
  s_nop 0
  ds_read_b64_tr_b16 a[100:101], v46 offset:9216
  ds_read_b64_tr_b16 a[102:103], v46 offset:13824
  v_mfma_f32_16x16x32_bf16 v[100:103], a[80:83], a[108:111], v[100:103]
  ds_read_b128 a[140:143], v41 offset:9216
  v_add_u32 v45, s74, v45
  v_mfma_f32_16x16x32_bf16 v[136:139], a[84:87], a[108:111], v[136:139]
  v_add_u32 v46, s74, v46
  v_mfma_f32_16x16x32_bf16 v[172:175], a[88:91], a[108:111], v[172:175]
  ds_read_b128 a[144:147], v41 offset:10240
  v_mfma_f32_16x16x32_bf16 v[104:107], a[80:83], a[112:115], v[104:107]
  ds_read_b128 a[148:151], v41 offset:11264
  v_add_u32 v41, s74, v41
  v_mfma_f32_16x16x32_bf16 v[140:143], a[84:87], a[112:115], v[140:143]
  s_waitcnt lgkmcnt(9)
  v_mfma_f32_16x16x32_bf16 v[176:179], a[88:91], a[112:115], v[176:179]
  ds_read_b128 a[152:155], v42 offset:9216
  v_mfma_f32_16x16x32_bf16 v[108:111], a[80:83], a[116:119], v[108:111]
  ds_read_b128 a[156:159], v42 offset:10240
  v_add_u32 v42, s74, v42
  v_mfma_f32_16x16x32_bf16 v[144:147], a[84:87], a[116:119], v[144:147]
  v_mfma_f32_16x16x32_bf16 v[112:115], a[80:83], a[120:123], v[112:115]
  ds_read_b128 a[160:163], v43 offset:9216
  v_mfma_f32_16x16x32_bf16 v[148:151], a[84:87], a[120:123], v[148:151]
  ds_read_b128 a[164:167], v43 offset:10240
  v_add_u32 v43, s74, v43
  v_mfma_f32_16x16x32_bf16 v[116:119], a[80:83], a[124:127], v[116:119]
  v_mfma_f32_16x16x32_bf16 v[152:155], a[84:87], a[124:127], v[152:155]
  ds_read_b128 a[168:171], v44 offset:9216
  v_mfma_f32_16x16x32_bf16 v[120:123], a[80:83], a[128:131], v[120:123]
  ds_read_b128 a[172:175], v44 offset:10240
  v_add_u32 v44, s74, v44
  v_mfma_f32_16x16x32_bf16 v[156:159], a[84:87], a[128:131], v[156:159]
  v_mfma_f32_16x16x32_bf16 v[124:127], a[80:83], a[132:135], v[124:127]
  v_mfma_f32_16x16x32_bf16 v[160:163], a[84:87], a[132:135], v[160:163]
  v_mfma_f32_16x16x32_bf16 v[128:131], a[80:83], a[136:139], v[128:131]
  v_mfma_f32_16x16x32_bf16 v[164:167], a[84:87], a[136:139], v[164:167]
  s_waitcnt lgkmcnt(6)
  v_mfma_f32_16x16x32_bf16 v[96:99], a[92:95], a[140:143], v[96:99]
  s_and_b32 s60, s36, 15
  s_lshr_b64 s[36:37], s[36:37], 4
  s_add_u32 s60, s60, s79
  v_mfma_f32_16x16x32_bf16 v[132:135], a[96:99], a[140:143], v[132:135]
  s_and_b32 s60, s60, 15
  s_mul_i32 s60, s60, s52
  s_add_u32 s60, s60, s78
  v_mfma_f32_16x16x32_bf16 v[168:171], a[100:103], a[140:143], v[168:171]
  s_cmp_ge_u32 s63, 12
  s_cselect_b32 s75, 196608, s62
  s_cselect_b32 s76, 1073741824, s60
  v_mfma_f32_16x16x32_bf16 v[100:103], a[92:95], a[144:147], v[100:103]
  s_add_u32 s62, s62, s74
  s_add_u32 s67, s67, 1
  s_and_b32 s67, s67, 3
  v_mfma_f32_16x16x32_bf16 v[136:139], a[96:99], a[144:147], v[136:139]
  s_cmp_eq_u32 s67, 3
  s_cselect_b32 s74, s73, s72
  v_mfma_f32_16x16x32_bf16 v[172:175], a[100:103], a[144:147], v[172:175]
  s_waitcnt lgkmcnt(0)
  s_barrier
  v_mfma_f32_16x16x32_bf16 v[104:107], a[92:95], a[148:151], v[104:107]
  s_add_u32 m0, s75, 0
  ds_read_b64_tr_b16 a[80:81], v45 offset:0
  ds_read_b64_tr_b16 a[82:83], v45 offset:4608
  v_mfma_f32_16x16x32_bf16 v[140:143], a[96:99], a[148:151], v[140:143]
  s_nop 0
  ds_read_b64_tr_b16 a[84:85], v45 offset:32
  ds_read_b64_tr_b16 a[86:87], v45 offset:4640
  v_mfma_f32_16x16x32_bf16 v[176:179], a[100:103], a[148:151], v[176:179]
  s_nop 0
  ds_read_b64_tr_b16 a[88:89], v46 offset:0
  ds_read_b64_tr_b16 a[90:91], v46 offset:4608
  v_mfma_f32_16x16x32_bf16 v[108:111], a[92:95], a[152:155], v[108:111]
  ds_read_b128 a[104:107], v41 offset:0
  v_mfma_f32_16x16x32_bf16 v[144:147], a[96:99], a[152:155], v[144:147]
  ds_read_b128 a[108:111], v41 offset:1024
  v_mfma_f32_16x16x32_bf16 v[112:115], a[92:95], a[156:159], v[112:115]
  ds_read_b128 a[112:115], v41 offset:2048
  v_mfma_f32_16x16x32_bf16 v[148:151], a[96:99], a[156:159], v[148:151]
  buffer_load_dwordx4 v32, s[8:11], s76 offen offset:0  lds
  v_mfma_f32_16x16x32_bf16 v[116:119], a[92:95], a[160:163], v[116:119]
  s_add_u32 s63, s63, 1
  ds_read_b128 a[116:119], v42 offset:0
  v_mfma_f32_16x16x32_bf16 v[152:155], a[96:99], a[160:163], v[152:155]
  ds_read_b128 a[120:123], v42 offset:1024
  v_mfma_f32_16x16x32_bf16 v[120:123], a[92:95], a[164:167], v[120:123]
  buffer_load_dwordx4 v33, s[8:11], s76 offen offset:1024  lds
  v_mfma_f32_16x16x32_bf16 v[156:159], a[96:99], a[164:167], v[156:159]
  ds_read_b128 a[124:127], v43 offset:0
  v_mfma_f32_16x16x32_bf16 v[124:127], a[92:95], a[168:171], v[124:127]
  ds_read_b128 a[128:131], v43 offset:1024
  v_mfma_f32_16x16x32_bf16 v[160:163], a[96:99], a[168:171], v[160:163]
  buffer_load_dwordx4 v34, s[8:11], s76 offen offset:2048  lds
  v_mfma_f32_16x16x32_bf16 v[128:131], a[92:95], a[172:175], v[128:131]
  ds_read_b128 a[132:135], v44 offset:0
  v_mfma_f32_16x16x32_bf16 v[164:167], a[96:99], a[172:175], v[164:167]
  ds_read_b128 a[136:139], v44 offset:1024
L_gw:
  s_waitcnt lgkmcnt(6)
  v_mfma_f32_16x16x32_bf16 v[96:99], a[80:83], a[104:107], v[96:99]
  s_nop 0
  ds_read_b64_tr_b16 a[92:93], v45 offset:9216
  ds_read_b64_tr_b16 a[94:95], v45 offset:13824
  v_mfma_f32_16x16x32_bf16 v[132:135], a[84:87], a[104:107], v[132:135]
  s_nop 0
  ds_read_b64_tr_b16 a[96:97], v45 offset:9248
  ds_read_b64_tr_b16 a[98:99], v45 offset:13856
  v_mfma_f32_16x16x32_bf16 v[168:171], a[88:91], a[104:107], v[168:171]
  s_nop 0
  ds_read_b64_tr_b16 a[100:101], v46 offset:9216
  ds_read_b64_tr_b16 a[102:103], v46 offset:13824
  v_mfma_f32_16x16x32_bf16 v[100:103], a[80:83], a[108:111], v[100:103]
  ds_read_b128 a[140:143], v41 offset:9216
  v_add_u32 v45, s74, v45
  v_mfma_f32_16x16x32_bf16 v[136:139], a[84:87], a[108:111], v[136:139]
  buffer_load_dwordx4 v35, s[8:11], s76 offen offset:3072  lds
  v_mfma_f32_16x16x32_bf16 v[172:175], a[88:91], a[108:111], v[172:175]
  s_add_u32 m0, s75, 4096
  ds_read_b128 a[144:147], v41 offset:10240
  v_add_u32 v46, s74, v46
  v_mfma_f32_16x16x32_bf16 v[104:107], a[80:83], a[112:115], v[104:107]
  ds_read_b128 a[148:151], v41 offset:11264
  v_add_u32 v41, s74, v41
  v_mfma_f32_16x16x32_bf16 v[140:143], a[84:87], a[112:115], v[140:143]
  buffer_load_dwordx4 v36, s[8:11], s76 offen offset:0  lds
  v_mfma_f32_16x16x32_bf16 v[176:179], a[88:91], a[112:115], v[176:179]
  s_waitcnt lgkmcnt(9)
  ds_read_b128 a[152:155], v42 offset:9216
  v_mfma_f32_16x16x32_bf16 v[108:111], a[80:83], a[116:119], v[108:111]
  ds_read_b128 a[156:159], v42 offset:10240
  v_add_u32 v42, s74, v42
  v_mfma_f32_16x16x32_bf16 v[144:147], a[84:87], a[116:119], v[144:147]
  buffer_load_dwordx4 v37, s[8:11], s76 offen offset:1024  lds
  v_mfma_f32_16x16x32_bf16 v[112:115], a[80:83], a[120:123], v[112:115]
  ds_read_b128 a[160:163], v43 offset:9216
  v_mfma_f32_16x16x32_bf16 v[148:151], a[84:87], a[120:123], v[148:151]
  ds_read_b128 a[164:167], v43 offset:10240
  v_add_u32 v43, s74, v43
  v_mfma_f32_16x16x32_bf16 v[116:119], a[80:83], a[124:127], v[116:119]
  buffer_load_dwordx4 v38, s[8:11], s76 offen offset:2048  lds
  v_mfma_f32_16x16x32_bf16 v[152:155], a[84:87], a[124:127], v[152:155]
  ds_read_b128 a[168:171], v44 offset:9216
  v_mfma_f32_16x16x32_bf16 v[120:123], a[80:83], a[128:131], v[120:123]
  ds_read_b128 a[172:175], v44 offset:10240
  v_add_u32 v44, s74, v44
  v_mfma_f32_16x16x32_bf16 v[156:159], a[84:87], a[128:131], v[156:159]
  buffer_load_dwordx4 v39, s[8:11], s76 offen offset:3072  lds
  v_mfma_f32_16x16x32_bf16 v[124:127], a[80:83], a[132:135], v[124:127]
  s_add_u32 m0, s75, 8192
  v_mfma_f32_16x16x32_bf16 v[160:163], a[84:87], a[132:135], v[160:163]
  v_mfma_f32_16x16x32_bf16 v[128:131], a[80:83], a[136:139], v[128:131]
  buffer_load_dwordx4 v40, s[8:11], s76 offen offset:0  lds
  v_mfma_f32_16x16x32_bf16 v[164:167], a[84:87], a[136:139], v[164:167]
  s_waitcnt lgkmcnt(6)
  v_mfma_f32_16x16x32_bf16 v[96:99], a[92:95], a[140:143], v[96:99]
  s_and_b32 s60, s36, 15
  s_lshr_b64 s[36:37], s[36:37], 4
  s_add_u32 s60, s60, s79
  v_mfma_f32_16x16x32_bf16 v[132:135], a[96:99], a[140:143], v[132:135]
  s_and_b32 s60, s60, 15
  s_mul_i32 s60, s60, s52
  s_add_u32 s60, s60, s78
  v_mfma_f32_16x16x32_bf16 v[168:171], a[100:103], a[140:143], v[168:171]
  s_cmp_ge_u32 s63, 12
  s_cselect_b32 s75, 196608, s62
  s_cselect_b32 s76, 1073741824, s60
  v_mfma_f32_16x16x32_bf16 v[100:103], a[92:95], a[144:147], v[100:103]
  s_add_u32 s62, s62, s74
  s_add_u32 s67, s67, 1
  s_and_b32 s67, s67, 3
  v_mfma_f32_16x16x32_bf16 v[136:139], a[96:99], a[144:147], v[136:139]
  s_cmp_eq_u32 s67, 3
  s_cselect_b32 s74, s73, s72
  s_bitcmp1_b32 s35, s63
  v_mfma_f32_16x16x32_bf16 v[172:175], a[100:103], a[144:147], v[172:175]
  s_waitcnt lgkmcnt(0)
  s_cbranch_scc1 L_hw
  s_waitcnt vmcnt(18)
L_hw:
  s_barrier
L_hcw:
  v_mfma_f32_16x16x32_bf16 v[104:107], a[92:95], a[148:151], v[104:107]
  s_add_u32 m0, s75, 0
  ds_read_b64_tr_b16 a[80:81], v45 offset:0
  ds_read_b64_tr_b16 a[82:83], v45 offset:4608
  v_mfma_f32_16x16x32_bf16 v[140:143], a[96:99], a[148:151], v[140:143]
  s_nop 0
  ds_read_b64_tr_b16 a[84:85], v45 offset:32
  ds_read_b64_tr_b16 a[86:87], v45 offset:4640
  v_mfma_f32_16x16x32_bf16 v[176:179], a[100:103], a[148:151], v[176:179]
  s_nop 0
  ds_read_b64_tr_b16 a[88:89], v46 offset:0
  ds_read_b64_tr_b16 a[90:91], v46 offset:4608
  v_mfma_f32_16x16x32_bf16 v[108:111], a[92:95], a[152:155], v[108:111]
  ds_read_b128 a[104:107], v41 offset:0
  v_mfma_f32_16x16x32_bf16 v[144:147], a[96:99], a[152:155], v[144:147]
  ds_read_b128 a[108:111], v41 offset:1024
  v_mfma_f32_16x16x32_bf16 v[112:115], a[92:95], a[156:159], v[112:115]
  ds_read_b128 a[112:115], v41 offset:2048
  v_mfma_f32_16x16x32_bf16 v[148:151], a[96:99], a[156:159], v[148:151]
  buffer_load_dwordx4 v32, s[8:11], s76 offen offset:0  lds
  v_mfma_f32_16x16x32_bf16 v[116:119], a[92:95], a[160:163], v[116:119]
  s_add_u32 s63, s63, 1
  ds_read_b128 a[116:119], v42 offset:0
  s_cmp_lt_u32 s63, 12
  v_mfma_f32_16x16x32_bf16 v[152:155], a[96:99], a[160:163], v[152:155]
  ds_read_b128 a[120:123], v42 offset:1024
  v_mfma_f32_16x16x32_bf16 v[120:123], a[92:95], a[164:167], v[120:123]
  buffer_load_dwordx4 v33, s[8:11], s76 offen offset:1024  lds
  v_mfma_f32_16x16x32_bf16 v[156:159], a[96:99], a[164:167], v[156:159]
  ds_read_b128 a[124:127], v43 offset:0
  v_mfma_f32_16x16x32_bf16 v[124:127], a[92:95], a[168:171], v[124:127]
  ds_read_b128 a[128:131], v43 offset:1024
  v_mfma_f32_16x16x32_bf16 v[160:163], a[96:99], a[168:171], v[160:163]
  buffer_load_dwordx4 v34, s[8:11], s76 offen offset:2048  lds
  v_mfma_f32_16x16x32_bf16 v[128:131], a[92:95], a[172:175], v[128:131]
  ds_read_b128 a[132:135], v44 offset:0
  v_mfma_f32_16x16x32_bf16 v[164:167], a[96:99], a[172:175], v[164:167]
  ds_read_b128 a[136:139], v44 offset:1024
  s_cbranch_scc1 L_gw
  s_waitcnt lgkmcnt(6)
  v_mfma_f32_16x16x32_bf16 v[96:99], a[80:83], a[104:107], v[96:99]
  s_nop 0
  ds_read_b64_tr_b16 a[92:93], v45 offset:9216
  ds_read_b64_tr_b16 a[94:95], v45 offset:13824
  v_mfma_f32_16x16x32_bf16 v[132:135], a[84:87], a[104:107], v[132:135]
  s_nop 0
  ds_read_b64_tr_b16 a[96:97], v45 offset:9248
  ds_read_b64_tr_b16 a[98:99], v45 offset:13856
  v_mfma_f32_16x16x32_bf16 v[168:171], a[88:91], a[104:107], v[168:171]
  s_nop 0
  ds_read_b64_tr_b16 a[100:101], v46 offset:9216
  ds_read_b64_tr_b16 a[102:103], v46 offset:13824
  v_mfma_f32_16x16x32_bf16 v[100:103], a[80:83], a[108:111], v[100:103]
  ds_read_b128 a[140:143], v41 offset:9216
  v_add_u32 v45, s74, v45
  v_mfma_f32_16x16x32_bf16 v[136:139], a[84:87], a[108:111], v[136:139]
  buffer_load_dwordx4 v35, s[8:11], s76 offen offset:3072  lds
  v_mfma_f32_16x16x32_bf16 v[172:175], a[88:91], a[108:111], v[172:175]
  s_add_u32 m0, s75, 4096
  ds_read_b128 a[144:147], v41 offset:10240
  v_add_u32 v46, s74, v46
  v_mfma_f32_16x16x32_bf16 v[104:107], a[80:83], a[112:115], v[104:107]
  ds_read_b128 a[148:151], v41 offset:11264
  v_add_u32 v41, s74, v41
  v_mfma_f32_16x16x32_bf16 v[140:143], a[84:87], a[112:115], v[140:143]
  buffer_load_dwordx4 v36, s[8:11], s76 offen offset:0  lds
  v_mfma_f32_16x16x32_bf16 v[176:179], a[88:91], a[112:115], v[176:179]
  s_waitcnt lgkmcnt(9)
  ds_read_b128 a[152:155], v42 offset:9216
  v_mfma_f32_16x16x32_bf16 v[108:111], a[80:83], a[116:119], v[108:111]
  ds_read_b128 a[156:159], v42 offset:10240
  v_add_u32 v42, s74, v42
  v_mfma_f32_16x16x32_bf16 v[144:147], a[84:87], a[116:119], v[144:147]
  buffer_load_dwordx4 v37, s[8:11], s76 offen offset:1024  lds
  v_mfma_f32_16x16x32_bf16 v[112:115], a[80:83], a[120:123], v[112:115]
  ds_read_b128 a[160:163], v43 offset:9216
  v_mfma_f32_16x16x32_bf16 v[148:151], a[84:87], a[120:123], v[148:151]
  ds_read_b128 a[164:167], v43 offset:10240
  v_add_u32 v43, s74, v43
  v_mfma_f32_16x16x32_bf16 v[116:119], a[80:83], a[124:127], v[116:119]
  buffer_load_dwordx4 v38, s[8:11], s76 offen offset:2048  lds
  v_mfma_f32_16x16x32_bf16 v[152:155], a[84:87], a[124:127], v[152:155]
  ds_read_b128 a[168:171], v44 offset:9216
  v_mfma_f32_16x16x32_bf16 v[120:123], a[80:83], a[128:131], v[120:123]
  ds_read_b128 a[172:175], v44 offset:10240
  v_add_u32 v44, s74, v44
  v_mfma_f32_16x16x32_bf16 v[156:159], a[84:87], a[128:131], v[156:159]
  buffer_load_dwordx4 v39, s[8:11], s76 offen offset:3072  lds
  v_mfma_f32_16x16x32_bf16 v[124:127], a[80:83], a[132:135], v[124:127]
  s_add_u32 m0, s75, 8192
  v_mfma_f32_16x16x32_bf16 v[160:163], a[84:87], a[132:135], v[160:163]
  v_mfma_f32_16x16x32_bf16 v[128:131], a[80:83], a[136:139], v[128:131]
  buffer_load_dwordx4 v40, s[8:11], s76 offen offset:0  lds
  v_mfma_f32_16x16x32_bf16 v[164:167], a[84:87], a[136:139], v[164:167]
  s_waitcnt lgkmcnt(6)
  v_mfma_f32_16x16x32_bf16 v[96:99], a[92:95], a[140:143], v[96:99]
  s_add_u32 s67, s67, 1
  s_and_b32 s67, s67, 3
  s_cmp_eq_u32 s67, 3
  v_mfma_f32_16x16x32_bf16 v[132:135], a[96:99], a[140:143], v[132:135]
  s_cselect_b32 s74, s73, s72
  v_mfma_f32_16x16x32_bf16 v[168:171], a[100:103], a[140:143], v[168:171]
  v_mfma_f32_16x16x32_bf16 v[100:103], a[92:95], a[144:147], v[100:103]
  v_mfma_f32_16x16x32_bf16 v[136:139], a[96:99], a[144:147], v[136:139]
  v_mfma_f32_16x16x32_bf16 v[172:175], a[100:103], a[144:147], v[172:175]
  s_waitcnt vmcnt(18)
  s_waitcnt lgkmcnt(0)
  s_barrier
  v_mfma_f32_16x16x32_bf16 v[104:107], a[92:95], a[148:151], v[104:107]
  s_nop 0
  ds_read_b64_tr_b16 a[80:81], v45 offset:0
  ds_read_b64_tr_b16 a[82:83], v45 offset:4608
  v_mfma_f32_16x16x32_bf16 v[140:143], a[96:99], a[148:151], v[140:143]
  s_nop 0
  ds_read_b64_tr_b16 a[84:85], v45 offset:32
  ds_read_b64_tr_b16 a[86:87], v45 offset:4640
  v_mfma_f32_16x16x32_bf16 v[176:179], a[100:103], a[148:151], v[176:179]
  s_nop 0
  ds_read_b64_tr_b16 a[88:89], v46 offset:0
  ds_read_b64_tr_b16 a[90:91], v46 offset:4608
  v_mfma_f32_16x16x32_bf16 v[108:111], a[92:95], a[152:155], v[108:111]
  ds_read_b128 a[104:107], v41 offset:0
  v_mfma_f32_16x16x32_bf16 v[144:147], a[96:99], a[152:155], v[144:147]
  ds_read_b128 a[108:111], v41 offset:1024
  v_mfma_f32_16x16x32_bf16 v[112:115], a[92:95], a[156:159], v[112:115]
  ds_read_b128 a[112:115], v41 offset:2048
  v_mfma_f32_16x16x32_bf16 v[148:151], a[96:99], a[156:159], v[148:151]
  v_mfma_f32_16x16x32_bf16 v[116:119], a[92:95], a[160:163], v[116:119]
  s_add_u32 s63, s63, 1
  ds_read_b128 a[116:119], v42 offset:0
  v_mfma_f32_16x16x32_bf16 v[152:155], a[96:99], a[160:163], v[152:155]
  ds_read_b128 a[120:123], v42 offset:1024
  v_mfma_f32_16x16x32_bf16 v[120:123], a[92:95], a[164:167], v[120:123]
  v_mfma_f32_16x16x32_bf16 v[156:159], a[96:99], a[164:167], v[156:159]
  ds_read_b128 a[124:127], v43 offset:0
  v_mfma_f32_16x16x32_bf16 v[124:127], a[92:95], a[168:171], v[124:127]
  ds_read_b128 a[128:131], v43 offset:1024
  v_mfma_f32_16x16x32_bf16 v[160:163], a[96:99], a[168:171], v[160:163]
  v_mfma_f32_16x16x32_bf16 v[128:131], a[92:95], a[172:175], v[128:131]
  ds_read_b128 a[132:135], v44 offset:0
  v_mfma_f32_16x16x32_bf16 v[164:167], a[96:99], a[172:175], v[164:167]
  ds_read_b128 a[136:139], v44 offset:1024
  s_waitcnt lgkmcnt(6)
  v_mfma_f32_16x16x32_bf16 v[96:99], a[80:83], a[104:107], v[96:99]
  s_nop 0
  ds_read_b64_tr_b16 a[92:93], v45 offset:9216
  ds_read_b64_tr_b16 a[94:95], v45 offset:13824
  v_mfma_f32_16x16x32_bf16 v[132:135], a[84:87], a[104:107], v[132:135]
  s_nop 0
  ds_read_b64_tr_b16 a[96:97], v45 offset:9248
  ds_read_b64_tr_b16 a[98:99], v45 offset:13856
  v_mfma_f32_16x16x32_bf16 v[168:171], a[88:91], a[104:107], v[168:171]
  s_nop 0
  ds_read_b64_tr_b16 a[100:101], v46 offset:9216
  ds_read_b64_tr_b16 a[102:103], v46 offset:13824
  v_mfma_f32_16x16x32_bf16 v[100:103], a[80:83], a[108:111], v[100:103]
  ds_read_b128 a[140:143], v41 offset:9216
  v_add_u32 v45, s74, v45
  v_mfma_f32_16x16x32_bf16 v[136:139], a[84:87], a[108:111], v[136:139]
  v_add_u32 v46, s74, v46
  v_mfma_f32_16x16x32_bf16 v[172:175], a[88:91], a[108:111], v[172:175]
  ds_read_b128 a[144:147], v41 offset:10240
  v_mfma_f32_16x16x32_bf16 v[104:107], a[80:83], a[112:115], v[104:107]
  ds_read_b128 a[148:151], v41 offset:11264
  v_add_u32 v41, s74, v41
  v_mfma_f32_16x16x32_bf16 v[140:143], a[84:87], a[112:115], v[140:143]
  s_waitcnt lgkmcnt(9)
  v_mfma_f32_16x16x32_bf16 v[176:179], a[88:91], a[112:115], v[176:179]
  ds_read_b128 a[152:155], v42 offset:9216
  v_mfma_f32_16x16x32_bf16 v[108:111], a[80:83], a[116:119], v[108:111]
  ds_read_b128 a[156:159], v42 offset:10240
  v_add_u32 v42, s74, v42
  v_mfma_f32_16x16x32_bf16 v[144:147], a[84:87], a[116:119], v[144:147]
  v_mfma_f32_16x16x32_bf16 v[112:115], a[80:83], a[120:123], v[112:115]
  ds_read_b128 a[160:163], v43 offset:9216
  v_mfma_f32_16x16x32_bf16 v[148:151], a[84:87], a[120:123], v[148:151]
  ds_read_b128 a[164:167], v43 offset:10240
  v_add_u32 v43, s74, v43
  v_mfma_f32_16x16x32_bf16 v[116:119], a[80:83], a[124:127], v[116:119]
  v_mfma_f32_16x16x32_bf16 v[152:155], a[84:87], a[124:127], v[152:155]
  ds_read_b128 a[168:171], v44 offset:9216
  v_mfma_f32_16x16x32_bf16 v[120:123], a[80:83], a[128:131], v[120:123]
  ds_read_b128 a[172:175], v44 offset:10240
  v_add_u32 v44, s74, v44
  v_mfma_f32_16x16x32_bf16 v[156:159], a[84:87], a[128:131], v[156:159]
  v_mfma_f32_16x16x32_bf16 v[124:127], a[80:83], a[132:135], v[124:127]
  v_mfma_f32_16x16x32_bf16 v[160:163], a[84:87], a[132:135], v[160:163]
  v_mfma_f32_16x16x32_bf16 v[128:131], a[80:83], a[136:139], v[128:131]
  v_mfma_f32_16x16x32_bf16 v[164:167], a[84:87], a[136:139], v[164:167]
  s_waitcnt lgkmcnt(6)
  v_mfma_f32_16x16x32_bf16 v[96:99], a[92:95], a[140:143], v[96:99]
  s_add_u32 s67, s67, 1
  s_and_b32 s67, s67, 3
  s_cmp_eq_u32 s67, 3
  v_mfma_f32_16x16x32_bf16 v[132:135], a[96:99], a[140:143], v[132:135]
  s_cselect_b32 s74, s73, s72
  v_mfma_f32_16x16x32_bf16 v[168:171], a[100:103], a[140:143], v[168:171]
  v_mfma_f32_16x16x32_bf16 v[100:103], a[92:95], a[144:147], v[100:103]
  v_mfma_f32_16x16x32_bf16 v[136:139], a[96:99], a[144:147], v[136:139]
  v_mfma_f32_16x16x32_bf16 v[172:175], a[100:103], a[144:147], v[172:175]
  s_waitcnt vmcnt(9)
  s_waitcnt lgkmcnt(0)
  s_barrier
  v_mfma_f32_16x16x32_bf16 v[104:107], a[92:95], a[148:151], v[104:107]
  s_nop 0
  ds_read_b64_tr_b16 a[80:81], v45 offset:0
  ds_read_b64_tr_b16 a[82:83], v45 offset:4608
  v_mfma_f32_16x16x32_bf16 v[140:143], a[96:99], a[148:151], v[140:143]
  s_nop 0
  ds_read_b64_tr_b16 a[84:85], v45 offset:32
  ds_read_b64_tr_b16 a[86:87], v45 offset:4640
  v_mfma_f32_16x16x32_bf16 v[176:179], a[100:103], a[148:151], v[176:179]
  s_nop 0
  ds_read_b64_tr_b16 a[88:89], v46 offset:0
  ds_read_b64_tr_b16 a[90:91], v46 offset:4608
  v_mfma_f32_16x16x32_bf16 v[108:111], a[92:95], a[152:155], v[108:111]
  ds_read_b128 a[104:107], v41 offset:0
  v_mfma_f32_16x16x32_bf16 v[144:147], a[96:99], a[152:155], v[144:147]
  ds_read_b128 a[108:111], v41 offset:1024
  v_mfma_f32_16x16x32_bf16 v[112:115], a[92:95], a[156:159], v[112:115]
  ds_read_b128 a[112:115], v41 offset:2048
  v_mfma_f32_16x16x32_bf16 v[148:151], a[96:99], a[156:159], v[148:151]
  v_mfma_f32_16x16x32_bf16 v[116:119], a[92:95], a[160:163], v[116:119]
  s_add_u32 s63, s63, 1
  ds_read_b128 a[116:119], v42 offset:0
  v_mfma_f32_16x16x32_bf16 v[152:155], a[96:99], a[160:163], v[152:155]
  ds_read_b128 a[120:123], v42 offset:1024
  v_mfma_f32_16x16x32_bf16 v[120:123], a[92:95], a[164:167], v[120:123]
  v_mfma_f32_16x16x32_bf16 v[156:159], a[96:99], a[164:167], v[156:159]
  ds_read_b128 a[124:127], v43 offset:0
  v_mfma_f32_16x16x32_bf16 v[124:127], a[92:95], a[168:171], v[124:127]
  ds_read_b128 a[128:131], v43 offset:1024
  v_mfma_f32_16x16x32_bf16 v[160:163], a[96:99], a[168:171], v[160:163]
  v_mfma_f32_16x16x32_bf16 v[128:131], a[92:95], a[172:175], v[128:131]
  ds_read_b128 a[132:135], v44 offset:0
  v_mfma_f32_16x16x32_bf16 v[164:167], a[96:99], a[172:175], v[164:167]
  ds_read_b128 a[136:139], v44 offset:1024
  s_waitcnt lgkmcnt(6)
  v_mfma_f32_16x16x32_bf16 v[96:99], a[80:83], a[104:107], v[96:99]
  s_nop 0
  ds_read_b64_tr_b16 a[92:93], v45 offset:9216
  ds_read_b64_tr_b16 a[94:95], v45 offset:13824
  v_mfma_f32_16x16x32_bf16 v[132:135], a[84:87], a[104:107], v[132:135]
  s_nop 0
  ds_read_b64_tr_b16 a[96:97], v45 offset:9248
  ds_read_b64_tr_b16 a[98:99], v45 offset:13856
  v_mfma_f32_16x16x32_bf16 v[168:171], a[88:91], a[104:107], v[168:171]
  s_nop 0
  ds_read_b64_tr_b16 a[100:101], v46 offset:9216
  ds_read_b64_tr_b16 a[102:103], v46 offset:13824
  v_mfma_f32_16x16x32_bf16 v[100:103], a[80:83], a[108:111], v[100:103]
  ds_read_b128 a[140:143], v41 offset:9216
  v_add_u32 v45, s74, v45
  v_mfma_f32_16x16x32_bf16 v[136:139], a[84:87], a[108:111], v[136:139]
  v_add_u32 v46, s74, v46
  v_mfma_f32_16x16x32_bf16 v[172:175], a[88:91], a[108:111], v[172:175]
  ds_read_b128 a[144:147], v41 offset:10240
  v_mfma_f32_16x16x32_bf16 v[104:107], a[80:83], a[112:115], v[104:107]
  ds_read_b128 a[148:151], v41 offset:11264
  v_add_u32 v41, s74, v41
  v_mfma_f32_16x16x32_bf16 v[140:143], a[84:87], a[112:115], v[140:143]
  s_waitcnt lgkmcnt(9)
  v_mfma_f32_16x16x32_bf16 v[176:179], a[88:91], a[112:115], v[176:179]
  ds_read_b128 a[152:155], v42 offset:9216
  v_mfma_f32_16x16x32_bf16 v[108:111], a[80:83], a[116:119], v[108:111]
  ds_read_b128 a[156:159], v42 offset:10240
  v_add_u32 v42, s74, v42
  v_mfma_f32_16x16x32_bf16 v[144:147], a[84:87], a[116:119], v[144:147]
  v_mfma_f32_16x16x32_bf16 v[112:115], a[80:83], a[120:123], v[112:115]
  ds_read_b128 a[160:163], v43 offset:9216
  v_mfma_f32_16x16x32_bf16 v[148:151], a[84:87], a[120:123], v[148:151]
  ds_read_b128 a[164:167], v43 offset:10240
  v_add_u32 v43, s74, v43
  v_mfma_f32_16x16x32_bf16 v[116:119], a[80:83], a[124:127], v[116:119]
  v_mfma_f32_16x16x32_bf16 v[152:155], a[84:87], a[124:127], v[152:155]
  ds_read_b128 a[168:171], v44 offset:9216
  v_mfma_f32_16x16x32_bf16 v[120:123], a[80:83], a[128:131], v[120:123]
  ds_read_b128 a[172:175], v44 offset:10240
  v_add_u32 v44, s74, v44
  v_mfma_f32_16x16x32_bf16 v[156:159], a[84:87], a[128:131], v[156:159]
  v_mfma_f32_16x16x32_bf16 v[124:127], a[80:83], a[132:135], v[124:127]
  v_mfma_f32_16x16x32_bf16 v[160:163], a[84:87], a[132:135], v[160:163]
  v_mfma_f32_16x16x32_bf16 v[128:131], a[80:83], a[136:139], v[128:131]
  v_mfma_f32_16x16x32_bf16 v[164:167], a[84:87], a[136:139], v[164:167]
  s_waitcnt lgkmcnt(6)
  v_mfma_f32_16x16x32_bf16 v[96:99], a[92:95], a[140:143], v[96:99]
  s_add_u32 s67, s67, 1
  s_and_b32 s67, s67, 3
  s_cmp_eq_u32 s67, 3
  v_mfma_f32_16x16x32_bf16 v[132:135], a[96:99], a[140:143], v[132:135]
  s_cselect_b32 s74, s73, s72
  v_mfma_f32_16x16x32_bf16 v[168:171], a[100:103], a[140:143], v[168:171]
  v_mfma_f32_16x16x32_bf16 v[100:103], a[92:95], a[144:147], v[100:103]
  v_mfma_f32_16x16x32_bf16 v[136:139], a[96:99], a[144:147], v[136:139]
  v_mfma_f32_16x16x32_bf16 v[172:175], a[100:103], a[144:147], v[172:175]
  s_waitcnt vmcnt(0)
  s_waitcnt lgkmcnt(0)
  s_barrier
  v_mfma_f32_16x16x32_bf16 v[104:107], a[92:95], a[148:151], v[104:107]
  s_nop 0
  ds_read_b64_tr_b16 a[80:81], v45 offset:0
  ds_read_b64_tr_b16 a[82:83], v45 offset:4608
  v_mfma_f32_16x16x32_bf16 v[140:143], a[96:99], a[148:151], v[140:143]
  s_nop 0
  ds_read_b64_tr_b16 a[84:85], v45 offset:32
  ds_read_b64_tr_b16 a[86:87], v45 offset:4640
  v_mfma_f32_16x16x32_bf16 v[176:179], a[100:103], a[148:151], v[176:179]
  s_nop 0
  ds_read_b64_tr_b16 a[88:89], v46 offset:0
  ds_read_b64_tr_b16 a[90:91], v46 offset:4608
  v_mfma_f32_16x16x32_bf16 v[108:111], a[92:95], a[152:155], v[108:111]
  ds_read_b128 a[104:107], v41 offset:0
  v_mfma_f32_16x16x32_bf16 v[144:147], a[96:99], a[152:155], v[144:147]
  ds_read_b128 a[108:111], v41 offset:1024
  v_mfma_f32_16x16x32_bf16 v[112:115], a[92:95], a[156:159], v[112:115]
  ds_read_b128 a[112:115], v41 offset:2048
  v_mfma_f32_16x16x32_bf16 v[148:151], a[96:99], a[156:159], v[148:151]
  v_mfma_f32_16x16x32_bf16 v[116:119], a[92:95], a[160:163], v[116:119]
  s_add_u32 s63, s63, 1
  ds_read_b128 a[116:119], v42 offset:0
  v_mfma_f32_16x16x32_bf16 v[152:155], a[96:99], a[160:163], v[152:155]
  ds_read_b128 a[120:123], v42 offset:1024
  v_mfma_f32_16x16x32_bf16 v[120:123], a[92:95], a[164:167], v[120:123]
  v_mfma_f32_16x16x32_bf16 v[156:159], a[96:99], a[164:167], v[156:159]
  ds_read_b128 a[124:127], v43 offset:0
  v_mfma_f32_16x16x32_bf16 v[124:127], a[92:95], a[168:171], v[124:127]
  ds_read_b128 a[128:131], v43 offset:1024
  v_mfma_f32_16x16x32_bf16 v[160:163], a[96:99], a[168:171], v[160:163]
  v_mfma_f32_16x16x32_bf16 v[128:131], a[92:95], a[172:175], v[128:131]
  ds_read_b128 a[132:135], v44 offset:0
  v_mfma_f32_16x16x32_bf16 v[164:167], a[96:99], a[172:175], v[164:167]
  ds_read_b128 a[136:139], v44 offset:1024
  s_waitcnt lgkmcnt(6)
  v_mfma_f32_16x16x32_bf16 v[96:99], a[80:83], a[104:107], v[96:99]
  s_nop 0
  ds_read_b64_tr_b16 a[92:93], v45 offset:9216
  ds_read_b64_tr_b16 a[94:95], v45 offset:13824
  v_mfma_f32_16x16x32_bf16 v[132:135], a[84:87], a[104:107], v[132:135]
  s_nop 0
  ds_read_b64_tr_b16 a[96:97], v45 offset:9248
  ds_read_b64_tr_b16 a[98:99], v45 offset:13856
  v_mfma_f32_16x16x32_bf16 v[168:171], a[88:91], a[104:107], v[168:171]
  s_nop 0
  ds_read_b64_tr_b16 a[100:101], v46 offset:9216
  ds_read_b64_tr_b16 a[102:103], v46 offset:13824
  v_mfma_f32_16x16x32_bf16 v[100:103], a[80:83], a[108:111], v[100:103]
  ds_read_b128 a[140:143], v41 offset:9216
  v_add_u32 v45, s74, v45
  v_mfma_f32_16x16x32_bf16 v[136:139], a[84:87], a[108:111], v[136:139]
  v_add_u32 v46, s74, v46
  v_mfma_f32_16x16x32_bf16 v[172:175], a[88:91], a[108:111], v[172:175]
  ds_read_b128 a[144:147], v41 offset:10240
  v_mfma_f32_16x16x32_bf16 v[104:107], a[80:83], a[112:115], v[104:107]
  ds_read_b128 a[148:151], v41 offset:11264
  v_add_u32 v41, s74, v41
  v_mfma_f32_16x16x32_bf16 v[140:143], a[84:87], a[112:115], v[140:143]
  s_waitcnt lgkmcnt(9)
  v_mfma_f32_16x16x32_bf16 v[176:179], a[88:91], a[112:115], v[176:179]
  ds_read_b128 a[152:155], v42 offset:9216
  v_mfma_f32_16x16x32_bf16 v[108:111], a[80:83], a[116:119], v[108:111]
  ds_read_b128 a[156:159], v42 offset:10240
  v_add_u32 v42, s74, v42
  v_mfma_f32_16x16x32_bf16 v[144:147], a[84:87], a[116:119], v[144:147]
  v_mfma_f32_16x16x32_bf16 v[112:115], a[80:83], a[120:123], v[112:115]
  ds_read_b128 a[160:163], v43 offset:9216
  v_mfma_f32_16x16x32_bf16 v[148:151], a[84:87], a[120:123], v[148:151]
  ds_read_b128 a[164:167], v43 offset:10240
  v_add_u32 v43, s74, v43
  v_mfma_f32_16x16x32_bf16 v[116:119], a[80:83], a[124:127], v[116:119]
  v_mfma_f32_16x16x32_bf16 v[152:155], a[84:87], a[124:127], v[152:155]
  ds_read_b128 a[168:171], v44 offset:9216
  v_mfma_f32_16x16x32_bf16 v[120:123], a[80:83], a[128:131], v[120:123]
  ds_read_b128 a[172:175], v44 offset:10240
  v_add_u32 v44, s74, v44
  v_mfma_f32_16x16x32_bf16 v[156:159], a[84:87], a[128:131], v[156:159]
  v_mfma_f32_16x16x32_bf16 v[124:127], a[80:83], a[132:135], v[124:127]
  v_mfma_f32_16x16x32_bf16 v[160:163], a[84:87], a[132:135], v[160:163]
  v_mfma_f32_16x16x32_bf16 v[128:131], a[80:83], a[136:139], v[128:131]
  v_mfma_f32_16x16x32_bf16 v[164:167], a[84:87], a[136:139], v[164:167]
  s_waitcnt lgkmcnt(6)
  v_mfma_f32_16x16x32_bf16 v[96:99], a[92:95], a[140:143], v[96:99]
  s_add_u32 s67, s67, 1
  s_and_b32 s67, s67, 3
  s_cmp_eq_u32 s67, 3
  v_mfma_f32_16x16x32_bf16 v[132:135], a[96:99], a[140:143], v[132:135]
  s_cselect_b32 s74, s73, s72
  v_mfma_f32_16x16x32_bf16 v[168:171], a[100:103], a[140:143], v[168:171]
  v_mfma_f32_16x16x32_bf16 v[100:103], a[92:95], a[144:147], v[100:103]
  v_mfma_f32_16x16x32_bf16 v[136:139], a[96:99], a[144:147], v[136:139]
  v_mfma_f32_16x16x32_bf16 v[172:175], a[100:103], a[144:147], v[172:175]
  s_waitcnt lgkmcnt(0)
  s_barrier
  v_mfma_f32_16x16x32_bf16 v[104:107], a[92:95], a[148:151], v[104:107]
  s_and_b32 s38, s3, 3
  s_lshl_b32 s60, s38, 4
  s_lshr_b32 s61, s3, 2
  v_mfma_f32_16x16x32_bf16 v[140:143], a[96:99], a[148:151], v[140:143]
  s_lshl_b32 s61, s61, 3
  s_add_u32 s61, s61, s5
  s_add_u32 s60, s60, s61
  v_mfma_f32_16x16x32_bf16 v[176:179], a[100:103], a[148:151], v[176:179]
  s_lshl_b32 s60, s60, 2
  s_add_u32 s60, s60, s4
  s_mul_i32 s60, s60, 41472
  v_mfma_f32_16x16x32_bf16 v[108:111], a[92:95], a[152:155], v[108:111]
  s_add_u32 s12, s82, 33554432
  s_addc_u32 s13, s83, 0
  s_mov_b32 s14, 10616832
  v_mfma_f32_16x16x32_bf16 v[144:147], a[96:99], a[152:155], v[144:147]
  s_mul_i32 s62, s28, 9216
  s_add_u32 s62, s62, s60
  s_lshl_b32 s63, s28, 1
  v_mfma_f32_16x16x32_bf16 v[112:115], a[92:95], a[156:159], v[112:115]
  s_cmp_eq_u32 s28, 0
  s_cselect_b32 s64, 3, 0
  s_cmp_lt_u32 s28, 2
  v_mfma_f32_16x16x32_bf16 v[148:151], a[96:99], a[156:159], v[148:151]
  s_cselect_b32 s65, 5, 2
  s_cmp_lt_u32 s28, 3
  s_cselect_b32 s66, 7, 4
  v_mfma_f32_16x16x32_bf16 v[116:119], a[92:95], a[160:163], v[116:119]
  v_mfma_f32_16x16x32_bf16 v[152:155], a[96:99], a[160:163], v[152:155]
  v_mfma_f32_16x16x32_bf16 v[120:123], a[92:95], a[164:167], v[120:123]
  v_mfma_f32_16x16x32_bf16 v[156:159], a[96:99], a[164:167], v[156:159]
  v_mfma_f32_16x16x32_bf16 v[124:127], a[92:95], a[168:171], v[124:127]
  v_mfma_f32_16x16x32_bf16 v[160:163], a[96:99], a[168:171], v[160:163]
  v_mfma_f32_16x16x32_bf16 v[128:131], a[92:95], a[172:175], v[128:131]
  v_mfma_f32_16x16x32_bf16 v[164:167], a[96:99], a[172:175], v[164:167]
L_ge:
  v_and_b32 v2, 63, v0
  v_lshlrev_b32 v3, 4, v2
  v_lshlrev_b32 v4, 3, v2
  s_and_b32 s38, s3, 3
  s_cmp_eq_u32 s38, s28
  s_cbranch_scc1 L_own
  v_cvt_pk_bf16_f32 v8, v96, v97
  v_cvt_pk_bf16_f32 v9, v98, v99
  v_cvt_pk_bf16_f32 v10, v132, v133
  v_cvt_pk_bf16_f32 v11, v134, v135
  s_lshl_b32 s38, s63, 10
  s_add_u32 s38, s38, s62
  buffer_store_dwordx4 v[8:11], v3, s[12:15], s38 offen offset:0 sc1
  v_cvt_pk_bf16_f32 v12, v100, v101
  v_cvt_pk_bf16_f32 v13, v102, v103
  v_cvt_pk_bf16_f32 v14, v136, v137
  v_cvt_pk_bf16_f32 v15, v138, v139
  s_lshl_b32 s38, s63, 10
  s_add_u32 s38, s38, s62
  buffer_store_dwordx4 v[12:15], v3, s[12:15], s38 offen offset:1024 sc1
  v_cvt_pk_bf16_f32 v16, v104, v105
  v_cvt_pk_bf16_f32 v17, v106, v107
  v_cvt_pk_bf16_f32 v18, v140, v141
  v_cvt_pk_bf16_f32 v19, v142, v143
  s_lshl_b32 s38, s63, 10
  s_add_u32 s38, s38, s62
  buffer_store_dwordx4 v[16:19], v3, s[12:15], s38 offen offset:2048 sc1
  v_cvt_pk_bf16_f32 v20, v108, v109
  v_cvt_pk_bf16_f32 v21, v110, v111
  v_cvt_pk_bf16_f32 v22, v144, v145
  v_cvt_pk_bf16_f32 v23, v146, v147
  s_lshl_b32 s38, s64, 10
  s_add_u32 s38, s38, s62
  buffer_store_dwordx4 v[20:23], v3, s[12:15], s38 offen offset:0 sc1
  v_cvt_pk_bf16_f32 v8, v112, v113
  v_cvt_pk_bf16_f32 v9, v114, v115
  v_cvt_pk_bf16_f32 v10, v148, v149
  v_cvt_pk_bf16_f32 v11, v150, v151
  s_lshl_b32 s38, s64, 10
  s_add_u32 s38, s38, s62
  buffer_store_dwordx4 v[8:11], v3, s[12:15], s38 offen offset:1024 sc1
  v_cvt_pk_bf16_f32 v12, v116, v117
  v_cvt_pk_bf16_f32 v13, v118, v119
  v_cvt_pk_bf16_f32 v14, v152, v153
  v_cvt_pk_bf16_f32 v15, v154, v155
  s_lshl_b32 s38, s65, 10
  s_add_u32 s38, s38, s62
  buffer_store_dwordx4 v[12:15], v3, s[12:15], s38 offen offset:0 sc1
  v_cvt_pk_bf16_f32 v16, v120, v121
  v_cvt_pk_bf16_f32 v17, v122, v123
  v_cvt_pk_bf16_f32 v18, v156, v157
  v_cvt_pk_bf16_f32 v19, v158, v159
  s_lshl_b32 s38, s65, 10
  s_add_u32 s38, s38, s62
  buffer_store_dwordx4 v[16:19], v3, s[12:15], s38 offen offset:1024 sc1
  v_cvt_pk_bf16_f32 v20, v124, v125
  v_cvt_pk_bf16_f32 v21, v126, v127
  v_cvt_pk_bf16_f32 v22, v160, v161
  v_cvt_pk_bf16_f32 v23, v162, v163
  s_lshl_b32 s38, s66, 10
  s_add_u32 s38, s38, s62
  buffer_store_dwordx4 v[20:23], v3, s[12:15], s38 offen offset:0 sc1
  v_cvt_pk_bf16_f32 v8, v128, v129
  v_cvt_pk_bf16_f32 v9, v130, v131
  v_cvt_pk_bf16_f32 v10, v164, v165
  v_cvt_pk_bf16_f32 v11, v166, v167
  s_lshl_b32 s38, s66, 10
  s_add_u32 s38, s38, s62
  buffer_store_dwordx4 v[8:11], v3, s[12:15], s38 offen offset:1024 sc1
  s_lshl_b32 s38, s63, 9
  s_add_u32 s38, s38, s60
  s_add_u32 s38, s38, 36864
  v_cvt_pk_bf16_f32 v24, v168, v169
  v_cvt_pk_bf16_f32 v25, v170, v171
  buffer_store_dwordx2 v[24:25], v4, s[12:15], s38 offen offset:0 sc1
  v_cvt_pk_bf16_f32 v26, v172, v173
  v_cvt_pk_bf16_f32 v27, v174, v175
  buffer_store_dwordx2 v[26:27], v4, s[12:15], s38 offen offset:512 sc1
  s_cmp_eq_u32 s28, 3
  s_cbranch_scc0 L_pe
  v_cvt_pk_bf16_f32 v28, v176, v177
  v_cvt_pk_bf16_f32 v29, v178, v179
  buffer_store_dwordx2 v[28:29], v4, s[12:15], s38 offen offset:1024 sc1
  s_branch L_pe
L_own:
  v_cvt_pk_bf16_f32 v8, v96, v97
  v_cvt_pk_bf16_f32 v9, v98, v99
  v_cvt_pk_bf16_f32 v10, v132, v133
  v_cvt_pk_bf16_f32 v11, v134, v135
  s_lshl_b32 s38, s63, 10
  v_add_u32 v5, s38, v3
  ds_write_b128 v5, v[8:11] offset:0
  v_cvt_pk_bf16_f32 v12, v100, v101
  v_cvt_pk_bf16_f32 v13, v102, v103
  v_cvt_pk_bf16_f32 v14, v136, v137
  v_cvt_pk_bf16_f32 v15, v138, v139
  ds_write_b128 v5, v[12:15] offset:1024
  v_cvt_pk_bf16_f32 v16, v104, v105
  v_cvt_pk_bf16_f32 v17, v106, v107
  v_cvt_pk_bf16_f32 v18, v140, v141
  v_cvt_pk_bf16_f32 v19, v142, v143
  ds_write_b128 v5, v[16:19] offset:2048
  v_cvt_pk_bf16_f32 v20, v108, v109
  v_cvt_pk_bf16_f32 v21, v110, v111
  v_cvt_pk_bf16_f32 v22, v144, v145
  v_cvt_pk_bf16_f32 v23, v146, v147
  s_lshl_b32 s38, s64, 10
  v_add_u32 v5, s38, v3
  ds_write_b128 v5, v[20:23] offset:0
  v_cvt_pk_bf16_f32 v8, v112, v113
  v_cvt_pk_bf16_f32 v9, v114, v115
  v_cvt_pk_bf16_f32 v10, v148, v149
  v_cvt_pk_bf16_f32 v11, v150, v151
  ds_write_b128 v5, v[8:11] offset:1024
  v_cvt_pk_bf16_f32 v12, v116, v117
  v_cvt_pk_bf16_f32 v13, v118, v119
  v_cvt_pk_bf16_f32 v14, v152, v153
  v_cvt_pk_bf16_f32 v15, v154, v155
  s_lshl_b32 s38, s65, 10
  v_add_u32 v5, s38, v3
  ds_write_b128 v5, v[12:15] offset:0
  v_cvt_pk_bf16_f32 v16, v120, v121
  v_cvt_pk_bf16_f32 v17, v122, v123
  v_cvt_pk_bf16_f32 v18, v156, v157
  v_cvt_pk_bf16_f32 v19, v158, v159
  ds_write_b128 v5, v[16:19] offset:1024
  v_cvt_pk_bf16_f32 v20, v124, v125
  v_cvt_pk_bf16_f32 v21, v126, v127
  v_cvt_pk_bf16_f32 v22, v160, v161
  v_cvt_pk_bf16_f32 v23, v162, v163
  s_lshl_b32 s38, s66, 10
  v_add_u32 v5, s38, v3
  ds_write_b128 v5, v[20:23] offset:0
  v_cvt_pk_bf16_f32 v8, v128, v129
  v_cvt_pk_bf16_f32 v9, v130, v131
  v_cvt_pk_bf16_f32 v10, v164, v165
  v_cvt_pk_bf16_f32 v11, v166, v167
  ds_write_b128 v5, v[8:11] offset:1024
  v_cvt_pk_bf16_f32 v24, v168, v169
  v_cvt_pk_bf16_f32 v25, v170, v171
  ds_write_b64 v4, v[24:25] offset:9216
  v_cvt_pk_bf16_f32 v26, v172, v173
  v_cvt_pk_bf16_f32 v27, v174, v175
  ds_write_b64 v4, v[26:27] offset:9728
  v_cvt_pk_bf16_f32 v28, v176, v177
  v_cvt_pk_bf16_f32 v29, v178, v179
  ds_write_b64 v4, v[28:29] offset:10240
L_pe:
  s_load_dwordx2 s[68:69], s[0:1], 80
  s_and_b32 s64, s3, 3
  s_lshl_b32 s65, s61, 2
  s_add_u32 s65, s65, s4
  s_mul_i32 s65, s65, 41472
  s_mul_i32 s66, s64, 9216
  s_add_u32 s66, s66, s65
  s_lshl_b32 s38, s28, 10
  s_add_u32 s66, s66, s38
  s_lshl_b32 s67, s64, 1
  s_add_u32 s67, s67, s28
  s_sub_u32 s67, s67, 1
  s_lshl_b32 s72, s67, 9
  s_add_u32 s72, s72, s65
  s_add_u32 s72, s72, 36864
  s_lshr_b32 s73, s3, 2
  s_mul_i32 s73, s73, 1152
  s_mul_i32 s38, s4, 288
  s_add_u32 s73, s73, s38
  s_mul_i32 s38, s5, 331776
  s_add_u32 s73, s73, s38
  s_mul_i32 s74, s67, 36864
  s_add_u32 s74, s74, s73
  s_add_u32 s74, s74, 256
  s_lshl_b32 s38, s64, 6
  s_add_u32 s73, s73, s38
  s_mul_i32 s38, s28, 36864
  s_add_u32 s73, s73, s38
  s_cmp_eq_u32 s28, 3
  s_cselect_b32 s75, 8, s67
  s_cmp_eq_u32 s75, s67
  s_cselect_b32 s72, s72, 1073741824
  s_cselect_b32 s74, s74, 1073741824
  v_and_b32 v5, 15, v2
  s_movk_i32 s38, 2304
  v_lshrrev_b32 v6, 4, v2
  v_lshlrev_b32 v6, 3, v6
  v_mad_u32_u24 v7, v5, s38, v6
  s_mov_b32 s70, 2654208
  s_mov_b32 s71, 0x20000
  s_add_u32 s76, s64, 1
  s_add_u32 s77, s64, 2
  s_add_u32 s78, s64, 3
  s_and_b32 s76, s76, 3
  s_and_b32 s77, s77, 3
  s_and_b32 s78, s78, 3
  s_mul_i32 s76, s76, 2654208
  s_mul_i32 s77, s77, 2654208
  s_mul_i32 s78, s78, 2654208
  v_add_u32 v9, 4096, v3
  s_lshl_b32 s38, s28, 10
  v_add_u32 v10, s38, v3
  s_lshl_b32 s38, s28, 9
  v_add_u32 v11, s38, v4
  s_waitcnt vmcnt(0) lgkmcnt(0)
  s_barrier
  s_cmp_eq_u32 s28, 0
  s_cbranch_scc0 L_n1
  s_lshr_b32 s38, s2, 2
  s_lshl_b32 s38, s38, 7
  s_add_u32 s38, s38, 50364416
  s_and_b32 s39, s2, 3
  s_lshl_b32 s39, s39, 2
  s_add_u32 s38, s38, s39
  v_mov_b32 v1, s38
  v_mov_b32 v2, s31
  s_mov_b64 exec, 1
  global_store_dword v1, v2, s[82:83] sc1
  s_mov_b64 exec, -1
  ds_read_b128 v[128:131], v3 offset:8192
  s_branch L_n2
L_n1:
  ds_read_b64 v[128:129], v11 offset:8704
L_n2:
  ds_read_b128 v[96:99], v10 offset:0
  ds_read_b128 v[112:115], v10 offset:4096
  s_lshr_b32 s38, s2, 2
  s_lshl_b32 s38, s38, 7
  s_add_u32 s38, s38, 50364416
  v_and_b32 v1, 3, v0
  v_lshl_add_u32 v1, v1, 2, s38
  s_mov_b32 s38, 0
L_p2:
  global_load_dword v2, v1, s[82:83] sc1
  s_add_u32 s38, s38, 1
  s_waitcnt vmcnt(0)
  v_cmp_ne_u32 vcc, s31, v2
  s_cmp_lt_u32 s38, 262144
  s_cbranch_vccz L_pd2
  s_cbranch_scc1 L_p2
L_pd2:
  s_add_u32 s38, s66, s76
  buffer_load_dwordx4 v[100:103], v3, s[12:15], s38 offen sc1
  s_add_u32 s38, s66, s77
  buffer_load_dwordx4 v[104:107], v3, s[12:15], s38 offen sc1
  s_add_u32 s38, s66, s78
  buffer_load_dwordx4 v[108:111], v3, s[12:15], s38 offen sc1
  s_add_u32 s38, s66, s76
  buffer_load_dwordx4 v[116:119], v9, s[12:15], s38 offen sc1
  s_add_u32 s38, s66, s77
  buffer_load_dwordx4 v[120:123], v9, s[12:15], s38 offen sc1
  s_add_u32 s38, s66, s78
  buffer_load_dwordx4 v[124:127], v9, s[12:15], s38 offen sc1
  s_cmp_eq_u32 s28, 0
  s_cbranch_scc0 L_r3
  s_add_u32 s66, s66, 8192
  s_add_u32 s38, s66, s76
  buffer_load_dwordx4 v[132:135], v3, s[12:15], s38 offen sc1
  s_add_u32 s38, s66, s77
  buffer_load_dwordx4 v[136:139], v3, s[12:15], s38 offen sc1
  s_add_u32 s38, s66, s78
  buffer_load_dwordx4 v[140:143], v3, s[12:15], s38 offen sc1
  s_branch L_r4
L_r3:
  s_add_u32 s38, s72, s76
  buffer_load_dwordx2 v[132:133], v4, s[12:15], s38 offen sc1
  s_add_u32 s38, s72, s77
  buffer_load_dwordx2 v[136:137], v4, s[12:15], s38 offen sc1
  s_add_u32 s38, s72, s78
  buffer_load_dwordx2 v[140:141], v4, s[12:15], s38 offen sc1
L_r4:
  s_waitcnt lgkmcnt(0)
  s_waitcnt vmcnt(6)
  v_lshlrev_b32 v80, 16, v96
  v_and_b32 v81, 0xffff0000, v96
  v_lshlrev_b32 v82, 16, v100
  v_and_b32 v83, 0xffff0000, v100
  v_pk_add_f32 v[80:81], v[80:81], v[82:83]
  v_lshlrev_b32 v82, 16, v104
  v_and_b32 v83, 0xffff0000, v104
  v_pk_add_f32 v[80:81], v[80:81], v[82:83]
  v_lshlrev_b32 v82, 16, v108
  v_and_b32 v83, 0xffff0000, v108
  v_pk_add_f32 v[80:81], v[80:81], v[82:83]
  v_cvt_pk_bf16_f32 v12, v80, v81
  v_lshlrev_b32 v80, 16, v97
  v_and_b32 v81, 0xffff0000, v97
  v_lshlrev_b32 v82, 16, v101
  v_and_b32 v83, 0xffff0000, v101
  v_pk_add_f32 v[80:81], v[80:81], v[82:83]
  v_lshlrev_b32 v82, 16, v105
  v_and_b32 v83, 0xffff0000, v105
  v_pk_add_f32 v[80:81], v[80:81], v[82:83]
  v_lshlrev_b32 v82, 16, v109
  v_and_b32 v83, 0xffff0000, v109
  v_pk_add_f32 v[80:81], v[80:81], v[82:83]
  v_cvt_pk_bf16_f32 v13, v80, v81
  v_lshlrev_b32 v80, 16, v98
  v_and_b32 v81, 0xffff0000, v98
  v_lshlrev_b32 v82, 16, v102
  v_and_b32 v83, 0xffff0000, v102
  v_pk_add_f32 v[80:81], v[80:81], v[82:83]
  v_lshlrev_b32 v82, 16, v106
  v_and_b32 v83, 0xffff0000, v106
  v_pk_add_f32 v[80:81], v[80:81], v[82:83]
  v_lshlrev_b32 v82, 16, v110
  v_and_b32 v83, 0xffff0000, v110
  v_pk_add_f32 v[80:81], v[80:81], v[82:83]
  v_cvt_pk_bf16_f32 v14, v80, v81
  v_lshlrev_b32 v80, 16, v99
  v_and_b32 v81, 0xffff0000, v99
  v_lshlrev_b32 v82, 16, v103
  v_and_b32 v83, 0xffff0000, v103
  v_pk_add_f32 v[80:81], v[80:81], v[82:83]
  v_lshlrev_b32 v82, 16, v107
  v_and_b32 v83, 0xffff0000, v107
  v_pk_add_f32 v[80:81], v[80:81], v[82:83]
  v_lshlrev_b32 v82, 16, v111
  v_and_b32 v83, 0xffff0000, v111
  v_pk_add_f32 v[80:81], v[80:81], v[82:83]
  v_cvt_pk_bf16_f32 v15, v80, v81
  buffer_store_dwordx2 v[12:13], v7, s[68:71], s73 offen
  buffer_store_dwordx2 v[14:15], v7, s[68:71], s73 offen offset:32
  s_add_u32 s73, s73, 147456
  s_waitcnt vmcnt(5)
  v_lshlrev_b32 v80, 16, v112
  v_and_b32 v81, 0xffff0000, v112
  v_lshlrev_b32 v82, 16, v116
  v_and_b32 v83, 0xffff0000, v116
  v_pk_add_f32 v[80:81], v[80:81], v[82:83]
  v_lshlrev_b32 v82, 16, v120
  v_and_b32 v83, 0xffff0000, v120
  v_pk_add_f32 v[80:81], v[80:81], v[82:83]
  v_lshlrev_b32 v82, 16, v124
  v_and_b32 v83, 0xffff0000, v124
  v_pk_add_f32 v[80:81], v[80:81], v[82:83]
  v_cvt_pk_bf16_f32 v16, v80, v81
  v_lshlrev_b32 v80, 16, v113
  v_and_b32 v81, 0xffff0000, v113
  v_lshlrev_b32 v82, 16, v117
  v_and_b32 v83, 0xffff0000, v117
  v_pk_add_f32 v[80:81], v[80:81], v[82:83]
  v_lshlrev_b32 v82, 16, v121
  v_and_b32 v83, 0xffff0000, v121
  v_pk_add_f32 v[80:81], v[80:81], v[82:83]
  v_lshlrev_b32 v82, 16, v125
  v_and_b32 v83, 0xffff0000, v125
  v_pk_add_f32 v[80:81], v[80:81], v[82:83]
  v_cvt_pk_bf16_f32 v17, v80, v81
  v_lshlrev_b32 v80, 16, v114
  v_and_b32 v81, 0xffff0000, v114
  v_lshlrev_b32 v82, 16, v118
  v_and_b32 v83, 0xffff0000, v118
  v_pk_add_f32 v[80:81], v[80:81], v[82:83]
  v_lshlrev_b32 v82, 16, v122
  v_and_b32 v83, 0xffff0000, v122
  v_pk_add_f32 v[80:81], v[80:81], v[82:83]
  v_lshlrev_b32 v82, 16, v126
  v_and_b32 v83, 0xffff0000, v126
  v_pk_add_f32 v[80:81], v[80:81], v[82:83]
  v_cvt_pk_bf16_f32 v18, v80, v81
  v_lshlrev_b32 v80, 16, v115
  v_and_b32 v81, 0xffff0000, v115
  v_lshlrev_b32 v82, 16, v119
  v_and_b32 v83, 0xffff0000, v119
  v_pk_add_f32 v[80:81], v[80:81], v[82:83]
  v_lshlrev_b32 v82, 16, v123
  v_and_b32 v83, 0xffff0000, v123
  v_pk_add_f32 v[80:81], v[80:81], v[82:83]
  v_lshlrev_b32 v82, 16, v127
  v_and_b32 v83, 0xffff0000, v127
  v_pk_add_f32 v[80:81], v[80:81], v[82:83]
  v_cvt_pk_bf16_f32 v19, v80, v81
  buffer_store_dwordx2 v[16:17], v7, s[68:71], s73 offen
  buffer_store_dwordx2 v[18:19], v7, s[68:71], s73 offen offset:32
  s_add_u32 s73, s73, 147456
  s_waitcnt vmcnt(4)
  s_cmp_eq_u32 s28, 0
  s_cbranch_scc0 L_r5
  v_lshlrev_b32 v80, 16, v128
  v_and_b32 v81, 0xffff0000, v128
  v_lshlrev_b32 v82, 16, v132
  v_and_b32 v83, 0xffff0000, v132
  v_pk_add_f32 v[80:81], v[80:81], v[82:83]
  v_lshlrev_b32 v82, 16, v136
  v_and_b32 v83, 0xffff0000, v136
  v_pk_add_f32 v[80:81], v[80:81], v[82:83]
  v_lshlrev_b32 v82, 16, v140
  v_and_b32 v83, 0xffff0000, v140
  v_pk_add_f32 v[80:81], v[80:81], v[82:83]
  v_cvt_pk_bf16_f32 v20, v80, v81
  v_lshlrev_b32 v80, 16, v129
  v_and_b32 v81, 0xffff0000, v129
  v_lshlrev_b32 v82, 16, v133
  v_and_b32 v83, 0xffff0000, v133
  v_pk_add_f32 v[80:81], v[80:81], v[82:83]
  v_lshlrev_b32 v82, 16, v137
  v_and_b32 v83, 0xffff0000, v137
  v_pk_add_f32 v[80:81], v[80:81], v[82:83]
  v_lshlrev_b32 v82, 16, v141
  v_and_b32 v83, 0xffff0000, v141
  v_pk_add_f32 v[80:81], v[80:81], v[82:83]
  v_cvt_pk_bf16_f32 v21, v80, v81
  v_lshlrev_b32 v80, 16, v130
  v_and_b32 v81, 0xffff0000, v130
  v_lshlrev_b32 v82, 16, v134
  v_and_b32 v83, 0xffff0000, v134
  v_pk_add_f32 v[80:81], v[80:81], v[82:83]
  v_lshlrev_b32 v82, 16, v138
  v_and_b32 v83, 0xffff0000, v138
  v_pk_add_f32 v[80:81], v[80:81], v[82:83]
  v_lshlrev_b32 v82, 16, v142
  v_and_b32 v83, 0xffff0000, v142
  v_pk_add_f32 v[80:81], v[80:81], v[82:83]
  v_cvt_pk_bf16_f32 v22, v80, v81
  v_lshlrev_b32 v80, 16, v131
  v_and_b32 v81, 0xffff0000, v131
  v_lshlrev_b32 v82, 16, v135
  v_and_b32 v83, 0xffff0000, v135
  v_pk_add_f32 v[80:81], v[80:81], v[82:83]
  v_lshlrev_b32 v82, 16, v139
  v_and_b32 v83, 0xffff0000, v139
  v_pk_add_f32 v[80:81], v[80:81], v[82:83]
  v_lshlrev_b32 v82, 16, v143
  v_and_b32 v83, 0xffff0000, v143
  v_pk_add_f32 v[80:81], v[80:81], v[82:83]
  v_cvt_pk_bf16_f32 v23, v80, v81
  buffer_store_dwordx2 v[20:21], v7, s[68:71], s73 offen
  buffer_store_dwordx2 v[22:23], v7, s[68:71], s73 offen offset:32
  s_branch L_r6
L_r5:
  v_lshlrev_b32 v80, 16, v128
  v_and_b32 v81, 0xffff0000, v128
  v_lshlrev_b32 v82, 16, v132
  v_and_b32 v83, 0xffff0000, v132
  v_pk_add_f32 v[80:81], v[80:81], v[82:83]
  v_lshlrev_b32 v82, 16, v136
  v_and_b32 v83, 0xffff0000, v136
  v_pk_add_f32 v[80:81], v[80:81], v[82:83]
  v_lshlrev_b32 v82, 16, v140
  v_and_b32 v83, 0xffff0000, v140
  v_pk_add_f32 v[80:81], v[80:81], v[82:83]
  v_cvt_pk_bf16_f32 v20, v80, v81
  v_lshlrev_b32 v80, 16, v129
  v_and_b32 v81, 0xffff0000, v129
  v_lshlrev_b32 v82, 16, v133
  v_and_b32 v83, 0xffff0000, v133
  v_pk_add_f32 v[80:81], v[80:81], v[82:83]
  v_lshlrev_b32 v82, 16, v137
  v_and_b32 v83, 0xffff0000, v137
  v_pk_add_f32 v[80:81], v[80:81], v[82:83]
  v_lshlrev_b32 v82, 16, v141
  v_and_b32 v83, 0xffff0000, v141
  v_pk_add_f32 v[80:81], v[80:81], v[82:83]
  v_cvt_pk_bf16_f32 v21, v80, v81
  buffer_store_dwordx2 v[20:21], v7, s[68:71], s74 offen
L_r6:
L_end:
  s_endpgm
L_redo:
  s_bitcmp1_b32 s28, 0
  s_cbranch_scc1 L_redos
  s_branch L_redob
L_ho:
  s_waitcnt lgkmcnt(0)
  s_bitcmp1_b32 s32, s63
  s_cbranch_scc0 L_hx
  s_mov_b32 s39, 0
L_hk:
  s_xor_b64 s[40:41], s[40:41], s[46:47]
  s_xor_b64 s[42:43], s[42:43], s[46:47]
  s_or_b64 s[40:41], s[40:41], s[42:43]
  s_cbranch_scc0 L_hr
  s_bitcmp1_b32 0x208, s63
  s_cbranch_scc1 L_hs
  s_mov_b32 s75, 196608
  s_mov_b32 s76, 1073741824
L_hx:
  s_cmp_lt_u32 s63, 3
  s_cbranch_scc1 L_hn
  s_waitcnt vmcnt(18)
L_hn:
  s_barrier
  s_lshr_b32 s38, s32, 1
  s_bitcmp1_b32 s38, s63
  s_cbranch_scc0 L_hp
  s_load_dwordx4 s[40:43], s[80:81], s33 glc
L_hp:
L_hq:
  s_bitcmp1_b32 s53, s63
  s_cbranch_scc0 L_hz
  s_mov_b64 exec, 1
  global_store_dword v47, v48, s[80:81] offset:128 sc1
  s_mov_b64 exec, -1
L_hz:
  s_setpc_b64 s[54:55]
L_hs:
  s_add_u32 s39, s39, 1
  s_cmp_ge_u32 s39, 262144
  s_cbranch_scc1 L_hr
  s_load_dwordx4 s[40:43], s[80:81], s33 glc
  s_waitcnt lgkmcnt(0)
  s_branch L_hk
L_hr:
  s_mov_b32 s44, s75
  s_mov_b32 s45, s76
  s_cmp_eq_u32 s33, 0
  s_cbranch_scc0 L_hr1
L_hr0:
  s_movk_i32 s33, 128
  s_and_b32 s32, s32, 960
  s_mov_b32 s35, 1007
  s_cmp_gt_u32 s63, 0
  s_cbranch_scc0 L_hy
  s_add_u32 s76, s79, 4
  s_and_b32 s76, s76, 15
  s_mul_i32 s76, s76, s52
  s_add_u32 s76, s76, s78
  s_add_u32 s75, s77, 0
  s_add_u32 m0, s75, 0
  s_nop 0
  buffer_load_dwordx4 v32, s[8:11], s76 offen offset:0 sc1 lds
  buffer_load_dwordx4 v33, s[8:11], s76 offen offset:1024 sc1 lds
  buffer_load_dwordx4 v34, s[8:11], s76 offen offset:2048 sc1 lds
  buffer_load_dwordx4 v35, s[8:11], s76 offen offset:3072 sc1 lds
  s_add_u32 m0, s75, 4096
  s_nop 0
  buffer_load_dwordx4 v36, s[8:11], s76 offen offset:0 sc1 lds
  buffer_load_dwordx4 v37, s[8:11], s76 offen offset:1024 sc1 lds
  buffer_load_dwordx4 v38, s[8:11], s76 offen offset:2048 sc1 lds
  buffer_load_dwordx4 v39, s[8:11], s76 offen offset:3072 sc1 lds
  s_add_u32 m0, s75, 8192
  s_nop 0
  buffer_load_dwordx4 v40, s[8:11], s76 offen offset:0 sc1 lds
  s_cmp_gt_u32 s63, 1
  s_cbranch_scc0 L_hy
  s_add_u32 s76, s79, 6
  s_and_b32 s76, s76, 15
  s_mul_i32 s76, s76, s52
  s_add_u32 s76, s76, s78
  s_add_u32 s75, s77, 36864
  s_add_u32 m0, s75, 0
  s_nop 0
  buffer_load_dwordx4 v32, s[8:11], s76 offen offset:0 sc1 lds
  buffer_load_dwordx4 v33, s[8:11], s76 offen offset:1024 sc1 lds
  buffer_load_dwordx4 v34, s[8:11], s76 offen offset:2048 sc1 lds
  buffer_load_dwordx4 v35, s[8:11], s76 offen offset:3072 sc1 lds
  s_add_u32 m0, s75, 4096
  s_nop 0
  buffer_load_dwordx4 v36, s[8:11], s76 offen offset:0 sc1 lds
  buffer_load_dwordx4 v37, s[8:11], s76 offen offset:1024 sc1 lds
  buffer_load_dwordx4 v38, s[8:11], s76 offen offset:2048 sc1 lds
  buffer_load_dwordx4 v39, s[8:11], s76 offen offset:3072 sc1 lds
  s_add_u32 m0, s75, 8192
  s_nop 0
  buffer_load_dwordx4 v40, s[8:11], s76 offen offset:0 sc1 lds
  s_cmp_gt_u32 s63, 2
  s_cbranch_scc0 L_hy
  s_add_u32 s76, s79, 8
  s_and_b32 s76, s76, 15
  s_mul_i32 s76, s76, s52
  s_add_u32 s76, s76, s78
  s_add_u32 s75, s77, 73728
  s_add_u32 m0, s75, 0
  s_nop 0
  buffer_load_dwordx4 v32, s[8:11], s76 offen offset:0 sc1 lds
  buffer_load_dwordx4 v33, s[8:11], s76 offen offset:1024 sc1 lds
  buffer_load_dwordx4 v34, s[8:11], s76 offen offset:2048 sc1 lds
  buffer_load_dwordx4 v35, s[8:11], s76 offen offset:3072 sc1 lds
  s_add_u32 m0, s75, 4096
  s_nop 0
  buffer_load_dwordx4 v36, s[8:11], s76 offen offset:0 sc1 lds
  buffer_load_dwordx4 v37, s[8:11], s76 offen offset:1024 sc1 lds
  buffer_load_dwordx4 v38, s[8:11], s76 offen offset:2048 sc1 lds
  buffer_load_dwordx4 v39, s[8:11], s76 offen offset:3072 sc1 lds
  s_add_u32 m0, s75, 8192
  s_nop 0
  buffer_load_dwordx4 v40, s[8:11], s76 offen offset:0 sc1 lds
  s_branch L_hy
L_hr1:
  s_movk_i32 s33, 128
  s_and_b32 s32, s32, 0
  s_mov_b32 s35, 0
  s_cmp_gt_u32 s63, 6
  s_cbranch_scc0 L_hy
  s_add_u32 s76, s79, 5
  s_and_b32 s76, s76, 15
  s_mul_i32 s76, s76, s52
  s_add_u32 s76, s76, s78
  s_add_u32 s75, s77, 73728
  s_add_u32 m0, s75, 0
  s_nop 0
  buffer_load_dwordx4 v32, s[8:11], s76 offen offset:0 sc1 lds
  buffer_load_dwordx4 v33, s[8:11], s76 offen offset:1024 sc1 lds
  buffer_load_dwordx4 v34, s[8:11], s76 offen offset:2048 sc1 lds
  buffer_load_dwordx4 v35, s[8:11], s76 offen offset:3072 sc1 lds
  s_add_u32 m0, s75, 4096
  s_nop 0
  buffer_load_dwordx4 v36, s[8:11], s76 offen offset:0 sc1 lds
  buffer_load_dwordx4 v37, s[8:11], s76 offen offset:1024 sc1 lds
  buffer_load_dwordx4 v38, s[8:11], s76 offen offset:2048 sc1 lds
  buffer_load_dwordx4 v39, s[8:11], s76 offen offset:3072 sc1 lds
  s_add_u32 m0, s75, 8192
  s_nop 0
  buffer_load_dwordx4 v40, s[8:11], s76 offen offset:0 sc1 lds
  s_cmp_gt_u32 s63, 7
  s_cbranch_scc0 L_hy
  s_add_u32 s76, s79, 7
  s_and_b32 s76, s76, 15
  s_mul_i32 s76, s76, s52
  s_add_u32 s76, s76, s78
  s_add_u32 s75, s77, 110592
  s_add_u32 m0, s75, 0
  s_nop 0
  buffer_load_dwordx4 v32, s[8:11], s76 offen offset:0 sc1 lds
  buffer_load_dwordx4 v33, s[8:11], s76 offen offset:1024 sc1 lds
  buffer_load_dwordx4 v34, s[8:11], s76 offen offset:2048 sc1 lds
  buffer_load_dwordx4 v35, s[8:11], s76 offen offset:3072 sc1 lds
  s_add_u32 m0, s75, 4096
  s_nop 0
  buffer_load_dwordx4 v36, s[8:11], s76 offen offset:0 sc1 lds
  buffer_load_dwordx4 v37, s[8:11], s76 offen offset:1024 sc1 lds
  buffer_load_dwordx4 v38, s[8:11], s76 offen offset:2048 sc1 lds
  buffer_load_dwordx4 v39, s[8:11], s76 offen offset:3072 sc1 lds
  s_add_u32 m0, s75, 8192
  s_nop 0
  buffer_load_dwordx4 v40, s[8:11], s76 offen offset:0 sc1 lds
  s_cmp_gt_u32 s63, 8
  s_cbranch_scc0 L_hy
  s_add_u32 s76, s79, 9
  s_and_b32 s76, s76, 15
  s_mul_i32 s76, s76, s52
  s_add_u32 s76, s76, s78
  s_add_u32 s75, s77, 0
  s_add_u32 m0, s75, 0
  s_nop 0
  buffer_load_dwordx4 v32, s[8:11], s76 offen offset:0 sc1 lds
  buffer_load_dwordx4 v33, s[8:11], s76 offen offset:1024 sc1 lds
  buffer_load_dwordx4 v34, s[8:11], s76 offen offset:2048 sc1 lds
  buffer_load_dwordx4 v35, s[8:11], s76 offen offset:3072 sc1 lds
  s_add_u32 m0, s75, 4096
  s_nop 0
  buffer_load_dwordx4 v36, s[8:11], s76 offen offset:0 sc1 lds
  buffer_load_dwordx4 v37, s[8:11], s76 offen offset:1024 sc1 lds
  buffer_load_dwordx4 v38, s[8:11], s76 offen offset:2048 sc1 lds
  buffer_load_dwordx4 v39, s[8:11], s76 offen offset:3072 sc1 lds
  s_add_u32 m0, s75, 8192
  s_nop 0
  buffer_load_dwordx4 v40, s[8:11], s76 offen offset:0 sc1 lds
L_hy:
  s_mov_b32 s75, s44
  s_mov_b32 s76, s45
  s_branch L_hx
L_codeend:
.section .rodata,"a"
.p2align 6
.amdhsa_kernel concat_heads__mha_block_cached__mha_block_cached__near_ridge_kernel
  .amdhsa_next_free_vgpr 512
  .amdhsa_next_free_sgpr 102
  .amdhsa_accum_offset 256
  .amdhsa_group_segment_fixed_size 0
  .amdhsa_kernarg_size 104
  .amdhsa_user_sgpr_count 2
  .amdhsa_user_sgpr_kernarg_segment_ptr 1
  .amdhsa_system_sgpr_workgroup_id_x 1
.end_amdhsa_kernel
```
